```python
import torch

def _softmax(x, axis=-1):
    return torch.softmax(x, dim=axis)
def _gelu(x):
    return torch.nn.functional.gelu(x, approximate="tanh")
def _silu(x):
    return torch.nn.functional.silu(x)
def _sigmoid(x):
    return torch.sigmoid(x)
def _layernorm(x, axis=-1, eps=1e-5):
    m = x.mean(dim=axis, keepdim=True)
    v = x.var(dim=axis, keepdim=True, unbiased=False)
    return (x - m) / torch.sqrt(v + eps)
def _scatter_add(tgt, idx, src, axis=0):
    return tgt.clone().index_add_(axis, idx, src)
def _segment_sum(src, seg, n):
    out = torch.zeros((n,) + src.shape[1:], dtype=src.dtype)
    return out.index_add_(0, seg, src)
def _pad(x, pw):
    flat = tuple(v for pair in reversed(pw) for v in pair)
    return torch.nn.functional.pad(x, flat)

kernel_name = 'sequential_preLN__sliding_block__glu_gated_swiglu__prompt'

def setup_inputs():

    _w = (lambda a: (lambda t: t.to(torch.bfloat16) if t.is_floating_point() else t)(torch.as_tensor(a)))
    def _A_setup():
        B, S, D = 1, 2048, 640
        return {
            "x": _w((lambda *s: torch.randn(*s, dtype=torch.bfloat16) * 0.05)(B, S, D)),
            "wqkv": _w((lambda *s: torch.randn(*s, dtype=torch.bfloat16) * 0.05)(D, 3 * D)),
            "wo": _w((lambda *s: torch.randn(*s, dtype=torch.bfloat16) * 0.05)(D, D)),
        }
    _A_in = _A_setup()

    def _B_setup():
        B, S, D, F = 1, 2048, 640, 1536
        return {
            "x": _w((lambda *s: torch.randn(*s, dtype=torch.bfloat16) * 0.05)(B, S, D)),
            "w1": _w((lambda *s: torch.randn(*s, dtype=torch.bfloat16) * 0.8)(D, F) * (2.0 / D) ** 0.5),
            "w3": _w((lambda *s: torch.randn(*s, dtype=torch.bfloat16) * 0.8)(D, F) * (2.0 / D) ** 0.5),
            "w2": _w((lambda *s: torch.randn(*s, dtype=torch.bfloat16) * 0.8)(F, D) * (2.0 / F) ** 0.5),
        }
    _B_in = _B_setup()

    return {
        "A_x": _A_in["x"],
        "A_wqkv": _A_in["wqkv"],
        "A_wo": _A_in["wo"],
        "B_x": _B_in["x"],
        "B_w1": _B_in["w1"],
        "B_w3": _B_in["w3"],
        "B_w2": _B_in["w2"],
    }

def reference(A_x, A_wqkv, A_wo, B_x, B_w1, B_w3, B_w2):
    def _A_ref(x, wqkv, wo):
        B, S, D = x.shape
        H = 32; Dh = D // H; W = 256
        qkv = (lambda x, *d: x.permute(*d))((x @ wqkv).reshape(B, S, 3, H, Dh), 2, 0, 3, 1, 4)
        q, k, v = qkv[0], qkv[1], qkv[2]
        scores = torch.einsum("bhqd,bhkd->bhqk", q, k) * (Dh ** -0.5)
        idx = torch.arange(S)
        mask = (idx[:, None] - idx[None, :] >= 0) & (idx[:, None] - idx[None, :] < W)
        scores = torch.where(mask[None, None], scores, -1e9)
        p = _softmax(scores, axis=-1)
        o = torch.einsum("bhqk,bhkd->bhqd", p, v)
        return (lambda x, *d: x.permute(*d))(o, 0, 2, 1, 3).reshape(B, S, D) @ wo

    def _B_ref(x, w1, w3, w2):
        gate = torch.einsum("bsd,df->bsf", x, w1)
        up = torch.einsum("bsd,df->bsf", x, w3)
        h = _silu(gate) * up
        out = torch.einsum("bsf,fd->bsd", h, w2)
        return out

    x = A_x
    h = x + _A_ref(_layernorm(x, axis=-1), A_wqkv, A_wo)
    h2 = h + _B_ref(_layernorm(h, axis=-1), B_w1, B_w3, B_w2)
    return h2
```

```asm
; @launch kernel=mega_kernel grid=(256,1,1) block=(512,1,1) lds=163840
.amdgcn_target "amdgcn-amd-amdhsa--gfx950"
.text
.globl mega_kernel
.p2align 8
.type mega_kernel,@function
mega_kernel:
    s_cmp_ge_u32 s2, 256
    s_cbranch_scc1 mega_kernel_end
    s_load_dwordx16 s[32:47], s[0:1], 0
    s_load_dwordx4 s[48:51], s[0:1], 64
    s_bfe_u32 s54, s2, 0x30003
    s_lshl_b32 exec_lo, 0x01010101, s54
    s_mov_b32 exec_hi, exec_lo
    s_getpc_b64 s[52:53]
mega_kernel_pc1:
    s_sub_u32 s52, s52, mega_kernel_pc1-mega_kernel
    s_subb_u32 s53, s53, 0
    v_lshlrev_b32 v5, 6, v0
    v_min_u32 v6, mega_kernel_end-mega_kernel, v5
    global_load_dword v9, v6, s[52:53]
    v_add_u32 v5, 32768, v5
    v_min_u32 v6, mega_kernel_end-mega_kernel, v5
    global_load_dword v9, v6, s[52:53]
    s_mov_b64 exec, -1
    v_lshrrev_b32 v5, 6, v0
    v_and_b32 v1, 63, v0
    v_readfirstlane_b32 s24, v5
    v_lshlrev_b32 v2, 4, v1
    v_lshrrev_b32 v3, 5, v1
    v_and_b32 v4, 31, v1
    s_and_b32 s52, s2, 7
    s_lshr_b32 s53, s2, 3
    s_and_b32 s54, s52, 1
    s_mul_i32 s54, s54, 30
    s_add_u32 s54, s54, s53
    s_lshr_b32 s25, s54, 2
    s_and_b32 s54, s54, 3
    s_lshr_b32 s52, s52, 1
    s_lshl_b32 s55, s52, 2
    s_add_u32 s26, s55, s54
    s_mul_i32 s54, s54, 5
    s_add_u32 s54, s54, 1
    s_lshr_b32 s54, s54, 1
    s_add_u32 s54, s54, s52
    s_add_u32 s27, s54, s25
    s_cmp_ge_u32 s27, 20
    s_cselect_b32 s54, 20, 0
    s_sub_u32 s27, s27, s54
    s_cmp_ge_u32 s27, 10
    s_cselect_b32 s54, 10, 0
    s_sub_u32 s27, s27, s54
    s_cmp_ge_u32 s2, 240
    s_cbranch_scc1 mega_kernel_nl
    s_cmp_lt_u32 s24, 4
    s_cbranch_scc1 mega_kernel_nl
    s_sub_u32 s31, s24, 4
    s_lshl_b32 s29, s31, 12
    s_add_u32 s29, s29, 98304
    s_mul_i32 s28, s26, 163840
    s_lshl_b32 s52, s27, 7
    s_add_u32 s58, s28, s52
    s_add_u32 s28, s28, 1280
    s_lshl_b32 s59, s25, 8
    s_mul_i32 s52, s27, 245760
    s_add_u32 s59, s59, s52
    v_lshrrev_b32 v5, 3, v1
    s_lshl_b32 s52, s31, 5
    v_add_u32 v5, s52, v5
    v_mul_u32_u24 v5, 1280, v5
    v_and_b32 v6, 7, v1
    v_lshrrev_b32 v7, 4, v1
    v_xor_b32 v6, v6, v7
    v_lshl_add_u32 v16, v6, 4, v5
    v_xor_b32 v5, 64, v16
    v_add_u32 v17, 9216, v16
    v_add_u32 v18, 18432, v5
    v_add_u32 v19, 27648, v5
    s_lshl_b32 s52, s31, 4
    v_add_u32 v5, s52, v7
    v_mul_u32_u24 v5, 3840, v5
    v_and_b32 v6, 15, v1
    v_lshlrev_b32 v8, 2, v7
    v_xor_b32 v6, v6, v8
    v_lshl_add_u32 v20, v6, 4, v5
    v_xor_b32 v5, 32, v20
    v_add_u32 v21, 14336, v20
    v_add_u32 v22, 28672, v5
    v_add_u32 v23, 43008, v5
    s_waitcnt lgkmcnt(0)
    s_mov_b32 s12, s32
    s_mov_b32 s13, s33
    s_mov_b32 s14, 2621440
    s_mov_b32 s15, 0x20000
    s_add_i32 m0, s29, 0
    s_nop 0
    buffer_load_dwordx4 v16, s[12:15], s58 offen offset:0 lds
    buffer_load_dwordx4 v17, s[12:15], s58 offen offset:1024 lds
    buffer_load_dwordx4 v18, s[12:15], s58 offen offset:2048 lds
    buffer_load_dwordx4 v19, s[12:15], s58 offen offset:3072 lds
    s_mov_b32 s16, s34
    s_mov_b32 s17, s35
    s_mov_b32 s18, 2457600
    s_mov_b32 s19, 0x20000
    s_mov_b32 s20, s50
    s_mov_b32 s21, s51
    s_mov_b32 s22, 23043072
    s_mov_b32 s23, 0x20000
    s_add_i32 m0, s29, 16384
    s_nop 0
    buffer_load_dwordx4 v20, s[16:19], s59 offen offset:0 lds
    buffer_load_dwordx4 v21, s[16:19], s59 offen offset:1024 lds
    buffer_load_dwordx4 v22, s[16:19], s59 offen offset:2048 lds
    buffer_load_dwordx4 v23, s[16:19], s59 offen offset:3072 lds
    s_add_u32 s58, s58, 128
    s_add_u32 s59, s59, 245760
    s_cmp_ge_u32 s58, s28
    s_cselect_b32 s52, 1280, 0
    s_cselect_b32 s53, 2457600, 0
    s_sub_u32 s58, s58, s52
    s_sub_u32 s59, s59, s53
    v_mov_b32 v5, 0
    s_mov_b32 s52, 22517760
    buffer_load_dword v30, v5, s[20:23], s52 offen sc1
    s_mov_b32 s60, s58
    s_mov_b32 s30, s59
    s_lshr_b32 s61, s31, 1
    s_cmp_ge_u32 s25, 5
    s_cselect_b32 s52, 5, 0
    s_sub_u32 s52, s25, s52
    s_min_u32 s52, s52, 5
    s_lshl_b32 s52, s52, 1
    s_add_u32 s52, s52, s61
    s_cmp_lg_u32 s52, 0
    s_cbranch_scc1 mega_kernel_lt1
    s_mov_b32 s54, 0x38281000
    s_mov_b32 s55, 0x40301808
    s_mov_b32 s56, 0x3020100
    s_mov_b32 s57, 0x88786050
    s_mov_b32 s58, 0x90806858
    s_mov_b32 s59, 0x8070605
    s_branch mega_kernel_ltd
mega_kernel_lt1:
    s_cmp_lg_u32 s52, 1
    s_cbranch_scc1 mega_kernel_lt2
    s_mov_b32 s54, 0x20f8b0a8
    s_mov_b32 s55, 0x48f0b8a0
    s_mov_b32 s56, 0x40f0b0a
    s_mov_b32 s57, 0xc070d8c8
    s_mov_b32 s58, 0xe898e0d0
    s_mov_b32 s59, 0xe090d0c
    s_branch mega_kernel_ltd
mega_kernel_lt2:
    s_cmp_lg_u32 s52, 2
    s_cbranch_scc1 mega_kernel_lt3
    s_mov_b32 s54, 0x50281800
    s_mov_b32 s55, 0x58302008
    s_mov_b32 s56, 0x15121110
    s_mov_b32 s57, 0x90786840
    s_mov_b32 s58, 0x98807048
    s_mov_b32 s59, 0x19171614
    s_branch mega_kernel_ltd
mega_kernel_lt3:
    s_cmp_lg_u32 s52, 3
    s_cbranch_scc1 mega_kernel_lt4
    s_mov_b32 s54, 0x10c8b8a0
    s_mov_b32 s55, 0x38d0c0a8
    s_mov_b32 s56, 0x131c1b1a
    s_mov_b32 s57, 0xb060f8e8
    s_mov_b32 s58, 0xd888f0e0
    s_mov_b32 s59, 0x1d181f1e
    s_branch mega_kernel_ltd
mega_kernel_lt4:
    s_cmp_lg_u32 s52, 4
    s_cbranch_scc1 mega_kernel_lt5
    s_mov_b32 s54, 0x40301808
    s_mov_b32 s55, 0x48382010
    s_mov_b32 s56, 0x24232120
    s_mov_b32 s57, 0x90806858
    s_mov_b32 s58, 0x98887060
    s_mov_b32 s59, 0x29282625
    s_branch mega_kernel_ltd
mega_kernel_lt5:
    s_cmp_lg_u32 s52, 5
    s_cbranch_scc1 mega_kernel_lt6
    s_mov_b32 s54, 0x5000b8a8
    s_mov_b32 s55, 0x7828c0b0
    s_mov_b32 s56, 0x27222b2a
    s_mov_b32 s57, 0xf0a0e8d8
    s_mov_b32 s58, 0xf8c8e0d0
    s_mov_b32 s59, 0x312c2e2d
    s_branch mega_kernel_ltd
mega_kernel_lt6:
    s_cmp_lg_u32 s52, 6
    s_cbranch_scc1 mega_kernel_lt7
    s_mov_b32 s54, 0x38281000
    s_mov_b32 s55, 0x30201808
    s_mov_b32 s56, 0x3332302f
    s_mov_b32 s57, 0x80705848
    s_mov_b32 s58, 0x88786050
    s_mov_b32 s59, 0x38373534
    s_branch mega_kernel_ltd
mega_kernel_lt7:
    s_cmp_lg_u32 s52, 7
    s_cbranch_scc1 mega_kernel_lt8
    s_mov_b32 s54, 0xe0f0a898
    s_mov_b32 s55, 0xf8e8b0a0
    s_mov_b32 s56, 0x403e3a39
    s_mov_b32 s57, 0x9040d8c8
    s_mov_b32 s58, 0xb868d0c0
    s_mov_b32 s59, 0x3b363d3c
    s_branch mega_kernel_ltd
mega_kernel_lt8:
    s_cmp_lg_u32 s52, 8
    s_cbranch_scc1 mega_kernel_lt9
    s_mov_b32 s54, 0x78281000
    s_mov_b32 s55, 0x70201808
    s_mov_b32 s56, 0x4742413f
    s_mov_b32 s57, 0xb0604838
    s_mov_b32 s58, 0xb8685040
    s_mov_b32 s59, 0x4b464443
    s_branch mega_kernel_ltd
mega_kernel_lt9:
    s_cmp_lg_u32 s52, 9
    s_cbranch_scc1 mega_kernel_lt10
    s_mov_b32 s54, 0x30c09888
    s_mov_b32 s55, 0x58c8a090
    s_mov_b32 s56, 0x454c4948
    s_mov_b32 s57, 0xd080e8d8
    s_mov_b32 s58, 0xf8a8f0e0
    s_mov_b32 s59, 0x4f4a4e4d
    s_branch mega_kernel_ltd
mega_kernel_lt10:
    s_cmp_lg_u32 s52, 10
    s_cbranch_scc1 mega_kernel_lt11
    s_mov_b32 s54, 0x18100800
    s_mov_b32 s55, 0x38302820
    s_mov_b32 s56, 0x0
    s_mov_b32 s57, 0x58504840
    s_mov_b32 s58, 0x78706860
    s_mov_b32 s59, 0x0
    s_branch mega_kernel_ltd
mega_kernel_lt11:
    s_mov_b32 s54, 0x98908880
    s_mov_b32 s55, 0xb8b0a8a0
    s_mov_b32 s56, 0x0
    s_mov_b32 s57, 0xd8d0c8c0
    s_mov_b32 s58, 0xf8f0e8e0
    s_mov_b32 s59, 0x0
mega_kernel_ltd:
    s_bitcmp1_b32 s31, 0
    s_cselect_b32 s54, s57, s54
    s_cselect_b32 s55, s58, s55
    v_bfe_u32 v5, v1, 2, 2
    v_bfe_u32 v6, v1, 4, 1
    v_cmp_eq_u32 vcc, 1, v6
    v_mov_b32 v6, s54
    v_mov_b32 v7, s55
    v_cndmask_b32 v6, v6, v7, vcc
    v_and_b32 v7, 3, v1
    v_lshlrev_b32 v7, 3, v7
    v_bfe_u32 v6, v6, v7, 8
    v_lshl_add_u32 v7, v5, 1, v3
    v_lshlrev_b32 v7, 5, v7
    v_xor_b32 v6, v6, v7
    v_lshl_add_u32 v5, v3, 3, v5
    v_lshl_add_u32 v28, v5, 8, v6
    v_add_u32 v28, 98304, v28
    v_lshlrev_b32 v5, 7, v4
    v_add_u32 v5, s29, v5
    v_bfe_u32 v6, v4, 1, 3
    v_xor_b32 v6, v6, v3
    v_xor_b32 v7, 0, v6
    v_lshl_add_u32 v24, v7, 4, v5
    v_xor_b32 v7, 2, v6
    v_lshl_add_u32 v25, v7, 4, v5
    v_xor_b32 v7, 4, v6
    v_lshl_add_u32 v26, v7, 4, v5
    v_xor_b32 v7, 6, v6
    v_lshl_add_u32 v27, v7, 4, v5
    s_mov_b32 s58, s60
    s_mov_b32 s59, s30
    s_mul_i32 s4, s26, 20480
    s_lshl_b32 s56, s31, 9
    s_add_u32 s4, s4, s56
    s_add_u32 s4, s4, 21872640
    s_mul_i32 s5, s25, 10240
    s_lshl_b32 s57, s31, 8
    s_add_u32 s5, s5, s57
    s_add_u32 s5, s5, 22200320
    s_lshl_b32 s55, s27, 11
    s_add_u32 s55, s55, s4
    s_lshl_b32 s56, s27, 10
    s_add_u32 s56, s56, s5
    s_mov_b32 s54, 0x3f803f80
    s_add_i32 m0, s29, 32768
    s_nop 0
    buffer_load_dwordx4 v16, s[12:15], s58 offen offset:0 lds
    buffer_load_dwordx4 v17, s[12:15], s58 offen offset:1024 lds
    buffer_load_dwordx4 v18, s[12:15], s58 offen offset:2048 lds
    buffer_load_dwordx4 v19, s[12:15], s58 offen offset:3072 lds
    s_add_i32 m0, s29, 49152
    s_nop 0
    buffer_load_dwordx4 v20, s[16:19], s59 offen offset:0 lds
    buffer_load_dwordx4 v21, s[16:19], s59 offen offset:1024 lds
    buffer_load_dwordx4 v22, s[16:19], s59 offen offset:2048 lds
    buffer_load_dwordx4 v23, s[16:19], s59 offen offset:3072 lds
    s_add_u32 s58, s58, 128
    s_add_u32 s59, s59, 245760
    s_cmp_ge_u32 s58, s28
    s_cselect_b32 s52, 1280, 0
    s_cselect_b32 s53, 2457600, 0
    s_sub_u32 s58, s58, s52
    s_sub_u32 s59, s59, s53
    s_waitcnt vmcnt(8)
    s_barrier
    s_add_i32 m0, s29, -65536
    s_nop 0
    buffer_load_dwordx4 v16, s[12:15], s58 offen offset:0 lds
    buffer_load_dwordx4 v17, s[12:15], s58 offen offset:1024 lds
    v_readfirstlane_b32 s3, v30
    s_nop 0
    s_add_u32 s3, s3, 0x9e3779b9
    ds_read_b128 v[32:35], v24
    ds_read_b128 v[36:39], v25
    ds_read_b128 v[40:43], v26
    ds_read_b128 v[44:47], v27
    ds_read_b64_tr_b16 v[48:49], v28 offset:16384
    ds_read_b64_tr_b16 v[50:51], v28 offset:17408
    ds_read_b64_tr_b16 v[52:53], v28 offset:20480
    ds_read_b64_tr_b16 v[54:55], v28 offset:21504
    ds_read_b64_tr_b16 v[56:57], v28 offset:24576
    ds_read_b64_tr_b16 v[58:59], v28 offset:25600
    ds_read_b64_tr_b16 v[60:61], v28 offset:28672
    ds_read_b64_tr_b16 v[62:63], v28 offset:29696
    v_mov_b32 v64, 0
    v_mov_b32 v66, 0
    v_mov_b32 v68, 0
    v_lshlrev_b32 v7, 4, v4
    v_lshlrev_b32 v8, 3, v4
    buffer_load_dwordx4 v18, s[12:15], s58 offen offset:2048 lds
    buffer_load_dwordx4 v19, s[12:15], s58 offen offset:3072 lds
    s_add_i32 m0, s29, -49152
    s_nop 0
    buffer_load_dwordx4 v20, s[16:19], s59 offen offset:0 lds
    buffer_load_dwordx4 v21, s[16:19], s59 offen offset:1024 lds
    buffer_load_dwordx4 v22, s[16:19], s59 offen offset:2048 lds
    buffer_load_dwordx4 v23, s[16:19], s59 offen offset:3072 lds
    s_add_u32 s58, s58, 128
    s_add_u32 s59, s59, 245760
    s_cmp_ge_u32 s58, s28
    s_cselect_b32 s52, 1280, 0
    s_cselect_b32 s53, 2457600, 0
    s_sub_u32 s58, s58, s52
    s_sub_u32 s59, s59, s53
    s_add_i32 m0, s29, -32768
    s_nop 0
    buffer_load_dwordx4 v16, s[12:15], s58 offen offset:0 lds
    buffer_load_dwordx4 v17, s[12:15], s58 offen offset:1024 lds
    s_waitcnt lgkmcnt(0)
    s_waitcnt vmcnt(10)
    s_barrier
    v_mov_b32 v65, s3
    v_mov_b32 v67, s3
    v_mov_b32 v69, s3
    buffer_load_dwordx4 v18, s[12:15], s58 offen offset:2048 lds
    buffer_load_dwordx4 v19, s[12:15], s58 offen offset:3072 lds
    v_lshlrev_b32 v5, 16, v32
    v_and_b32 v32, 0xffff0000, v32
    v_lshlrev_b32 v6, 16, v48
    v_and_b32 v48, 0xffff0000, v48
    v_add_f32 v64, v64, v5
    v_fmac_f32 v66, v5, v5
    v_add_f32 v68, v68, v6
    v_add_f32 v64, v64, v32
    v_fmac_f32 v66, v32, v32
    v_add_f32 v68, v68, v48
    s_add_i32 m0, s29, -16384
    s_nop 0
    buffer_load_dwordx4 v20, s[16:19], s59 offen offset:0 lds
    buffer_load_dwordx4 v21, s[16:19], s59 offen offset:1024 lds
    v_lshlrev_b32 v5, 16, v33
    v_and_b32 v33, 0xffff0000, v33
    v_lshlrev_b32 v6, 16, v49
    v_and_b32 v49, 0xffff0000, v49
    v_add_f32 v64, v64, v5
    v_fmac_f32 v66, v5, v5
    v_add_f32 v68, v68, v6
    v_add_f32 v64, v64, v33
    v_fmac_f32 v66, v33, v33
    v_add_f32 v68, v68, v49
    buffer_load_dwordx4 v22, s[16:19], s59 offen offset:2048 lds
    buffer_load_dwordx4 v23, s[16:19], s59 offen offset:3072 lds
    s_add_u32 s58, s58, 128
    s_add_u32 s59, s59, 245760
    s_cmp_ge_u32 s58, s28
    s_cselect_b32 s52, 1280, 0
    s_cselect_b32 s53, 2457600, 0
    s_sub_u32 s58, s58, s52
    s_sub_u32 s59, s59, s53
    v_lshlrev_b32 v5, 16, v34
    v_and_b32 v34, 0xffff0000, v34
    v_lshlrev_b32 v6, 16, v50
    v_and_b32 v50, 0xffff0000, v50
    v_add_f32 v64, v64, v5
    v_fmac_f32 v66, v5, v5
    v_add_f32 v68, v68, v6
    v_add_f32 v64, v64, v34
    v_fmac_f32 v66, v34, v34
    v_add_f32 v68, v68, v50
    s_add_i32 m0, s29, 0
    s_nop 0
    buffer_load_dwordx4 v16, s[12:15], s58 offen offset:0 lds
    buffer_load_dwordx4 v17, s[12:15], s58 offen offset:1024 lds
    v_lshlrev_b32 v5, 16, v35
    v_and_b32 v35, 0xffff0000, v35
    v_lshlrev_b32 v6, 16, v51
    v_and_b32 v51, 0xffff0000, v51
    v_add_f32 v64, v64, v5
    v_fmac_f32 v66, v5, v5
    v_add_f32 v68, v68, v6
    v_add_f32 v64, v64, v35
    v_fmac_f32 v66, v35, v35
    v_add_f32 v68, v68, v51
    s_waitcnt vmcnt(10)
    s_barrier
    buffer_load_dwordx4 v18, s[12:15], s58 offen offset:2048 lds
    buffer_load_dwordx4 v19, s[12:15], s58 offen offset:3072 lds
    v_lshlrev_b32 v5, 16, v36
    v_and_b32 v36, 0xffff0000, v36
    v_lshlrev_b32 v6, 16, v52
    v_and_b32 v52, 0xffff0000, v52
    v_add_f32 v64, v64, v5
    v_fmac_f32 v66, v5, v5
    v_add_f32 v68, v68, v6
    v_add_f32 v64, v64, v36
    v_fmac_f32 v66, v36, v36
    v_add_f32 v68, v68, v52
    s_add_i32 m0, s29, 16384
    s_nop 0
    buffer_load_dwordx4 v20, s[16:19], s59 offen offset:0 lds
    buffer_load_dwordx4 v21, s[16:19], s59 offen offset:1024 lds
    v_lshlrev_b32 v5, 16, v37
    v_and_b32 v37, 0xffff0000, v37
    v_lshlrev_b32 v6, 16, v53
    v_and_b32 v53, 0xffff0000, v53
    v_add_f32 v64, v64, v5
    v_fmac_f32 v66, v5, v5
    v_add_f32 v68, v68, v6
    v_add_f32 v64, v64, v37
    v_fmac_f32 v66, v37, v37
    v_add_f32 v68, v68, v53
    buffer_load_dwordx4 v22, s[16:19], s59 offen offset:2048 lds
    buffer_load_dwordx4 v23, s[16:19], s59 offen offset:3072 lds
    s_add_u32 s58, s58, 128
    s_add_u32 s59, s59, 245760
    s_cmp_ge_u32 s58, s28
    s_cselect_b32 s52, 1280, 0
    s_cselect_b32 s53, 2457600, 0
    s_sub_u32 s58, s58, s52
    s_sub_u32 s59, s59, s53
    v_lshlrev_b32 v5, 16, v38
    v_and_b32 v38, 0xffff0000, v38
    v_lshlrev_b32 v6, 16, v54
    v_and_b32 v54, 0xffff0000, v54
    v_add_f32 v64, v64, v5
    v_fmac_f32 v66, v5, v5
    v_add_f32 v68, v68, v6
    v_add_f32 v64, v64, v38
    v_fmac_f32 v66, v38, v38
    v_add_f32 v68, v68, v54
    s_add_i32 m0, s29, 32768
    s_nop 0
    buffer_load_dwordx4 v16, s[12:15], s58 offen offset:0 lds
    buffer_load_dwordx4 v17, s[12:15], s58 offen offset:1024 lds
    v_lshlrev_b32 v5, 16, v39
    v_and_b32 v39, 0xffff0000, v39
    v_lshlrev_b32 v6, 16, v55
    v_and_b32 v55, 0xffff0000, v55
    v_add_f32 v64, v64, v5
    v_fmac_f32 v66, v5, v5
    v_add_f32 v68, v68, v6
    v_add_f32 v64, v64, v39
    v_fmac_f32 v66, v39, v39
    v_add_f32 v68, v68, v55
    s_waitcnt vmcnt(10)
    s_barrier
    buffer_load_dwordx4 v18, s[12:15], s58 offen offset:2048 lds
    buffer_load_dwordx4 v19, s[12:15], s58 offen offset:3072 lds
    v_lshlrev_b32 v5, 16, v40
    v_and_b32 v40, 0xffff0000, v40
    v_lshlrev_b32 v6, 16, v56
    v_and_b32 v56, 0xffff0000, v56
    v_add_f32 v64, v64, v5
    v_fmac_f32 v66, v5, v5
    v_add_f32 v68, v68, v6
    v_add_f32 v64, v64, v40
    v_fmac_f32 v66, v40, v40
    v_add_f32 v68, v68, v56
    s_add_i32 m0, s29, 49152
    s_nop 0
    buffer_load_dwordx4 v20, s[16:19], s59 offen offset:0 lds
    buffer_load_dwordx4 v21, s[16:19], s59 offen offset:1024 lds
    v_lshlrev_b32 v5, 16, v41
    v_and_b32 v41, 0xffff0000, v41
    v_lshlrev_b32 v6, 16, v57
    v_and_b32 v57, 0xffff0000, v57
    v_add_f32 v64, v64, v5
    v_fmac_f32 v66, v5, v5
    v_add_f32 v68, v68, v6
    v_add_f32 v64, v64, v41
    v_fmac_f32 v66, v41, v41
    v_add_f32 v68, v68, v57
    buffer_load_dwordx4 v22, s[16:19], s59 offen offset:2048 lds
    buffer_load_dwordx4 v23, s[16:19], s59 offen offset:3072 lds
    s_add_u32 s58, s58, 128
    s_add_u32 s59, s59, 245760
    s_cmp_ge_u32 s58, s28
    s_cselect_b32 s52, 1280, 0
    s_cselect_b32 s53, 2457600, 0
    s_sub_u32 s58, s58, s52
    s_sub_u32 s59, s59, s53
    v_lshlrev_b32 v5, 16, v42
    v_and_b32 v42, 0xffff0000, v42
    v_lshlrev_b32 v6, 16, v58
    v_and_b32 v58, 0xffff0000, v58
    v_add_f32 v64, v64, v5
    v_fmac_f32 v66, v5, v5
    v_add_f32 v68, v68, v6
    v_add_f32 v64, v64, v42
    v_fmac_f32 v66, v42, v42
    v_add_f32 v68, v68, v58
    s_add_i32 m0, s29, -65536
    s_nop 0
    buffer_load_dwordx4 v16, s[12:15], s58 offen offset:0 lds
    buffer_load_dwordx4 v17, s[12:15], s58 offen offset:1024 lds
    v_lshlrev_b32 v5, 16, v43
    v_and_b32 v43, 0xffff0000, v43
    v_lshlrev_b32 v6, 16, v59
    v_and_b32 v59, 0xffff0000, v59
    v_add_f32 v64, v64, v5
    v_fmac_f32 v66, v5, v5
    v_add_f32 v68, v68, v6
    v_add_f32 v64, v64, v43
    v_fmac_f32 v66, v43, v43
    v_add_f32 v68, v68, v59
    s_waitcnt vmcnt(10)
    s_barrier
    buffer_load_dwordx4 v18, s[12:15], s58 offen offset:2048 lds
    buffer_load_dwordx4 v19, s[12:15], s58 offen offset:3072 lds
    v_lshlrev_b32 v5, 16, v44
    v_and_b32 v44, 0xffff0000, v44
    v_lshlrev_b32 v6, 16, v60
    v_and_b32 v60, 0xffff0000, v60
    v_add_f32 v64, v64, v5
    v_fmac_f32 v66, v5, v5
    v_add_f32 v68, v68, v6
    v_add_f32 v64, v64, v44
    v_fmac_f32 v66, v44, v44
    v_add_f32 v68, v68, v60
    s_add_i32 m0, s29, -49152
    s_nop 0
    buffer_load_dwordx4 v20, s[16:19], s59 offen offset:0 lds
    buffer_load_dwordx4 v21, s[16:19], s59 offen offset:1024 lds
    v_lshlrev_b32 v5, 16, v45
    v_and_b32 v45, 0xffff0000, v45
    v_lshlrev_b32 v6, 16, v61
    v_and_b32 v61, 0xffff0000, v61
    v_add_f32 v64, v64, v5
    v_fmac_f32 v66, v5, v5
    v_add_f32 v68, v68, v6
    v_add_f32 v64, v64, v45
    v_fmac_f32 v66, v45, v45
    v_add_f32 v68, v68, v61
    buffer_load_dwordx4 v22, s[16:19], s59 offen offset:2048 lds
    buffer_load_dwordx4 v23, s[16:19], s59 offen offset:3072 lds
    s_add_u32 s58, s58, 128
    s_add_u32 s59, s59, 245760
    s_cmp_ge_u32 s58, s28
    s_cselect_b32 s52, 1280, 0
    s_cselect_b32 s53, 2457600, 0
    s_sub_u32 s58, s58, s52
    s_sub_u32 s59, s59, s53
    v_lshlrev_b32 v5, 16, v46
    v_and_b32 v46, 0xffff0000, v46
    v_lshlrev_b32 v6, 16, v62
    v_and_b32 v62, 0xffff0000, v62
    v_add_f32 v64, v64, v5
    v_fmac_f32 v66, v5, v5
    v_add_f32 v68, v68, v6
    v_add_f32 v64, v64, v46
    v_fmac_f32 v66, v46, v46
    v_add_f32 v68, v68, v62
    s_add_i32 m0, s29, -32768
    s_nop 0
    buffer_load_dwordx4 v16, s[12:15], s58 offen offset:0 lds
    buffer_load_dwordx4 v17, s[12:15], s58 offen offset:1024 lds
    v_lshlrev_b32 v5, 16, v47
    v_and_b32 v47, 0xffff0000, v47
    v_lshlrev_b32 v6, 16, v63
    v_and_b32 v63, 0xffff0000, v63
    v_add_f32 v64, v64, v5
    v_fmac_f32 v66, v5, v5
    v_add_f32 v68, v68, v6
    v_add_f32 v64, v64, v47
    v_fmac_f32 v66, v47, v47
    v_add_f32 v68, v68, v63
    v_mov_b32 v5, v64
    s_nop 1
    v_permlane32_swap_b32 v5, v64
    v_add_f32 v64, v5, v64
    v_mov_b32 v6, v66
    s_nop 1
    v_permlane32_swap_b32 v6, v66
    v_add_f32 v66, v6, v66
    v_mov_b32 v5, v68
    s_nop 1
    v_permlane32_swap_b32 v5, v68
    v_add_f32 v68, v5, v68
    s_mov_b32 exec_hi, 0
    buffer_store_dwordx4 v[64:67], v7, s[20:23], s55 offen sc1
    buffer_store_dwordx2 v[68:69], v8, s[20:23], s56 offen sc1
    s_mov_b64 exec, -1
    s_waitcnt vmcnt(12)
    s_barrier
    v_mul_u32_u24 v70, 10240, v3
    v_lshl_add_u32 v70, v4, 4, v70
    v_lshrrev_b32 v71, 1, v70
    s_add_u32 s6, s4, 4096
    s_add_u32 s7, s4, 8192
    s_add_u32 s8, s5, 4096
    buffer_load_dwordx4 v18, s[12:15], s58 offen offset:2048 lds
    buffer_load_dwordx4 v19, s[12:15], s58 offen offset:3072 lds
    s_add_i32 m0, s29, -16384
    s_nop 0
    buffer_load_dwordx4 v20, s[16:19], s59 offen offset:0 lds
    buffer_load_dwordx4 v21, s[16:19], s59 offen offset:1024 lds
    buffer_load_dwordx4 v22, s[16:19], s59 offen offset:2048 lds
    buffer_load_dwordx4 v23, s[16:19], s59 offen offset:3072 lds
    s_add_u32 s58, s58, 128
    s_add_u32 s59, s59, 245760
    s_cmp_ge_u32 s58, s28
    s_cselect_b32 s52, 1280, 0
    s_cselect_b32 s53, 2457600, 0
    s_sub_u32 s58, s58, s52
    s_sub_u32 s59, s59, s53
    s_add_i32 m0, s29, 0
    s_nop 0
    buffer_load_dwordx4 v16, s[12:15], s58 offen offset:0 lds
    buffer_load_dwordx4 v17, s[12:15], s58 offen offset:1024 lds
    s_waitcnt vmcnt(12)
    s_barrier
    buffer_load_dwordx4 v18, s[12:15], s58 offen offset:2048 lds
    buffer_load_dwordx4 v19, s[12:15], s58 offen offset:3072 lds
    s_add_i32 m0, s29, 16384
    s_nop 0
    buffer_load_dwordx4 v20, s[16:19], s59 offen offset:0 lds
    buffer_load_dwordx4 v21, s[16:19], s59 offen offset:1024 lds
    buffer_load_dwordx4 v22, s[16:19], s59 offen offset:2048 lds
    buffer_load_dwordx4 v23, s[16:19], s59 offen offset:3072 lds
    s_add_u32 s58, s58, 128
    s_add_u32 s59, s59, 245760
    s_cmp_ge_u32 s58, s28
    s_cselect_b32 s52, 1280, 0
    s_cselect_b32 s53, 2457600, 0
    s_sub_u32 s58, s58, s52
    s_sub_u32 s59, s59, s53
    s_add_i32 m0, s29, 32768
    s_nop 0
    buffer_load_dwordx4 v16, s[12:15], s58 offen offset:0 lds
    buffer_load_dwordx4 v17, s[12:15], s58 offen offset:1024 lds
    v_lshrrev_b32 v5, 4, v4
    v_mul_u32_u24 v5, 20480, v5
    v_and_b32 v6, 15, v1
    v_lshl_add_u32 v95, v6, 3, v5
    v_lshl_add_u32 v5, v6, 4, v5
    v_lshl_add_u32 v94, v3, 8, v5
    s_and_b32 s52, s2, 0x3c
    s_xor_b32 s52, s52, s24
    s_mul_i32 s52, s52, 40960
    s_add_u32 s52, s52, 7864320
    s_and_b32 s53, s2, 7
    s_lshl_b32 s53, s53, 2
    s_lshr_b32 s54, s2, 6
    s_add_u32 s53, s53, s54
    s_lshl_b32 s54, s53, 9
    s_add_u32 s50, s54, s52
    s_lshl_b32 s54, s53, 7
    s_add_u32 s54, s54, s52
    s_add_u32 s51, s54, 16384
    v_mov_b64 v[104:105], -1
    v_mov_b64 v[106:107], -1
    s_bitcmp1_b32 s2, 2
    s_cselect_b32 s53, 1, -1
    s_mul_i32 s53, s53, 163840
    s_add_u32 s10, s50, s53
    s_add_u32 s11, s51, s53
    s_waitcnt vmcnt(10)
    s_barrier
    buffer_load_dwordx4 v18, s[12:15], s58 offen offset:2048 lds
    buffer_load_dwordx4 v19, s[12:15], s58 offen offset:3072 lds
    s_add_i32 m0, s29, 49152
    s_nop 0
    buffer_load_dwordx4 v20, s[16:19], s59 offen offset:0 lds
    buffer_load_dwordx4 v21, s[16:19], s59 offen offset:1024 lds
    buffer_load_dwordx4 v22, s[16:19], s59 offen offset:2048 lds
    buffer_load_dwordx4 v23, s[16:19], s59 offen offset:3072 lds
    s_waitcnt vmcnt(8)
    s_barrier
    buffer_load_dwordx4 v[32:35], v70, s[20:23], s4 offen offset:0 sc1
    buffer_load_dwordx2 v[52:53], v71, s[20:23], s5 offen offset:0 sc1
    buffer_load_dwordx4 v[36:39], v70, s[20:23], s4 offen offset:2048 sc1
    buffer_load_dwordx2 v[54:55], v71, s[20:23], s5 offen offset:1024 sc1
    buffer_load_dwordx4 v[40:43], v70, s[20:23], s6 offen offset:0 sc1
    buffer_load_dwordx2 v[56:57], v71, s[20:23], s5 offen offset:2048 sc1
    buffer_load_dwordx4 v[44:47], v70, s[20:23], s6 offen offset:2048 sc1
    buffer_load_dwordx2 v[58:59], v71, s[20:23], s5 offen offset:3072 sc1
    buffer_load_dwordx4 v[48:51], v70, s[20:23], s7 offen offset:0 sc1
    buffer_load_dwordx2 v[60:61], v71, s[20:23], s8 offen offset:0 sc1
    s_waitcnt vmcnt(10)
    s_barrier
    v_mov_b32 v20, s3
    v_mov_b32 v8, 106496
    ds_write_b32 v8, v20 offset:2048
    s_mov_b32 s61, 0
    s_waitcnt vmcnt(0)
mega_kernel_pt_chk:
    v_xor_b32 v5, s3, v33
    v_xor_b32 v6, s3, v35
    v_xor_b32 v9, s3, v37
    v_or3_b32 v5, v5, v6, v9
    v_xor_b32 v6, s3, v39
    v_xor_b32 v9, s3, v41
    v_or3_b32 v5, v5, v6, v9
    v_xor_b32 v6, s3, v43
    v_xor_b32 v9, s3, v45
    v_or3_b32 v5, v5, v6, v9
    v_xor_b32 v6, s3, v47
    v_xor_b32 v9, s3, v49
    v_or3_b32 v5, v5, v6, v9
    v_xor_b32 v6, s3, v51
    v_xor_b32 v9, s3, v53
    v_or3_b32 v5, v5, v6, v9
    v_xor_b32 v6, s3, v55
    v_xor_b32 v9, s3, v57
    v_or3_b32 v5, v5, v6, v9
    v_xor_b32 v6, s3, v59
    v_xor_b32 v9, s3, v61
    v_or3_b32 v5, v5, v6, v9
    v_cmp_ne_u32 vcc, 0, v5
    s_add_u32 s61, s61, 1
    s_cbranch_vccz mega_kernel_pt_ok
    s_cmp_gt_u32 s61, 40000
    s_cbranch_scc1 mega_kernel_pt_ok
    buffer_load_dwordx4 v[32:35], v70, s[20:23], s4 offen offset:0 sc1
    buffer_load_dwordx2 v[52:53], v71, s[20:23], s5 offen offset:0 sc1
    buffer_load_dwordx4 v[36:39], v70, s[20:23], s4 offen offset:2048 sc1
    buffer_load_dwordx2 v[54:55], v71, s[20:23], s5 offen offset:1024 sc1
    buffer_load_dwordx4 v[40:43], v70, s[20:23], s6 offen offset:0 sc1
    buffer_load_dwordx2 v[56:57], v71, s[20:23], s5 offen offset:2048 sc1
    buffer_load_dwordx4 v[44:47], v70, s[20:23], s6 offen offset:2048 sc1
    buffer_load_dwordx2 v[58:59], v71, s[20:23], s5 offen offset:3072 sc1
    buffer_load_dwordx4 v[48:51], v70, s[20:23], s7 offen offset:0 sc1
    buffer_load_dwordx2 v[60:61], v71, s[20:23], s8 offen offset:0 sc1
    s_waitcnt vmcnt(0)
    s_branch mega_kernel_pt_chk
mega_kernel_pt_ok:
    buffer_store_dwordx4 v[104:107], v94, s[20:23], s50 offen sc1
    s_mov_b32 exec_hi, 0
    buffer_store_dwordx2 v[104:105], v95, s[20:23], s51 offen sc1
    s_mov_b64 exec, -1
    buffer_store_dwordx4 v[104:107], v94, s[20:23], s10 offen sc1
    s_mov_b32 exec_hi, 0
    buffer_store_dwordx2 v[104:105], v95, s[20:23], s11 offen sc1
    s_mov_b64 exec, -1
    v_add_f32 v32, v32, v36
    v_add_f32 v34, v34, v38
    v_add_f32 v52, v52, v54
    v_add_f32 v32, v32, v40
    v_add_f32 v34, v34, v42
    v_add_f32 v52, v52, v56
    v_add_f32 v32, v32, v44
    v_add_f32 v34, v34, v46
    v_add_f32 v52, v52, v58
    v_add_f32 v32, v32, v48
    v_add_f32 v34, v34, v50
    v_add_f32 v52, v52, v60
    v_mov_b32 v5, v32
    s_nop 1
    v_permlane32_swap_b32 v5, v32
    v_add_f32 v32, v5, v32
    v_mov_b32 v6, v34
    s_nop 1
    v_permlane32_swap_b32 v6, v34
    v_add_f32 v34, v6, v34
    v_mov_b32 v7, v52
    s_nop 1
    v_permlane32_swap_b32 v7, v52
    v_add_f32 v52, v7, v52
    v_mul_f32 v32, 0x3acccccd, v32
    v_mul_f32 v34, 0x3acccccd, v34
    v_fma_f32 v5, -v32, v32, v34
    v_max_f32 v5, 0, v5
    v_cvt_pk_bf16_f32 v6, v32, v5
    v_lshlrev_b32 v36, 16, v6
    v_and_b32 v5, 0xffff0000, v6
    v_add_f32 v5, 0x3727c5ac, v5
    v_cvt_pk_bf16_f32 v5, v5, v5
    v_lshlrev_b32 v5, 16, v5
    v_sqrt_f32 v5, v5
    s_nop 0
    v_cvt_pk_bf16_f32 v5, v5, v5
    v_lshlrev_b32 v5, 16, v5
    v_rcp_f32 v37, v5
    v_cvt_pk_bf16_f32 v5, v52, v52
    v_lshlrev_b32 v5, 16, v5
    v_sub_f32 v5, v52, v5
    v_cvt_pk_bf16_f32 v6, v5, v5
    v_cvt_pk_bf16_f32 v44, v52, v5
    v_lshlrev_b32 v6, 16, v6
    v_sub_f32 v5, v5, v6
    v_cvt_pk_bf16_f32 v45, v5, 0
    s_cmp_lt_u32 s25, 5
    s_cselect_b32 s52, 0x3ea52b5c, 0x3f800000
    v_mul_f32 v37, s52, v37
    v_cvt_pk_bf16_f32 v36, -v36, -v36
    s_lshl_b32 s52, s31, 7
    s_add_u32 s52, s52, 106496
    v_lshl_add_u32 v5, v4, 2, s52
    s_lshl_b32 s52, s31, 8
    s_add_u32 s52, s52, 107520
    v_lshl_add_u32 v6, v4, 3, s52
    ds_write_b32 v5, v36
    ds_write_b32 v5, v37 offset:512
    ds_write_b64 v6, v[44:45]
    s_waitcnt lgkmcnt(0)
    s_barrier
    s_branch mega_kernel_a_done
mega_kernel_nl:
    s_waitcnt lgkmcnt(0)
    s_mov_b32 s20, s50
    s_mov_b32 s21, s51
    s_mov_b32 s22, 23043072
    s_mov_b32 s23, 0x20000
    s_mov_b32 s12, s32
    s_mov_b32 s13, s33
    s_mov_b32 s14, 2621440
    s_mov_b32 s15, 0x20000
    s_cmp_lt_u32 s2, 240
    s_cbranch_scc1 mega_kernel_compute
mega_kernel_spare:
    v_mov_b32 v5, 0
    s_mov_b32 s52, 22517760
    buffer_load_dword v30, v5, s[20:23], s52 offen sc1
    v_lshrrev_b32 v5, 4, v4
    v_mul_u32_u24 v5, 20480, v5
    v_and_b32 v6, 15, v1
    v_lshl_add_u32 v95, v6, 3, v5
    v_lshl_add_u32 v5, v6, 4, v5
    v_lshl_add_u32 v94, v3, 8, v5
    s_and_b32 s52, s2, 0x3c
    s_xor_b32 s52, s52, s24
    s_mul_i32 s52, s52, 40960
    s_add_u32 s52, s52, 7864320
    s_and_b32 s53, s2, 7
    s_lshl_b32 s53, s53, 2
    s_lshr_b32 s54, s2, 6
    s_add_u32 s53, s53, s54
    s_lshl_b32 s54, s53, 9
    s_add_u32 s50, s54, s52
    s_lshl_b32 s54, s53, 7
    s_add_u32 s54, s54, s52
    s_add_u32 s51, s54, 16384
    v_mov_b64 v[104:105], -1
    v_mov_b64 v[106:107], -1
    buffer_store_dwordx4 v[104:107], v94, s[20:23], s50 offen sc1
    s_mov_b32 exec_hi, 0
    buffer_store_dwordx2 v[104:105], v95, s[20:23], s51 offen sc1
    s_mov_b64 exec, -1
    s_lshl_b32 s11, s2, 3
    s_add_u32 s11, s11, s24
    s_mul_i32 s11, s11, 49152
    s_add_u32 s11, s11, -81264640
    s_and_b32 s52, s2, 3
    s_mul_i32 s52, s52, 5
    s_add_u32 s52, s52, 1
    s_lshr_b32 s52, s52, 1
    s_bfe_u32 s53, s2, 0x20002
    s_add_u32 s52, s52, s53
    s_lshl_b32 s8, s52, 12
    s_lshl_b32 s52, s2, 2
    s_lshr_b32 s53, s24, 1
    s_add_u32 s52, s52, s53
    s_mul_i32 s52, s52, 40960
    s_and_b32 s53, s24, 1
    s_lshl_b32 s53, s53, 11
    s_add_u32 s52, s52, s53
    s_add_u32 s9, s52, -28835840
    s_mov_b32 s16, s44
    s_mov_b32 s17, s45
    s_mov_b32 s18, 1966080
    s_mov_b32 s19, 0x20000
    s_sub_u32 s4, s2, 240
    s_mul_i32 s5, s4, 122880
    s_mul_i32 s52, s24, 320
    v_add_u32 v5, s52, v1
    s_mul_i32 s6, s24, 5120
    v_mul_u32_u24 v6, 52429, v5
    v_bfe_u32 v6, v6, 22, 3
    v_lshlrev_b32 v6, 1, v6
    v_xor_b32 v6, v6, v5
    v_lshlrev_b32 v20, 4, v6
    s_add_u32 m0, s6, 0
    s_nop 0
    buffer_load_dwordx4 v20, s[16:19], s5 offen lds
    v_add_u32 v5, 64, v5
    v_mul_u32_u24 v6, 52429, v5
    v_bfe_u32 v6, v6, 22, 3
    v_lshlrev_b32 v6, 1, v6
    v_xor_b32 v6, v6, v5
    v_lshlrev_b32 v21, 4, v6
    s_add_u32 m0, s6, 1024
    s_nop 0
    buffer_load_dwordx4 v21, s[16:19], s5 offen lds
    v_add_u32 v5, 64, v5
    v_mul_u32_u24 v6, 52429, v5
    v_bfe_u32 v6, v6, 22, 3
    v_lshlrev_b32 v6, 1, v6
    v_xor_b32 v6, v6, v5
    v_lshlrev_b32 v22, 4, v6
    s_add_u32 m0, s6, 2048
    s_nop 0
    buffer_load_dwordx4 v22, s[16:19], s5 offen lds
    v_add_u32 v5, 64, v5
    v_mul_u32_u24 v6, 52429, v5
    v_bfe_u32 v6, v6, 22, 3
    v_lshlrev_b32 v6, 1, v6
    v_xor_b32 v6, v6, v5
    v_lshlrev_b32 v23, 4, v6
    s_add_u32 m0, s6, 3072
    s_nop 0
    buffer_load_dwordx4 v23, s[16:19], s5 offen lds
    v_add_u32 v5, 64, v5
    v_mul_u32_u24 v6, 52429, v5
    v_bfe_u32 v6, v6, 22, 3
    v_lshlrev_b32 v6, 1, v6
    v_xor_b32 v6, v6, v5
    v_lshlrev_b32 v24, 4, v6
    s_add_u32 m0, s6, 4096
    s_nop 0
    buffer_load_dwordx4 v24, s[16:19], s5 offen lds
    v_add_u32 v5, 64, v5
    s_bfe_u32 s52, s2, 0x10003
    s_lshl_b32 s52, s52, 8
    s_add_u32 s52, s52, 256
    v_and_b32 v31, 255, v0
    v_add_u32 v31, s52, v31
    buffer_load_dword v9, v2, s[16:19], 0 offen
    s_add_u32 s5, s5, 40960
    s_add_u32 m0, s6, 40960
    s_nop 0
    buffer_load_dwordx4 v20, s[16:19], s5 offen lds
    s_add_u32 m0, s6, 41984
    s_nop 0
    buffer_load_dwordx4 v21, s[16:19], s5 offen lds
    s_add_u32 m0, s6, 43008
    s_nop 0
    buffer_load_dwordx4 v22, s[16:19], s5 offen lds
    s_add_u32 m0, s6, 44032
    s_nop 0
    buffer_load_dwordx4 v23, s[16:19], s5 offen lds
    s_add_u32 m0, s6, 45056
    s_nop 0
    buffer_load_dwordx4 v24, s[16:19], s5 offen lds
    v_bfe_u32 v5, v1, 2, 3
    v_lshl_add_u32 v6, v3, 4, v5
    v_mul_u32_u24 v6, 1280, v6
    v_xor_b32 v5, s24, v5
    v_lshl_add_u32 v6, v5, 5, v6
    v_and_b32 v5, 3, v1
    v_lshl_add_u32 v6, v5, 3, v6
    v_add_u32 v7, 81920, v6
    v_add_u32 v5, 5120, v2
    v_add_u32 v8, 10240, v2
    s_mul_i32 s7, s4, 15360
    s_add_u32 s7, s7, 19398656
    s_add_u32 s52, s24, 0
    s_mul_i32 s53, s52, 52
    s_lshr_b32 s53, s53, 8
    s_mul_i32 s53, s53, 240640
    s_lshl_b32 s52, s52, 10
    s_add_u32 s52, s52, s53
    s_add_u32 s54, s52, s7
    s_add_u32 s52, s24, 8
    s_mul_i32 s53, s52, 52
    s_lshr_b32 s53, s53, 8
    s_mul_i32 s53, s53, 240640
    s_lshl_b32 s52, s52, 10
    s_add_u32 s52, s52, s53
    s_add_u32 s55, s52, s7
    s_add_u32 s52, s24, 16
    s_mul_i32 s53, s52, 52
    s_lshr_b32 s53, s53, 8
    s_mul_i32 s53, s53, 240640
    s_lshl_b32 s52, s52, 10
    s_add_u32 s52, s52, s53
    s_add_u32 s56, s52, s7
    s_add_u32 s52, s24, 24
    s_mul_i32 s53, s52, 52
    s_lshr_b32 s53, s53, 8
    s_mul_i32 s53, s53, 240640
    s_lshl_b32 s52, s52, 10
    s_add_u32 s52, s52, s53
    s_add_u32 s57, s52, s7
    s_add_u32 s52, s24, 32
    s_mul_i32 s53, s52, 52
    s_lshr_b32 s53, s53, 8
    s_mul_i32 s53, s53, 240640
    s_lshl_b32 s52, s52, 10
    s_add_u32 s52, s52, s53
    s_add_u32 s58, s52, s7
    s_cmp_ge_u32 s8, 40960
    s_cselect_b32 s52, 40960, 0
    s_sub_u32 s52, s8, s52
    s_add_u32 s10, s9, s52
    s_add_u32 s8, s8, 4096
    buffer_store_dwordx4 v[104:107], v2, s[20:23], s10 offen offset:0 sc1
    buffer_store_dwordx4 v[104:107], v2, s[20:23], s10 offen offset:1024 sc1
    s_waitcnt vmcnt(8)
    s_barrier
    ds_read_b64_tr_b16 v[40:41], v6 offset:0
    ds_read_b64_tr_b16 v[42:43], v6 offset:10240
    ds_read_b64_tr_b16 v[44:45], v6 offset:256
    ds_read_b64_tr_b16 v[46:47], v6 offset:10496
    ds_read_b64_tr_b16 v[48:49], v6 offset:512
    ds_read_b64_tr_b16 v[50:51], v6 offset:10752
    ds_read_b64_tr_b16 v[52:53], v6 offset:768
    ds_read_b64_tr_b16 v[54:55], v6 offset:11008
    ds_read_b64_tr_b16 v[56:57], v6 offset:1024
    ds_read_b64_tr_b16 v[58:59], v6 offset:11264
    s_add_u32 s5, s5, 40960
    s_add_u32 m0, s6, 81920
    s_nop 0
    buffer_load_dwordx4 v20, s[16:19], s5 offen lds
    s_add_u32 m0, s6, 82944
    s_nop 0
    buffer_load_dwordx4 v21, s[16:19], s5 offen lds
    s_add_u32 m0, s6, 83968
    s_nop 0
    buffer_load_dwordx4 v22, s[16:19], s5 offen lds
    s_add_u32 m0, s6, 84992
    s_nop 0
    buffer_load_dwordx4 v23, s[16:19], s5 offen lds
    s_add_u32 m0, s6, 86016
    s_nop 0
    buffer_load_dwordx4 v24, s[16:19], s5 offen lds
    s_waitcnt lgkmcnt(8)
    buffer_store_dwordx4 v[40:43], v2, s[20:23], s54 offen sc1
    s_waitcnt lgkmcnt(6)
    buffer_store_dwordx4 v[44:47], v2, s[20:23], s55 offen sc1
    s_waitcnt lgkmcnt(4)
    buffer_store_dwordx4 v[48:51], v2, s[20:23], s56 offen sc1
    s_waitcnt lgkmcnt(2)
    buffer_store_dwordx4 v[52:55], v2, s[20:23], s57 offen sc1
    s_waitcnt lgkmcnt(0)
    buffer_store_dwordx4 v[56:59], v2, s[20:23], s58 offen sc1
    s_cmp_ge_u32 s8, 40960
    s_cselect_b32 s52, 40960, 0
    s_sub_u32 s52, s8, s52
    s_add_u32 s10, s9, s52
    s_add_u32 s8, s8, 4096
    buffer_store_dwordx4 v[104:107], v2, s[20:23], s10 offen offset:0 sc1
    buffer_store_dwordx4 v[104:107], v2, s[20:23], s10 offen offset:1024 sc1
    s_waitcnt vmcnt(14)
    s_barrier
    ds_read_b64_tr_b16 v[60:61], v6 offset:40960
    ds_read_b64_tr_b16 v[62:63], v6 offset:51200
    ds_read_b64_tr_b16 v[64:65], v6 offset:41216
    ds_read_b64_tr_b16 v[66:67], v6 offset:51456
    ds_read_b64_tr_b16 v[68:69], v6 offset:41472
    ds_read_b64_tr_b16 v[70:71], v6 offset:51712
    ds_read_b64_tr_b16 v[72:73], v6 offset:41728
    ds_read_b64_tr_b16 v[74:75], v6 offset:51968
    ds_read_b64_tr_b16 v[76:77], v6 offset:41984
    ds_read_b64_tr_b16 v[78:79], v6 offset:52224
    s_waitcnt lgkmcnt(8)
    buffer_store_dwordx4 v[60:63], v5, s[20:23], s54 offen sc1
    s_waitcnt lgkmcnt(6)
    buffer_store_dwordx4 v[64:67], v5, s[20:23], s55 offen sc1
    s_waitcnt lgkmcnt(4)
    buffer_store_dwordx4 v[68:71], v5, s[20:23], s56 offen sc1
    s_waitcnt lgkmcnt(2)
    buffer_store_dwordx4 v[72:75], v5, s[20:23], s57 offen sc1
    s_waitcnt lgkmcnt(0)
    buffer_store_dwordx4 v[76:79], v5, s[20:23], s58 offen sc1
    s_cmp_ge_u32 s8, 40960
    s_cselect_b32 s52, 40960, 0
    s_sub_u32 s52, s8, s52
    s_add_u32 s10, s9, s52
    s_add_u32 s8, s8, 4096
    buffer_store_dwordx4 v[104:107], v2, s[20:23], s10 offen offset:0 sc1
    buffer_store_dwordx4 v[104:107], v2, s[20:23], s10 offen offset:1024 sc1
    s_waitcnt vmcnt(14)
    s_barrier
    ds_read_b64_tr_b16 v[80:81], v7 offset:0
    ds_read_b64_tr_b16 v[82:83], v7 offset:10240
    ds_read_b64_tr_b16 v[84:85], v7 offset:256
    ds_read_b64_tr_b16 v[86:87], v7 offset:10496
    ds_read_b64_tr_b16 v[88:89], v7 offset:512
    ds_read_b64_tr_b16 v[90:91], v7 offset:10752
    ds_read_b64_tr_b16 v[92:93], v7 offset:768
    ds_read_b64_tr_b16 v[94:95], v7 offset:11008
    ds_read_b64_tr_b16 v[96:97], v7 offset:1024
    ds_read_b64_tr_b16 v[98:99], v7 offset:11264
    s_waitcnt lgkmcnt(8)
    buffer_store_dwordx4 v[80:83], v8, s[20:23], s54 offen sc1
    s_waitcnt lgkmcnt(6)
    buffer_store_dwordx4 v[84:87], v8, s[20:23], s55 offen sc1
    s_waitcnt lgkmcnt(4)
    buffer_store_dwordx4 v[88:91], v8, s[20:23], s56 offen sc1
    s_waitcnt lgkmcnt(2)
    buffer_store_dwordx4 v[92:95], v8, s[20:23], s57 offen sc1
    s_waitcnt lgkmcnt(0)
    buffer_store_dwordx4 v[96:99], v8, s[20:23], s58 offen sc1
    v_readfirstlane_b32 s3, v30
    s_nop 0
    s_add_u32 s3, s3, 0x9e3779b9
    s_lshl_b32 s52, s2, 2
    s_lshl_b32 s53, s24, 13
    s_add_u32 s52, s52, s53
    s_add_u32 s52, s52, 22451328
    v_lshlrev_b32 v5, 7, v1
    v_mov_b32 v8, s3
    s_waitcnt vmcnt(0)
    s_barrier
    s_cmp_ge_u32 s24, 4
    s_cbranch_scc1 mega_kernel_a_done
    buffer_store_dword v8, v5, s[20:23], s52 offen sc1
    s_branch mega_kernel_a_done
mega_kernel_compute:
    s_mov_b32 s16, s36
    s_mov_b32 s17, s37
    s_mov_b32 s18, 819200
    s_mov_b32 s19, 0x20000
    s_lshl_b32 s54, s2, 2
    s_add_u32 s54, s54, s24
    s_lshl_b32 s54, s54, 10
    buffer_load_dwordx4 v[244:247], v2, s[16:19], s54 offen
    v_lshlrev_b32 v5, 6, v1
    s_mul_i32 s54, s2, 704
    s_min_u32 s54, s54, 163136
    s_add_u32 s54, s54, 22353920
    s_mov_b64 exec, 0x7ff
    buffer_load_dword v9, v5, s[20:23], s54 offen sc1
    s_mov_b64 exec, -1
    s_lshr_b32 s28, s24, 1
    s_and_b32 s29, s24, 1
    s_cmp_ge_u32 s25, 5
    s_cselect_b32 s52, 5, 0
    s_sub_u32 s52, s25, s52
    s_min_u32 s52, s52, 5
    s_lshl_b32 s52, s52, 1
    s_add_u32 s52, s52, s29
    s_cmp_lg_u32 s52, 0
    s_cbranch_scc1 mega_kernel_ct1
    s_mov_b32 s54, 0x38281000
    s_mov_b32 s55, 0x40301808
    s_mov_b32 s56, 0x3020100
    s_mov_b32 s57, 0x88786050
    s_mov_b32 s58, 0x90806858
    s_mov_b32 s59, 0x8070605
    s_branch mega_kernel_ctd
mega_kernel_ct1:
    s_cmp_lg_u32 s52, 1
    s_cbranch_scc1 mega_kernel_ct2
    s_mov_b32 s54, 0x20f8b0a8
    s_mov_b32 s55, 0x48f0b8a0
    s_mov_b32 s56, 0x40f0b0a
    s_mov_b32 s57, 0xc070d8c8
    s_mov_b32 s58, 0xe898e0d0
    s_mov_b32 s59, 0xe090d0c
    s_branch mega_kernel_ctd
mega_kernel_ct2:
    s_cmp_lg_u32 s52, 2
    s_cbranch_scc1 mega_kernel_ct3
    s_mov_b32 s54, 0x50281800
    s_mov_b32 s55, 0x58302008
    s_mov_b32 s56, 0x15121110
    s_mov_b32 s57, 0x90786840
    s_mov_b32 s58, 0x98807048
    s_mov_b32 s59, 0x19171614
    s_branch mega_kernel_ctd
mega_kernel_ct3:
    s_cmp_lg_u32 s52, 3
    s_cbranch_scc1 mega_kernel_ct4
    s_mov_b32 s54, 0x10c8b8a0
    s_mov_b32 s55, 0x38d0c0a8
    s_mov_b32 s56, 0x131c1b1a
    s_mov_b32 s57, 0xb060f8e8
    s_mov_b32 s58, 0xd888f0e0
    s_mov_b32 s59, 0x1d181f1e
    s_branch mega_kernel_ctd
mega_kernel_ct4:
    s_cmp_lg_u32 s52, 4
    s_cbranch_scc1 mega_kernel_ct5
    s_mov_b32 s54, 0x40301808
    s_mov_b32 s55, 0x48382010
    s_mov_b32 s56, 0x24232120
    s_mov_b32 s57, 0x90806858
    s_mov_b32 s58, 0x98887060
    s_mov_b32 s59, 0x29282625
    s_branch mega_kernel_ctd
mega_kernel_ct5:
    s_cmp_lg_u32 s52, 5
    s_cbranch_scc1 mega_kernel_ct6
    s_mov_b32 s54, 0x5000b8a8
    s_mov_b32 s55, 0x7828c0b0
    s_mov_b32 s56, 0x27222b2a
    s_mov_b32 s57, 0xf0a0e8d8
    s_mov_b32 s58, 0xf8c8e0d0
    s_mov_b32 s59, 0x312c2e2d
    s_branch mega_kernel_ctd
mega_kernel_ct6:
    s_cmp_lg_u32 s52, 6
    s_cbranch_scc1 mega_kernel_ct7
    s_mov_b32 s54, 0x38281000
    s_mov_b32 s55, 0x30201808
    s_mov_b32 s56, 0x3332302f
    s_mov_b32 s57, 0x80705848
    s_mov_b32 s58, 0x88786050
    s_mov_b32 s59, 0x38373534
    s_branch mega_kernel_ctd
mega_kernel_ct7:
    s_cmp_lg_u32 s52, 7
    s_cbranch_scc1 mega_kernel_ct8
    s_mov_b32 s54, 0xe0f0a898
    s_mov_b32 s55, 0xf8e8b0a0
    s_mov_b32 s56, 0x403e3a39
    s_mov_b32 s57, 0x9040d8c8
    s_mov_b32 s58, 0xb868d0c0
    s_mov_b32 s59, 0x3b363d3c
    s_branch mega_kernel_ctd
mega_kernel_ct8:
    s_cmp_lg_u32 s52, 8
    s_cbranch_scc1 mega_kernel_ct9
    s_mov_b32 s54, 0x78281000
    s_mov_b32 s55, 0x70201808
    s_mov_b32 s56, 0x4742413f
    s_mov_b32 s57, 0xb0604838
    s_mov_b32 s58, 0xb8685040
    s_mov_b32 s59, 0x4b464443
    s_branch mega_kernel_ctd
mega_kernel_ct9:
    s_cmp_lg_u32 s52, 9
    s_cbranch_scc1 mega_kernel_ct10
    s_mov_b32 s54, 0x30c09888
    s_mov_b32 s55, 0x58c8a090
    s_mov_b32 s56, 0x454c4948
    s_mov_b32 s57, 0xd080e8d8
    s_mov_b32 s58, 0xf8a8f0e0
    s_mov_b32 s59, 0x4f4a4e4d
    s_branch mega_kernel_ctd
mega_kernel_ct10:
    s_cmp_lg_u32 s52, 10
    s_cbranch_scc1 mega_kernel_ct11
    s_mov_b32 s54, 0x18100800
    s_mov_b32 s55, 0x38302820
    s_mov_b32 s56, 0x0
    s_mov_b32 s57, 0x58504840
    s_mov_b32 s58, 0x78706860
    s_mov_b32 s59, 0x0
    s_branch mega_kernel_ctd
mega_kernel_ct11:
    s_mov_b32 s54, 0x98908880
    s_mov_b32 s55, 0xb8b0a8a0
    s_mov_b32 s56, 0x0
    s_mov_b32 s57, 0xd8d0c8c0
    s_mov_b32 s58, 0xf8f0e8e0
    s_mov_b32 s59, 0x0
mega_kernel_ctd:
    v_lshrrev_b32 v31, 4, v1
    v_and_b32 v5, 8, v1
    v_and_b32 v6, 15, v1
    v_add_u32 v30, v5, v6
    s_lshl_b32 s52, s28, 13
    s_add_u32 s52, s52, 98304
    v_lshl_add_u32 v5, v30, 7, s52
    v_lshrrev_b32 v6, 1, v6
    v_xor_b32 v6, v6, v31
    v_lshl_add_u32 v16, v6, 4, v5
    v_xor_b32 v17, 64, v16
    v_subrev_u32 v18, 65536, v16
    v_subrev_u32 v19, 65536, v17
    v_bfe_u32 v5, v1, 2, 2
    v_lshl_add_u32 v6, v31, 3, v5
    v_lshlrev_b32 v6, 8, v6
    v_add_u32 v6, 98304, v6
    v_and_b32 v7, 1, v31
    v_lshl_add_u32 v5, v5, 1, v7
    v_lshl_add_u32 v6, v5, 5, v6
    v_and_b32 v7, 3, v1
    v_lshlrev_b32 v7, 3, v7
    v_bfe_u32 v5, s54, v7, 8
    v_xor_b32 v20, v5, v6
    v_subrev_u32 v24, 65536, v20
    v_bfe_u32 v5, s55, v7, 8
    v_xor_b32 v21, v5, v6
    v_subrev_u32 v25, 65536, v21
    v_bfe_u32 v5, s57, v7, 8
    v_xor_b32 v22, v5, v6
    v_subrev_u32 v26, 65536, v22
    v_bfe_u32 v5, s58, v7, 8
    v_xor_b32 v23, v5, v6
    v_subrev_u32 v27, 65536, v23
    s_lshl_b32 s52, s26, 2
    s_lshl_b32 s53, s28, 1
    s_add_u32 s52, s52, s53
    v_mov_b64 v[194:195], 0
    v_mov_b64 v[198:199], 0
    v_mov_b64 v[202:203], 0
    v_mov_b64 v[206:207], 0
    v_mov_b64 v[210:211], 0
    v_mov_b64 v[214:215], 0
    v_mov_b64 v[218:219], 0
    v_mov_b64 v[222:223], 0
    s_cmp_ge_u32 s25, 10
    s_cbranch_scc1 mega_kernel_vpath
    s_cmp_ge_u32 s25, 5
    s_cselect_b32 s53, 2621440, 0
    s_lshl_b32 s30, s52, 9
    s_add_u32 s30, s30, s53
    v_lshlrev_b32 v5, 3, v31
    v_lshlrev_b32 v6, 4, v30
    v_bfe_u32 v7, s56, v5, 8
    v_lshl_add_u32 v28, v7, 15, v6
    v_bfe_u32 v7, s59, v5, 8
    v_lshl_add_u32 v29, v7, 15, v6
    s_barrier
    ds_read_b128 v[128:131], v16 offset:0
    ds_read_b64_tr_b16 v[144:145], v20 offset:16384
    ds_read_b64_tr_b16 v[146:147], v20 offset:17408
    ds_read_b64_tr_b16 v[148:149], v21 offset:16384
    ds_read_b64_tr_b16 v[150:151], v21 offset:17408
    ds_read_b128 v[132:135], v16 offset:1024
    ds_read_b64_tr_b16 v[152:153], v22 offset:16384
    ds_read_b64_tr_b16 v[154:155], v22 offset:17408
    ds_read_b64_tr_b16 v[156:157], v23 offset:16384
    ds_read_b64_tr_b16 v[158:159], v23 offset:17408
    ds_read_b128 v[136:139], v16 offset:4096
    ds_read_b128 v[140:143], v16 offset:5120
    s_waitcnt lgkmcnt(0)
    v_mfma_f32_16x16x32_bf16 v[64:67], v[144:147], v[128:131], 0
    s_nop 9
    ds_read_b128 v[160:163], v17 offset:0
    ds_read_b64_tr_b16 v[176:177], v20 offset:24576
    v_mfma_f32_16x16x32_bf16 v[68:71], v[148:151], v[128:131], 0
    s_nop 9
    ds_read_b64_tr_b16 v[178:179], v20 offset:25600
    v_mfma_f32_16x16x32_bf16 v[84:87], v[148:151], v[132:135], 0
    s_nop 9
    ds_read_b64_tr_b16 v[180:181], v21 offset:24576
    ds_read_b64_tr_b16 v[182:183], v21 offset:25600
    v_mfma_f32_16x16x32_bf16 v[80:83], v[144:147], v[132:135], 0
    s_nop 9
    ds_read_b128 v[164:167], v17 offset:1024
    v_mfma_f32_16x16x32_bf16 v[88:91], v[152:155], v[132:135], 0
    s_nop 9
    ds_read_b64_tr_b16 v[184:185], v22 offset:24576
    ds_read_b64_tr_b16 v[186:187], v22 offset:25600
    v_mfma_f32_16x16x32_bf16 v[72:75], v[152:155], v[128:131], 0
    s_nop 9
    ds_read_b64_tr_b16 v[188:189], v23 offset:24576
    v_mfma_f32_16x16x32_bf16 v[76:79], v[156:159], v[128:131], 0
    s_nop 9
    ds_read_b64_tr_b16 v[190:191], v23 offset:25600
    ds_read_b128 v[168:171], v17 offset:4096
    v_mfma_f32_16x16x32_bf16 v[92:95], v[156:159], v[132:135], 0
    s_nop 9
    ds_read_b128 v[172:175], v17 offset:5120
    v_mfma_f32_16x16x32_bf16 v[108:111], v[156:159], v[136:139], 0
    s_nop 9
    v_mfma_f32_16x16x32_bf16 v[104:107], v[152:155], v[136:139], 0
    s_nop 9
    v_mfma_f32_16x16x32_bf16 v[100:103], v[148:151], v[136:139], 0
    s_nop 9
    v_mfma_f32_16x16x32_bf16 v[96:99], v[144:147], v[136:139], 0
    s_nop 9
    v_mfma_f32_16x16x32_bf16 v[112:115], v[144:147], v[140:143], 0
    s_nop 9
    v_mfma_f32_16x16x32_bf16 v[116:119], v[148:151], v[140:143], 0
    s_nop 9
    v_mfma_f32_16x16x32_bf16 v[120:123], v[152:155], v[140:143], 0
    s_nop 9
    v_mfma_f32_16x16x32_bf16 v[124:127], v[156:159], v[140:143], 0
    s_nop 9
    s_waitcnt lgkmcnt(0)
    s_barrier
    v_mfma_f32_16x16x32_bf16 v[64:67], v[176:179], v[160:163], v[64:67]
    s_nop 9
    ds_read_b128 v[128:131], v16 offset:32768
    ds_read_b64_tr_b16 v[144:145], v20 offset:49152
    v_mfma_f32_16x16x32_bf16 v[68:71], v[180:183], v[160:163], v[68:71]
    s_nop 9
    ds_read_b64_tr_b16 v[146:147], v20 offset:50176
    v_mfma_f32_16x16x32_bf16 v[84:87], v[180:183], v[164:167], v[84:87]
    s_nop 9
    ds_read_b64_tr_b16 v[148:149], v21 offset:49152
    ds_read_b64_tr_b16 v[150:151], v21 offset:50176
    v_mfma_f32_16x16x32_bf16 v[80:83], v[176:179], v[164:167], v[80:83]
    s_nop 9
    ds_read_b128 v[132:135], v16 offset:33792
    v_mfma_f32_16x16x32_bf16 v[88:91], v[184:187], v[164:167], v[88:91]
    s_nop 9
    ds_read_b64_tr_b16 v[152:153], v22 offset:49152
    ds_read_b64_tr_b16 v[154:155], v22 offset:50176
    v_mfma_f32_16x16x32_bf16 v[72:75], v[184:187], v[160:163], v[72:75]
    s_nop 9
    ds_read_b64_tr_b16 v[156:157], v23 offset:49152
    v_mfma_f32_16x16x32_bf16 v[76:79], v[188:191], v[160:163], v[76:79]
    s_nop 9
    ds_read_b64_tr_b16 v[158:159], v23 offset:50176
    ds_read_b128 v[136:139], v16 offset:36864
    v_mfma_f32_16x16x32_bf16 v[92:95], v[188:191], v[164:167], v[92:95]
    s_nop 9
    ds_read_b128 v[140:143], v16 offset:37888
    v_mfma_f32_16x16x32_bf16 v[108:111], v[188:191], v[168:171], v[108:111]
    s_nop 9
    v_mfma_f32_16x16x32_bf16 v[104:107], v[184:187], v[168:171], v[104:107]
    s_nop 9
    v_mfma_f32_16x16x32_bf16 v[100:103], v[180:183], v[168:171], v[100:103]
    s_nop 9
    v_mfma_f32_16x16x32_bf16 v[96:99], v[176:179], v[168:171], v[96:99]
    s_nop 9
    v_mfma_f32_16x16x32_bf16 v[112:115], v[176:179], v[172:175], v[112:115]
    s_nop 9
    v_mfma_f32_16x16x32_bf16 v[116:119], v[180:183], v[172:175], v[116:119]
    s_nop 9
    v_mfma_f32_16x16x32_bf16 v[120:123], v[184:187], v[172:175], v[120:123]
    s_nop 9
    v_mfma_f32_16x16x32_bf16 v[124:127], v[188:191], v[172:175], v[124:127]
    s_nop 9
    s_waitcnt lgkmcnt(0)
    v_mfma_f32_16x16x32_bf16 v[64:67], v[144:147], v[128:131], v[64:67]
    s_nop 5
    ds_read_b128 v[160:163], v17 offset:32768
    ds_read_b64_tr_b16 v[176:177], v20 offset:57344
    v_mfma_f32_16x16x32_bf16 v[68:71], v[148:151], v[128:131], v[68:71]
    s_nop 5
    ds_read_b64_tr_b16 v[178:179], v20 offset:58368
    v_mfma_f32_16x16x32_bf16 v[84:87], v[148:151], v[132:135], v[84:87]
    s_nop 5
    ds_read_b64_tr_b16 v[180:181], v21 offset:57344
    ds_read_b64_tr_b16 v[182:183], v21 offset:58368
    v_mfma_f32_16x16x32_bf16 v[80:83], v[144:147], v[132:135], v[80:83]
    s_nop 5
    ds_read_b128 v[164:167], v17 offset:33792
    v_mfma_f32_16x16x32_bf16 v[88:91], v[152:155], v[132:135], v[88:91]
    s_nop 5
    ds_read_b64_tr_b16 v[184:185], v22 offset:57344
    ds_read_b64_tr_b16 v[186:187], v22 offset:58368
    v_mfma_f32_16x16x32_bf16 v[72:75], v[152:155], v[128:131], v[72:75]
    s_nop 5
    ds_read_b64_tr_b16 v[188:189], v23 offset:57344
    v_mfma_f32_16x16x32_bf16 v[76:79], v[156:159], v[128:131], v[76:79]
    s_nop 5
    ds_read_b64_tr_b16 v[190:191], v23 offset:58368
    ds_read_b128 v[168:171], v17 offset:36864
    v_mfma_f32_16x16x32_bf16 v[92:95], v[156:159], v[132:135], v[92:95]
    s_nop 5
    ds_read_b128 v[172:175], v17 offset:37888
    v_mfma_f32_16x16x32_bf16 v[108:111], v[156:159], v[136:139], v[108:111]
    s_nop 5
    v_mfma_f32_16x16x32_bf16 v[104:107], v[152:155], v[136:139], v[104:107]
    s_nop 5
    v_mfma_f32_16x16x32_bf16 v[100:103], v[148:151], v[136:139], v[100:103]
    s_nop 5
    v_mfma_f32_16x16x32_bf16 v[96:99], v[144:147], v[136:139], v[96:99]
    s_nop 5
    v_mfma_f32_16x16x32_bf16 v[112:115], v[144:147], v[140:143], v[112:115]
    s_nop 5
    v_mfma_f32_16x16x32_bf16 v[116:119], v[148:151], v[140:143], v[116:119]
    s_nop 5
    v_mfma_f32_16x16x32_bf16 v[120:123], v[152:155], v[140:143], v[120:123]
    s_nop 5
    v_mfma_f32_16x16x32_bf16 v[124:127], v[156:159], v[140:143], v[124:127]
    s_nop 5
    s_waitcnt lgkmcnt(0)
    s_barrier
    v_mfma_f32_16x16x32_bf16 v[64:67], v[176:179], v[160:163], v[64:67]
    s_nop 5
    ds_read_b128 v[128:131], v18 offset:0
    ds_read_b64_tr_b16 v[144:145], v24 offset:16384
    v_mfma_f32_16x16x32_bf16 v[68:71], v[180:183], v[160:163], v[68:71]
    s_nop 5
    ds_read_b64_tr_b16 v[146:147], v24 offset:17408
    v_mfma_f32_16x16x32_bf16 v[84:87], v[180:183], v[164:167], v[84:87]
    s_nop 5
    ds_read_b64_tr_b16 v[148:149], v25 offset:16384
    ds_read_b64_tr_b16 v[150:151], v25 offset:17408
    v_mfma_f32_16x16x32_bf16 v[80:83], v[176:179], v[164:167], v[80:83]
    s_nop 5
    ds_read_b128 v[132:135], v18 offset:1024
    v_mfma_f32_16x16x32_bf16 v[88:91], v[184:187], v[164:167], v[88:91]
    s_nop 5
    ds_read_b64_tr_b16 v[152:153], v26 offset:16384
    ds_read_b64_tr_b16 v[154:155], v26 offset:17408
    v_mfma_f32_16x16x32_bf16 v[72:75], v[184:187], v[160:163], v[72:75]
    s_nop 5
    ds_read_b64_tr_b16 v[156:157], v27 offset:16384
    v_mfma_f32_16x16x32_bf16 v[76:79], v[188:191], v[160:163], v[76:79]
    s_nop 5
    ds_read_b64_tr_b16 v[158:159], v27 offset:17408
    ds_read_b128 v[136:139], v18 offset:4096
    v_mfma_f32_16x16x32_bf16 v[92:95], v[188:191], v[164:167], v[92:95]
    s_nop 5
    ds_read_b128 v[140:143], v18 offset:5120
    v_mfma_f32_16x16x32_bf16 v[108:111], v[188:191], v[168:171], v[108:111]
    s_nop 5
    v_mfma_f32_16x16x32_bf16 v[104:107], v[184:187], v[168:171], v[104:107]
    s_nop 5
    v_mfma_f32_16x16x32_bf16 v[100:103], v[180:183], v[168:171], v[100:103]
    s_nop 5
    v_mfma_f32_16x16x32_bf16 v[96:99], v[176:179], v[168:171], v[96:99]
    s_nop 5
    v_mfma_f32_16x16x32_bf16 v[112:115], v[176:179], v[172:175], v[112:115]
    s_nop 5
    v_mfma_f32_16x16x32_bf16 v[116:119], v[180:183], v[172:175], v[116:119]
    s_nop 5
    v_mfma_f32_16x16x32_bf16 v[120:123], v[184:187], v[172:175], v[120:123]
    s_nop 5
    v_mfma_f32_16x16x32_bf16 v[124:127], v[188:191], v[172:175], v[124:127]
    s_nop 5
    s_waitcnt lgkmcnt(0)
    v_mfma_f32_16x16x32_bf16 v[64:67], v[144:147], v[128:131], v[64:67]
    s_nop 2
    ds_read_b128 v[160:163], v19 offset:0
    ds_read_b64_tr_b16 v[176:177], v24 offset:24576
    v_mfma_f32_16x16x32_bf16 v[68:71], v[148:151], v[128:131], v[68:71]
    s_nop 2
    ds_read_b64_tr_b16 v[178:179], v24 offset:25600
    v_mfma_f32_16x16x32_bf16 v[84:87], v[148:151], v[132:135], v[84:87]
    s_nop 2
    ds_read_b64_tr_b16 v[180:181], v25 offset:24576
    ds_read_b64_tr_b16 v[182:183], v25 offset:25600
    v_mfma_f32_16x16x32_bf16 v[80:83], v[144:147], v[132:135], v[80:83]
    s_nop 2
    ds_read_b128 v[164:167], v19 offset:1024
    v_mfma_f32_16x16x32_bf16 v[88:91], v[152:155], v[132:135], v[88:91]
    s_nop 2
    ds_read_b64_tr_b16 v[184:185], v26 offset:24576
    ds_read_b64_tr_b16 v[186:187], v26 offset:25600
    v_mfma_f32_16x16x32_bf16 v[72:75], v[152:155], v[128:131], v[72:75]
    s_nop 2
    ds_read_b64_tr_b16 v[188:189], v27 offset:24576
    v_mfma_f32_16x16x32_bf16 v[76:79], v[156:159], v[128:131], v[76:79]
    s_nop 2
    ds_read_b64_tr_b16 v[190:191], v27 offset:25600
    ds_read_b128 v[168:171], v19 offset:4096
    v_mfma_f32_16x16x32_bf16 v[92:95], v[156:159], v[132:135], v[92:95]
    s_nop 2
    ds_read_b128 v[172:175], v19 offset:5120
    v_mfma_f32_16x16x32_bf16 v[108:111], v[156:159], v[136:139], v[108:111]
    s_nop 2
    v_mfma_f32_16x16x32_bf16 v[104:107], v[152:155], v[136:139], v[104:107]
    s_nop 2
    v_mfma_f32_16x16x32_bf16 v[100:103], v[148:151], v[136:139], v[100:103]
    s_nop 2
    v_mfma_f32_16x16x32_bf16 v[96:99], v[144:147], v[136:139], v[96:99]
    s_nop 2
    v_mfma_f32_16x16x32_bf16 v[112:115], v[144:147], v[140:143], v[112:115]
    s_nop 2
    v_mfma_f32_16x16x32_bf16 v[116:119], v[148:151], v[140:143], v[116:119]
    s_nop 2
    v_mfma_f32_16x16x32_bf16 v[120:123], v[152:155], v[140:143], v[120:123]
    s_nop 2
    v_mfma_f32_16x16x32_bf16 v[124:127], v[156:159], v[140:143], v[124:127]
    s_nop 2
    s_waitcnt lgkmcnt(0)
    s_barrier
    v_mfma_f32_16x16x32_bf16 v[64:67], v[176:179], v[160:163], v[64:67]
    s_nop 2
    ds_read_b128 v[128:131], v18 offset:32768
    ds_read_b64_tr_b16 v[144:145], v24 offset:49152
    v_mfma_f32_16x16x32_bf16 v[68:71], v[180:183], v[160:163], v[68:71]
    s_nop 2
    ds_read_b64_tr_b16 v[146:147], v24 offset:50176
    v_mfma_f32_16x16x32_bf16 v[84:87], v[180:183], v[164:167], v[84:87]
    s_nop 2
    ds_read_b64_tr_b16 v[148:149], v25 offset:49152
    ds_read_b64_tr_b16 v[150:151], v25 offset:50176
    v_mfma_f32_16x16x32_bf16 v[80:83], v[176:179], v[164:167], v[80:83]
    s_nop 2
    ds_read_b128 v[132:135], v18 offset:33792
    v_mfma_f32_16x16x32_bf16 v[88:91], v[184:187], v[164:167], v[88:91]
    s_nop 2
    ds_read_b64_tr_b16 v[152:153], v26 offset:49152
    ds_read_b64_tr_b16 v[154:155], v26 offset:50176
    v_mfma_f32_16x16x32_bf16 v[72:75], v[184:187], v[160:163], v[72:75]
    s_nop 2
    ds_read_b64_tr_b16 v[156:157], v27 offset:49152
    v_mfma_f32_16x16x32_bf16 v[76:79], v[188:191], v[160:163], v[76:79]
    s_nop 2
    ds_read_b64_tr_b16 v[158:159], v27 offset:50176
    ds_read_b128 v[136:139], v18 offset:36864
    v_mfma_f32_16x16x32_bf16 v[92:95], v[188:191], v[164:167], v[92:95]
    s_nop 2
    ds_read_b128 v[140:143], v18 offset:37888
    v_mfma_f32_16x16x32_bf16 v[108:111], v[188:191], v[168:171], v[108:111]
    s_nop 2
    v_mfma_f32_16x16x32_bf16 v[104:107], v[184:187], v[168:171], v[104:107]
    s_nop 2
    v_mfma_f32_16x16x32_bf16 v[100:103], v[180:183], v[168:171], v[100:103]
    s_nop 2
    v_mfma_f32_16x16x32_bf16 v[96:99], v[176:179], v[168:171], v[96:99]
    s_nop 2
    v_mfma_f32_16x16x32_bf16 v[112:115], v[176:179], v[172:175], v[112:115]
    s_nop 2
    v_mfma_f32_16x16x32_bf16 v[116:119], v[180:183], v[172:175], v[116:119]
    s_nop 2
    v_mfma_f32_16x16x32_bf16 v[120:123], v[184:187], v[172:175], v[120:123]
    s_nop 2
    v_mfma_f32_16x16x32_bf16 v[124:127], v[188:191], v[172:175], v[124:127]
    s_nop 2
    s_waitcnt lgkmcnt(0)
    v_mfma_f32_16x16x32_bf16 v[64:67], v[144:147], v[128:131], v[64:67]
    ds_read_b128 v[160:163], v19 offset:32768
    ds_read_b64_tr_b16 v[176:177], v24 offset:57344
    v_mfma_f32_16x16x32_bf16 v[68:71], v[148:151], v[128:131], v[68:71]
    ds_read_b64_tr_b16 v[178:179], v24 offset:58368
    v_mfma_f32_16x16x32_bf16 v[84:87], v[148:151], v[132:135], v[84:87]
    ds_read_b64_tr_b16 v[180:181], v25 offset:57344
    ds_read_b64_tr_b16 v[182:183], v25 offset:58368
    v_mfma_f32_16x16x32_bf16 v[80:83], v[144:147], v[132:135], v[80:83]
    ds_read_b128 v[164:167], v19 offset:33792
    v_mfma_f32_16x16x32_bf16 v[88:91], v[152:155], v[132:135], v[88:91]
    ds_read_b64_tr_b16 v[184:185], v26 offset:57344
    ds_read_b64_tr_b16 v[186:187], v26 offset:58368
    v_mfma_f32_16x16x32_bf16 v[72:75], v[152:155], v[128:131], v[72:75]
    ds_read_b64_tr_b16 v[188:189], v27 offset:57344
    v_mfma_f32_16x16x32_bf16 v[76:79], v[156:159], v[128:131], v[76:79]
    ds_read_b64_tr_b16 v[190:191], v27 offset:58368
    ds_read_b128 v[168:171], v19 offset:36864
    v_mfma_f32_16x16x32_bf16 v[92:95], v[156:159], v[132:135], v[92:95]
    ds_read_b128 v[172:175], v19 offset:37888
    v_mfma_f32_16x16x32_bf16 v[108:111], v[156:159], v[136:139], v[108:111]
    v_mfma_f32_16x16x32_bf16 v[104:107], v[152:155], v[136:139], v[104:107]
    v_mfma_f32_16x16x32_bf16 v[100:103], v[148:151], v[136:139], v[100:103]
    v_mfma_f32_16x16x32_bf16 v[96:99], v[144:147], v[136:139], v[96:99]
    v_mfma_f32_16x16x32_bf16 v[112:115], v[144:147], v[140:143], v[112:115]
    v_mfma_f32_16x16x32_bf16 v[116:119], v[148:151], v[140:143], v[116:119]
    v_mfma_f32_16x16x32_bf16 v[120:123], v[152:155], v[140:143], v[120:123]
    v_mfma_f32_16x16x32_bf16 v[124:127], v[156:159], v[140:143], v[124:127]
    s_waitcnt lgkmcnt(0)
    s_barrier
    v_mfma_f32_16x16x32_bf16 v[64:67], v[176:179], v[160:163], v[64:67]
    ds_read_b128 v[128:131], v16 offset:0
    ds_read_b64_tr_b16 v[144:145], v20 offset:16384
    v_mfma_f32_16x16x32_bf16 v[68:71], v[180:183], v[160:163], v[68:71]
    ds_read_b64_tr_b16 v[146:147], v20 offset:17408
    v_mfma_f32_16x16x32_bf16 v[84:87], v[180:183], v[164:167], v[84:87]
    ds_read_b64_tr_b16 v[148:149], v21 offset:16384
    ds_read_b64_tr_b16 v[150:151], v21 offset:17408
    v_mfma_f32_16x16x32_bf16 v[80:83], v[176:179], v[164:167], v[80:83]
    ds_read_b128 v[132:135], v16 offset:1024
    v_mfma_f32_16x16x32_bf16 v[88:91], v[184:187], v[164:167], v[88:91]
    ds_read_b64_tr_b16 v[152:153], v22 offset:16384
    ds_read_b64_tr_b16 v[154:155], v22 offset:17408
    v_mfma_f32_16x16x32_bf16 v[72:75], v[184:187], v[160:163], v[72:75]
    ds_read_b64_tr_b16 v[156:157], v23 offset:16384
    v_mfma_f32_16x16x32_bf16 v[76:79], v[188:191], v[160:163], v[76:79]
    ds_read_b64_tr_b16 v[158:159], v23 offset:17408
    ds_read_b128 v[136:139], v16 offset:4096
    v_mfma_f32_16x16x32_bf16 v[92:95], v[188:191], v[164:167], v[92:95]
    ds_read_b128 v[140:143], v16 offset:5120
    v_mfma_f32_16x16x32_bf16 v[108:111], v[188:191], v[168:171], v[108:111]
    v_mfma_f32_16x16x32_bf16 v[104:107], v[184:187], v[168:171], v[104:107]
    v_mfma_f32_16x16x32_bf16 v[100:103], v[180:183], v[168:171], v[100:103]
    v_mfma_f32_16x16x32_bf16 v[96:99], v[176:179], v[168:171], v[96:99]
    v_mfma_f32_16x16x32_bf16 v[112:115], v[176:179], v[172:175], v[112:115]
    v_mfma_f32_16x16x32_bf16 v[116:119], v[180:183], v[172:175], v[116:119]
    v_mfma_f32_16x16x32_bf16 v[120:123], v[184:187], v[172:175], v[120:123]
    v_mfma_f32_16x16x32_bf16 v[124:127], v[188:191], v[172:175], v[124:127]
    s_waitcnt lgkmcnt(0)
    v_mfma_f32_16x16x32_bf16 v[64:67], v[144:147], v[128:131], v[64:67]
    ds_read_b128 v[160:163], v17 offset:0
    ds_read_b64_tr_b16 v[176:177], v20 offset:24576
    v_mfma_f32_16x16x32_bf16 v[68:71], v[148:151], v[128:131], v[68:71]
    ds_read_b64_tr_b16 v[178:179], v20 offset:25600
    v_mfma_f32_16x16x32_bf16 v[84:87], v[148:151], v[132:135], v[84:87]
    ds_read_b64_tr_b16 v[180:181], v21 offset:24576
    ds_read_b64_tr_b16 v[182:183], v21 offset:25600
    v_mfma_f32_16x16x32_bf16 v[80:83], v[144:147], v[132:135], v[80:83]
    ds_read_b128 v[164:167], v17 offset:1024
    v_mfma_f32_16x16x32_bf16 v[88:91], v[152:155], v[132:135], v[88:91]
    ds_read_b64_tr_b16 v[184:185], v22 offset:24576
    ds_read_b64_tr_b16 v[186:187], v22 offset:25600
    v_mfma_f32_16x16x32_bf16 v[72:75], v[152:155], v[128:131], v[72:75]
    ds_read_b64_tr_b16 v[188:189], v23 offset:24576
    v_mfma_f32_16x16x32_bf16 v[76:79], v[156:159], v[128:131], v[76:79]
    ds_read_b64_tr_b16 v[190:191], v23 offset:25600
    ds_read_b128 v[168:171], v17 offset:4096
    v_mfma_f32_16x16x32_bf16 v[92:95], v[156:159], v[132:135], v[92:95]
    ds_read_b128 v[172:175], v17 offset:5120
    v_mfma_f32_16x16x32_bf16 v[108:111], v[156:159], v[136:139], v[108:111]
    v_mfma_f32_16x16x32_bf16 v[104:107], v[152:155], v[136:139], v[104:107]
    v_mfma_f32_16x16x32_bf16 v[100:103], v[148:151], v[136:139], v[100:103]
    v_mfma_f32_16x16x32_bf16 v[96:99], v[144:147], v[136:139], v[96:99]
    v_mfma_f32_16x16x32_bf16 v[112:115], v[144:147], v[140:143], v[112:115]
    v_mfma_f32_16x16x32_bf16 v[116:119], v[148:151], v[140:143], v[116:119]
    v_mfma_f32_16x16x32_bf16 v[120:123], v[152:155], v[140:143], v[120:123]
    v_mfma_f32_16x16x32_bf16 v[124:127], v[156:159], v[140:143], v[124:127]
    s_waitcnt lgkmcnt(0)
    s_barrier
    v_mfma_f32_16x16x32_bf16 v[64:67], v[176:179], v[160:163], v[64:67]
    ds_read_b128 v[128:131], v16 offset:32768
    ds_read_b64_tr_b16 v[144:145], v20 offset:49152
    v_mfma_f32_16x16x32_bf16 v[68:71], v[180:183], v[160:163], v[68:71]
    ds_read_b64_tr_b16 v[146:147], v20 offset:50176
    v_mfma_f32_16x16x32_bf16 v[84:87], v[180:183], v[164:167], v[84:87]
    ds_read_b64_tr_b16 v[148:149], v21 offset:49152
    ds_read_b64_tr_b16 v[150:151], v21 offset:50176
    v_mfma_f32_16x16x32_bf16 v[80:83], v[176:179], v[164:167], v[80:83]
    ds_read_b128 v[132:135], v16 offset:33792
    v_mfma_f32_16x16x32_bf16 v[88:91], v[184:187], v[164:167], v[88:91]
    ds_read_b64_tr_b16 v[152:153], v22 offset:49152
    ds_read_b64_tr_b16 v[154:155], v22 offset:50176
    v_mfma_f32_16x16x32_bf16 v[72:75], v[184:187], v[160:163], v[72:75]
    ds_read_b64_tr_b16 v[156:157], v23 offset:49152
    v_mfma_f32_16x16x32_bf16 v[76:79], v[188:191], v[160:163], v[76:79]
    ds_read_b64_tr_b16 v[158:159], v23 offset:50176
    ds_read_b128 v[136:139], v16 offset:36864
    v_mfma_f32_16x16x32_bf16 v[92:95], v[188:191], v[164:167], v[92:95]
    ds_read_b128 v[140:143], v16 offset:37888
    v_mfma_f32_16x16x32_bf16 v[108:111], v[188:191], v[168:171], v[108:111]
    v_mfma_f32_16x16x32_bf16 v[104:107], v[184:187], v[168:171], v[104:107]
    v_mfma_f32_16x16x32_bf16 v[100:103], v[180:183], v[168:171], v[100:103]
    v_mfma_f32_16x16x32_bf16 v[96:99], v[176:179], v[168:171], v[96:99]
    v_mfma_f32_16x16x32_bf16 v[112:115], v[176:179], v[172:175], v[112:115]
    v_mfma_f32_16x16x32_bf16 v[116:119], v[180:183], v[172:175], v[116:119]
    v_mfma_f32_16x16x32_bf16 v[120:123], v[184:187], v[172:175], v[120:123]
    v_mfma_f32_16x16x32_bf16 v[124:127], v[188:191], v[172:175], v[124:127]
    s_waitcnt lgkmcnt(0)
    v_mfma_f32_16x16x32_bf16 v[64:67], v[144:147], v[128:131], v[64:67]
    ds_read_b128 v[160:163], v17 offset:32768
    ds_read_b64_tr_b16 v[176:177], v20 offset:57344
    v_mfma_f32_16x16x32_bf16 v[68:71], v[148:151], v[128:131], v[68:71]
    ds_read_b64_tr_b16 v[178:179], v20 offset:58368
    v_mfma_f32_16x16x32_bf16 v[84:87], v[148:151], v[132:135], v[84:87]
    ds_read_b64_tr_b16 v[180:181], v21 offset:57344
    ds_read_b64_tr_b16 v[182:183], v21 offset:58368
    v_mfma_f32_16x16x32_bf16 v[80:83], v[144:147], v[132:135], v[80:83]
    ds_read_b128 v[164:167], v17 offset:33792
    v_mfma_f32_16x16x32_bf16 v[88:91], v[152:155], v[132:135], v[88:91]
    ds_read_b64_tr_b16 v[184:185], v22 offset:57344
    ds_read_b64_tr_b16 v[186:187], v22 offset:58368
    v_mfma_f32_16x16x32_bf16 v[72:75], v[152:155], v[128:131], v[72:75]
    ds_read_b64_tr_b16 v[188:189], v23 offset:57344
    v_mfma_f32_16x16x32_bf16 v[76:79], v[156:159], v[128:131], v[76:79]
    ds_read_b64_tr_b16 v[190:191], v23 offset:58368
    ds_read_b128 v[168:171], v17 offset:36864
    v_mfma_f32_16x16x32_bf16 v[92:95], v[156:159], v[132:135], v[92:95]
    ds_read_b128 v[172:175], v17 offset:37888
    v_mfma_f32_16x16x32_bf16 v[108:111], v[156:159], v[136:139], v[108:111]
    v_mfma_f32_16x16x32_bf16 v[104:107], v[152:155], v[136:139], v[104:107]
    v_mfma_f32_16x16x32_bf16 v[100:103], v[148:151], v[136:139], v[100:103]
    v_mfma_f32_16x16x32_bf16 v[96:99], v[144:147], v[136:139], v[96:99]
    v_mfma_f32_16x16x32_bf16 v[112:115], v[144:147], v[140:143], v[112:115]
    v_mfma_f32_16x16x32_bf16 v[116:119], v[148:151], v[140:143], v[116:119]
    v_mfma_f32_16x16x32_bf16 v[120:123], v[152:155], v[140:143], v[120:123]
    v_mfma_f32_16x16x32_bf16 v[124:127], v[156:159], v[140:143], v[124:127]
    s_waitcnt lgkmcnt(0)
    s_barrier
    v_mfma_f32_16x16x32_bf16 v[64:67], v[176:179], v[160:163], v[64:67]
    ds_read_b128 v[128:131], v18 offset:0
    ds_read_b64_tr_b16 v[144:145], v24 offset:16384
    v_mfma_f32_16x16x32_bf16 v[68:71], v[180:183], v[160:163], v[68:71]
    ds_read_b64_tr_b16 v[146:147], v24 offset:17408
    v_mfma_f32_16x16x32_bf16 v[84:87], v[180:183], v[164:167], v[84:87]
    ds_read_b64_tr_b16 v[148:149], v25 offset:16384
    ds_read_b64_tr_b16 v[150:151], v25 offset:17408
    v_mfma_f32_16x16x32_bf16 v[80:83], v[176:179], v[164:167], v[80:83]
    ds_read_b128 v[132:135], v18 offset:1024
    v_mfma_f32_16x16x32_bf16 v[88:91], v[184:187], v[164:167], v[88:91]
    ds_read_b64_tr_b16 v[152:153], v26 offset:16384
    ds_read_b64_tr_b16 v[154:155], v26 offset:17408
    v_mfma_f32_16x16x32_bf16 v[72:75], v[184:187], v[160:163], v[72:75]
    ds_read_b64_tr_b16 v[156:157], v27 offset:16384
    v_mfma_f32_16x16x32_bf16 v[76:79], v[188:191], v[160:163], v[76:79]
    ds_read_b64_tr_b16 v[158:159], v27 offset:17408
    ds_read_b128 v[136:139], v18 offset:4096
    v_mfma_f32_16x16x32_bf16 v[92:95], v[188:191], v[164:167], v[92:95]
    ds_read_b128 v[140:143], v18 offset:5120
    v_mfma_f32_16x16x32_bf16 v[108:111], v[188:191], v[168:171], v[108:111]
    v_mfma_f32_16x16x32_bf16 v[104:107], v[184:187], v[168:171], v[104:107]
    v_mfma_f32_16x16x32_bf16 v[100:103], v[180:183], v[168:171], v[100:103]
    v_mfma_f32_16x16x32_bf16 v[96:99], v[176:179], v[168:171], v[96:99]
    v_mfma_f32_16x16x32_bf16 v[112:115], v[176:179], v[172:175], v[112:115]
    v_mfma_f32_16x16x32_bf16 v[116:119], v[180:183], v[172:175], v[116:119]
    v_mfma_f32_16x16x32_bf16 v[120:123], v[184:187], v[172:175], v[120:123]
    v_mfma_f32_16x16x32_bf16 v[124:127], v[188:191], v[172:175], v[124:127]
    s_waitcnt lgkmcnt(0)
    v_mfma_f32_16x16x32_bf16 v[64:67], v[144:147], v[128:131], v[64:67]
    ds_read_b128 v[160:163], v19 offset:0
    ds_read_b64_tr_b16 v[176:177], v24 offset:24576
    v_mfma_f32_16x16x32_bf16 v[68:71], v[148:151], v[128:131], v[68:71]
    ds_read_b64_tr_b16 v[178:179], v24 offset:25600
    v_mfma_f32_16x16x32_bf16 v[84:87], v[148:151], v[132:135], v[84:87]
    ds_read_b64_tr_b16 v[180:181], v25 offset:24576
    ds_read_b64_tr_b16 v[182:183], v25 offset:25600
    v_mfma_f32_16x16x32_bf16 v[80:83], v[144:147], v[132:135], v[80:83]
    ds_read_b128 v[164:167], v19 offset:1024
    v_mfma_f32_16x16x32_bf16 v[88:91], v[152:155], v[132:135], v[88:91]
    ds_read_b64_tr_b16 v[184:185], v26 offset:24576
    ds_read_b64_tr_b16 v[186:187], v26 offset:25600
    v_mfma_f32_16x16x32_bf16 v[72:75], v[152:155], v[128:131], v[72:75]
    ds_read_b64_tr_b16 v[188:189], v27 offset:24576
    v_mfma_f32_16x16x32_bf16 v[76:79], v[156:159], v[128:131], v[76:79]
    ds_read_b64_tr_b16 v[190:191], v27 offset:25600
    ds_read_b128 v[168:171], v19 offset:4096
    v_mfma_f32_16x16x32_bf16 v[92:95], v[156:159], v[132:135], v[92:95]
    ds_read_b128 v[172:175], v19 offset:5120
    v_mfma_f32_16x16x32_bf16 v[108:111], v[156:159], v[136:139], v[108:111]
    v_mfma_f32_16x16x32_bf16 v[104:107], v[152:155], v[136:139], v[104:107]
    v_mfma_f32_16x16x32_bf16 v[100:103], v[148:151], v[136:139], v[100:103]
    v_mfma_f32_16x16x32_bf16 v[96:99], v[144:147], v[136:139], v[96:99]
    v_mfma_f32_16x16x32_bf16 v[112:115], v[144:147], v[140:143], v[112:115]
    v_mfma_f32_16x16x32_bf16 v[116:119], v[148:151], v[140:143], v[116:119]
    v_mfma_f32_16x16x32_bf16 v[120:123], v[152:155], v[140:143], v[120:123]
    v_mfma_f32_16x16x32_bf16 v[124:127], v[156:159], v[140:143], v[124:127]
    s_waitcnt lgkmcnt(0)
    s_barrier
    v_mfma_f32_16x16x32_bf16 v[64:67], v[176:179], v[160:163], v[64:67]
    ds_read_b128 v[128:131], v18 offset:32768
    ds_read_b64_tr_b16 v[144:145], v24 offset:49152
    v_mfma_f32_16x16x32_bf16 v[68:71], v[180:183], v[160:163], v[68:71]
    ds_read_b64_tr_b16 v[146:147], v24 offset:50176
    v_mfma_f32_16x16x32_bf16 v[84:87], v[180:183], v[164:167], v[84:87]
    ds_read_b64_tr_b16 v[148:149], v25 offset:49152
    ds_read_b64_tr_b16 v[150:151], v25 offset:50176
    v_mfma_f32_16x16x32_bf16 v[80:83], v[176:179], v[164:167], v[80:83]
    ds_read_b128 v[132:135], v18 offset:33792
    v_mfma_f32_16x16x32_bf16 v[88:91], v[184:187], v[164:167], v[88:91]
    ds_read_b64_tr_b16 v[152:153], v26 offset:49152
    ds_read_b64_tr_b16 v[154:155], v26 offset:50176
    v_mfma_f32_16x16x32_bf16 v[72:75], v[184:187], v[160:163], v[72:75]
    ds_read_b64_tr_b16 v[156:157], v27 offset:49152
    v_mfma_f32_16x16x32_bf16 v[76:79], v[188:191], v[160:163], v[76:79]
    ds_read_b64_tr_b16 v[158:159], v27 offset:50176
    ds_read_b128 v[136:139], v18 offset:36864
    v_mfma_f32_16x16x32_bf16 v[92:95], v[188:191], v[164:167], v[92:95]
    ds_read_b128 v[140:143], v18 offset:37888
    v_mfma_f32_16x16x32_bf16 v[108:111], v[188:191], v[168:171], v[108:111]
    v_mfma_f32_16x16x32_bf16 v[104:107], v[184:187], v[168:171], v[104:107]
    v_mfma_f32_16x16x32_bf16 v[100:103], v[180:183], v[168:171], v[100:103]
    v_mfma_f32_16x16x32_bf16 v[96:99], v[176:179], v[168:171], v[96:99]
    v_mfma_f32_16x16x32_bf16 v[112:115], v[176:179], v[172:175], v[112:115]
    v_mfma_f32_16x16x32_bf16 v[116:119], v[180:183], v[172:175], v[116:119]
    v_mfma_f32_16x16x32_bf16 v[120:123], v[184:187], v[172:175], v[120:123]
    v_mfma_f32_16x16x32_bf16 v[124:127], v[188:191], v[172:175], v[124:127]
    s_waitcnt lgkmcnt(0)
    v_mfma_f32_16x16x32_bf16 v[64:67], v[144:147], v[128:131], v[64:67]
    ds_read_b128 v[160:163], v19 offset:32768
    ds_read_b64_tr_b16 v[176:177], v24 offset:57344
    v_mfma_f32_16x16x32_bf16 v[68:71], v[148:151], v[128:131], v[68:71]
    ds_read_b64_tr_b16 v[178:179], v24 offset:58368
    v_mfma_f32_16x16x32_bf16 v[84:87], v[148:151], v[132:135], v[84:87]
    ds_read_b64_tr_b16 v[180:181], v25 offset:57344
    ds_read_b64_tr_b16 v[182:183], v25 offset:58368
    v_mfma_f32_16x16x32_bf16 v[80:83], v[144:147], v[132:135], v[80:83]
    ds_read_b128 v[164:167], v19 offset:33792
    v_mfma_f32_16x16x32_bf16 v[88:91], v[152:155], v[132:135], v[88:91]
    ds_read_b64_tr_b16 v[184:185], v26 offset:57344
    ds_read_b64_tr_b16 v[186:187], v26 offset:58368
    v_mfma_f32_16x16x32_bf16 v[72:75], v[152:155], v[128:131], v[72:75]
    ds_read_b64_tr_b16 v[188:189], v27 offset:57344
    v_mfma_f32_16x16x32_bf16 v[76:79], v[156:159], v[128:131], v[76:79]
    ds_read_b64_tr_b16 v[190:191], v27 offset:58368
    ds_read_b128 v[168:171], v19 offset:36864
    v_mfma_f32_16x16x32_bf16 v[92:95], v[156:159], v[132:135], v[92:95]
    ds_read_b128 v[172:175], v19 offset:37888
    v_mfma_f32_16x16x32_bf16 v[108:111], v[156:159], v[136:139], v[108:111]
    v_mfma_f32_16x16x32_bf16 v[104:107], v[152:155], v[136:139], v[104:107]
    v_mfma_f32_16x16x32_bf16 v[100:103], v[148:151], v[136:139], v[100:103]
    v_mfma_f32_16x16x32_bf16 v[96:99], v[144:147], v[136:139], v[96:99]
    v_mfma_f32_16x16x32_bf16 v[112:115], v[144:147], v[140:143], v[112:115]
    v_mfma_f32_16x16x32_bf16 v[116:119], v[148:151], v[140:143], v[116:119]
    v_mfma_f32_16x16x32_bf16 v[120:123], v[152:155], v[140:143], v[120:123]
    v_mfma_f32_16x16x32_bf16 v[124:127], v[156:159], v[140:143], v[124:127]
    s_waitcnt lgkmcnt(0)
    s_barrier
    v_mfma_f32_16x16x32_bf16 v[64:67], v[176:179], v[160:163], v[64:67]
    ds_read_b128 v[128:131], v16 offset:0
    ds_read_b64_tr_b16 v[144:145], v20 offset:16384
    v_mfma_f32_16x16x32_bf16 v[68:71], v[180:183], v[160:163], v[68:71]
    ds_read_b64_tr_b16 v[146:147], v20 offset:17408
    v_mfma_f32_16x16x32_bf16 v[84:87], v[180:183], v[164:167], v[84:87]
    ds_read_b64_tr_b16 v[148:149], v21 offset:16384
    ds_read_b64_tr_b16 v[150:151], v21 offset:17408
    v_mfma_f32_16x16x32_bf16 v[80:83], v[176:179], v[164:167], v[80:83]
    ds_read_b128 v[132:135], v16 offset:1024
    v_mfma_f32_16x16x32_bf16 v[88:91], v[184:187], v[164:167], v[88:91]
    ds_read_b64_tr_b16 v[152:153], v22 offset:16384
    ds_read_b64_tr_b16 v[154:155], v22 offset:17408
    v_mfma_f32_16x16x32_bf16 v[72:75], v[184:187], v[160:163], v[72:75]
    ds_read_b64_tr_b16 v[156:157], v23 offset:16384
    v_mfma_f32_16x16x32_bf16 v[76:79], v[188:191], v[160:163], v[76:79]
    ds_read_b64_tr_b16 v[158:159], v23 offset:17408
    ds_read_b128 v[136:139], v16 offset:4096
    v_mfma_f32_16x16x32_bf16 v[92:95], v[188:191], v[164:167], v[92:95]
    ds_read_b128 v[140:143], v16 offset:5120
    v_mfma_f32_16x16x32_bf16 v[108:111], v[188:191], v[168:171], v[108:111]
    v_mfma_f32_16x16x32_bf16 v[104:107], v[184:187], v[168:171], v[104:107]
    v_mfma_f32_16x16x32_bf16 v[100:103], v[180:183], v[168:171], v[100:103]
    v_mfma_f32_16x16x32_bf16 v[96:99], v[176:179], v[168:171], v[96:99]
    v_mfma_f32_16x16x32_bf16 v[112:115], v[176:179], v[172:175], v[112:115]
    v_mfma_f32_16x16x32_bf16 v[116:119], v[180:183], v[172:175], v[116:119]
    v_mfma_f32_16x16x32_bf16 v[120:123], v[184:187], v[172:175], v[120:123]
    v_mfma_f32_16x16x32_bf16 v[124:127], v[188:191], v[172:175], v[124:127]
    s_waitcnt lgkmcnt(0)
    v_mfma_f32_16x16x32_bf16 v[64:67], v[144:147], v[128:131], v[64:67]
    ds_read_b128 v[160:163], v17 offset:0
    ds_read_b64_tr_b16 v[176:177], v20 offset:24576
    v_mfma_f32_16x16x32_bf16 v[68:71], v[148:151], v[128:131], v[68:71]
    ds_read_b64_tr_b16 v[178:179], v20 offset:25600
    v_mfma_f32_16x16x32_bf16 v[84:87], v[148:151], v[132:135], v[84:87]
    ds_read_b64_tr_b16 v[180:181], v21 offset:24576
    ds_read_b64_tr_b16 v[182:183], v21 offset:25600
    v_mfma_f32_16x16x32_bf16 v[80:83], v[144:147], v[132:135], v[80:83]
    ds_read_b128 v[164:167], v17 offset:1024
    v_mfma_f32_16x16x32_bf16 v[88:91], v[152:155], v[132:135], v[88:91]
    ds_read_b64_tr_b16 v[184:185], v22 offset:24576
    ds_read_b64_tr_b16 v[186:187], v22 offset:25600
    v_mfma_f32_16x16x32_bf16 v[72:75], v[152:155], v[128:131], v[72:75]
    ds_read_b64_tr_b16 v[188:189], v23 offset:24576
    v_mfma_f32_16x16x32_bf16 v[76:79], v[156:159], v[128:131], v[76:79]
    ds_read_b64_tr_b16 v[190:191], v23 offset:25600
    ds_read_b128 v[168:171], v17 offset:4096
    v_mfma_f32_16x16x32_bf16 v[92:95], v[156:159], v[132:135], v[92:95]
    ds_read_b128 v[172:175], v17 offset:5120
    v_mfma_f32_16x16x32_bf16 v[108:111], v[156:159], v[136:139], v[108:111]
    v_mfma_f32_16x16x32_bf16 v[104:107], v[152:155], v[136:139], v[104:107]
    v_mfma_f32_16x16x32_bf16 v[100:103], v[148:151], v[136:139], v[100:103]
    v_mfma_f32_16x16x32_bf16 v[96:99], v[144:147], v[136:139], v[96:99]
    v_mfma_f32_16x16x32_bf16 v[112:115], v[144:147], v[140:143], v[112:115]
    v_mfma_f32_16x16x32_bf16 v[116:119], v[148:151], v[140:143], v[116:119]
    v_mfma_f32_16x16x32_bf16 v[120:123], v[152:155], v[140:143], v[120:123]
    v_mfma_f32_16x16x32_bf16 v[124:127], v[156:159], v[140:143], v[124:127]
    s_waitcnt lgkmcnt(0)
    s_barrier
    v_mfma_f32_16x16x32_bf16 v[64:67], v[176:179], v[160:163], v[64:67]
    ds_read_b128 v[128:131], v16 offset:32768
    ds_read_b64_tr_b16 v[144:145], v20 offset:49152
    v_mfma_f32_16x16x32_bf16 v[68:71], v[180:183], v[160:163], v[68:71]
    ds_read_b64_tr_b16 v[146:147], v20 offset:50176
    v_mfma_f32_16x16x32_bf16 v[84:87], v[180:183], v[164:167], v[84:87]
    ds_read_b64_tr_b16 v[148:149], v21 offset:49152
    ds_read_b64_tr_b16 v[150:151], v21 offset:50176
    v_mfma_f32_16x16x32_bf16 v[80:83], v[176:179], v[164:167], v[80:83]
    ds_read_b128 v[132:135], v16 offset:33792
    v_mfma_f32_16x16x32_bf16 v[88:91], v[184:187], v[164:167], v[88:91]
    ds_read_b64_tr_b16 v[152:153], v22 offset:49152
    ds_read_b64_tr_b16 v[154:155], v22 offset:50176
    v_mfma_f32_16x16x32_bf16 v[72:75], v[184:187], v[160:163], v[72:75]
    ds_read_b64_tr_b16 v[156:157], v23 offset:49152
    v_mfma_f32_16x16x32_bf16 v[76:79], v[188:191], v[160:163], v[76:79]
    ds_read_b64_tr_b16 v[158:159], v23 offset:50176
    ds_read_b128 v[136:139], v16 offset:36864
    v_mfma_f32_16x16x32_bf16 v[92:95], v[188:191], v[164:167], v[92:95]
    ds_read_b128 v[140:143], v16 offset:37888
    v_mfma_f32_16x16x32_bf16 v[108:111], v[188:191], v[168:171], v[108:111]
    v_mfma_f32_16x16x32_bf16 v[104:107], v[184:187], v[168:171], v[104:107]
    v_mfma_f32_16x16x32_bf16 v[100:103], v[180:183], v[168:171], v[100:103]
    v_mfma_f32_16x16x32_bf16 v[96:99], v[176:179], v[168:171], v[96:99]
    v_mfma_f32_16x16x32_bf16 v[112:115], v[176:179], v[172:175], v[112:115]
    v_mfma_f32_16x16x32_bf16 v[116:119], v[180:183], v[172:175], v[116:119]
    v_mfma_f32_16x16x32_bf16 v[120:123], v[184:187], v[172:175], v[120:123]
    v_mfma_f32_16x16x32_bf16 v[124:127], v[188:191], v[172:175], v[124:127]
    s_waitcnt lgkmcnt(0)
    v_mfma_f32_16x16x32_bf16 v[64:67], v[144:147], v[128:131], v[64:67]
    ds_read_b128 v[160:163], v17 offset:32768
    ds_read_b64_tr_b16 v[176:177], v20 offset:57344
    v_mfma_f32_16x16x32_bf16 v[68:71], v[148:151], v[128:131], v[68:71]
    ds_read_b64_tr_b16 v[178:179], v20 offset:58368
    v_mfma_f32_16x16x32_bf16 v[84:87], v[148:151], v[132:135], v[84:87]
    ds_read_b64_tr_b16 v[180:181], v21 offset:57344
    ds_read_b64_tr_b16 v[182:183], v21 offset:58368
    v_mfma_f32_16x16x32_bf16 v[80:83], v[144:147], v[132:135], v[80:83]
    ds_read_b128 v[164:167], v17 offset:33792
    v_mfma_f32_16x16x32_bf16 v[88:91], v[152:155], v[132:135], v[88:91]
    ds_read_b64_tr_b16 v[184:185], v22 offset:57344
    ds_read_b64_tr_b16 v[186:187], v22 offset:58368
    v_mfma_f32_16x16x32_bf16 v[72:75], v[152:155], v[128:131], v[72:75]
    ds_read_b64_tr_b16 v[188:189], v23 offset:57344
    v_mfma_f32_16x16x32_bf16 v[76:79], v[156:159], v[128:131], v[76:79]
    ds_read_b64_tr_b16 v[190:191], v23 offset:58368
    ds_read_b128 v[168:171], v17 offset:36864
    v_mfma_f32_16x16x32_bf16 v[92:95], v[156:159], v[132:135], v[92:95]
    ds_read_b128 v[172:175], v17 offset:37888
    v_mfma_f32_16x16x32_bf16 v[108:111], v[156:159], v[136:139], v[108:111]
    v_mfma_f32_16x16x32_bf16 v[104:107], v[152:155], v[136:139], v[104:107]
    v_mfma_f32_16x16x32_bf16 v[100:103], v[148:151], v[136:139], v[100:103]
    v_mfma_f32_16x16x32_bf16 v[96:99], v[144:147], v[136:139], v[96:99]
    v_mfma_f32_16x16x32_bf16 v[112:115], v[144:147], v[140:143], v[112:115]
    v_mfma_f32_16x16x32_bf16 v[116:119], v[148:151], v[140:143], v[116:119]
    v_mfma_f32_16x16x32_bf16 v[120:123], v[152:155], v[140:143], v[120:123]
    v_mfma_f32_16x16x32_bf16 v[124:127], v[156:159], v[140:143], v[124:127]
    s_waitcnt lgkmcnt(0)
    v_mfma_f32_16x16x32_bf16 v[64:67], v[176:179], v[160:163], v[64:67]
    v_mfma_f32_16x16x32_bf16 v[68:71], v[180:183], v[160:163], v[68:71]
    v_mfma_f32_16x16x32_bf16 v[84:87], v[180:183], v[164:167], v[84:87]
    v_mfma_f32_16x16x32_bf16 v[80:83], v[176:179], v[164:167], v[80:83]
    v_mfma_f32_16x16x32_bf16 v[88:91], v[184:187], v[164:167], v[88:91]
    v_mfma_f32_16x16x32_bf16 v[72:75], v[184:187], v[160:163], v[72:75]
    v_mfma_f32_16x16x32_bf16 v[76:79], v[188:191], v[160:163], v[76:79]
    v_mfma_f32_16x16x32_bf16 v[92:95], v[188:191], v[164:167], v[92:95]
    v_mfma_f32_16x16x32_bf16 v[108:111], v[188:191], v[168:171], v[108:111]
    v_mfma_f32_16x16x32_bf16 v[104:107], v[184:187], v[168:171], v[104:107]
    v_mfma_f32_16x16x32_bf16 v[100:103], v[180:183], v[168:171], v[100:103]
    v_mfma_f32_16x16x32_bf16 v[96:99], v[176:179], v[168:171], v[96:99]
    v_mfma_f32_16x16x32_bf16 v[112:115], v[176:179], v[172:175], v[112:115]
    v_mfma_f32_16x16x32_bf16 v[116:119], v[180:183], v[172:175], v[116:119]
    v_mfma_f32_16x16x32_bf16 v[120:123], v[184:187], v[172:175], v[120:123]
    v_mfma_f32_16x16x32_bf16 v[124:127], v[188:191], v[172:175], v[124:127]
    s_lshl_b32 s53, s28, 8
    s_add_u32 s53, s53, 106496
    v_lshl_add_u32 v5, v30, 2, s53
    s_lshl_b32 s54, s29, 9
    s_add_u32 s54, s54, 107520
    v_and_b32 v6, 15, v1
    v_lshl_add_u32 v6, v6, 3, s54
    v_mov_b32 v8, 106496
    v_cmp_gt_u32 vcc, 16, v1
    s_barrier
    ds_read_b32 v192, v5 offset:0
    ds_read_b32 v196, v5 offset:32
    ds_read_b32 v200, v5 offset:128
    ds_read_b32 v204, v5 offset:160
    ds_read_b64 v[208:209], v6 offset:0
    ds_read_b64 v[212:213], v6 offset:128
    ds_read_b64 v[216:217], v6 offset:256
    ds_read_b64 v[220:221], v6 offset:384
    ds_read_b32 v8, v8 offset:2048
    ds_read_b32 v224, v5 offset:512
    ds_read_b32 v225, v5 offset:544
    ds_read_b32 v226, v5 offset:640
    ds_read_b32 v227, v5 offset:672
    s_waitcnt lgkmcnt(4)
    v_cndmask_b32 v192, 0, v192, vcc
    v_and_b32 v193, 0xffff, v192
    v_cndmask_b32 v196, 0, v196, vcc
    v_and_b32 v197, 0xffff, v196
    v_cndmask_b32 v200, 0, v200, vcc
    v_and_b32 v201, 0xffff, v200
    v_cndmask_b32 v204, 0, v204, vcc
    v_and_b32 v205, 0xffff, v204
    v_readfirstlane_b32 s3, v8
    v_mfma_f32_16x16x32_bf16 v[64:67], v[208:211], v[192:195], v[64:67]
    v_mfma_f32_16x16x32_bf16 v[68:71], v[212:215], v[192:195], v[68:71]
    v_mfma_f32_16x16x32_bf16 v[72:75], v[216:219], v[192:195], v[72:75]
    v_mfma_f32_16x16x32_bf16 v[76:79], v[220:223], v[192:195], v[76:79]
    v_mfma_f32_16x16x32_bf16 v[80:83], v[208:211], v[196:199], v[80:83]
    v_mfma_f32_16x16x32_bf16 v[84:87], v[212:215], v[196:199], v[84:87]
    s_waitcnt lgkmcnt(0)
    s_nop 1
    v_pk_mul_f32 v[64:65], v[64:65], v[224:225] op_sel:[0,0] op_sel_hi:[1,0]
    v_pk_mul_f32 v[66:67], v[66:67], v[224:225] op_sel:[0,0] op_sel_hi:[1,0]
    v_pk_mul_f32 v[68:69], v[68:69], v[224:225] op_sel:[0,0] op_sel_hi:[1,0]
    v_pk_mul_f32 v[70:71], v[70:71], v[224:225] op_sel:[0,0] op_sel_hi:[1,0]
    v_mfma_f32_16x16x32_bf16 v[88:91], v[216:219], v[196:199], v[88:91]
    v_cvt_pk_bf16_f32 v64, v64, v65
    v_cvt_pk_bf16_f32 v65, v66, v67
    v_mfma_f32_16x16x32_bf16 v[92:95], v[220:223], v[196:199], v[92:95]
    v_cvt_pk_bf16_f32 v66, v68, v69
    v_cvt_pk_bf16_f32 v67, v70, v71
    buffer_store_dwordx4 v[64:67], v28, s[20:23], s30 offen offset:0 sc1
    v_pk_mul_f32 v[72:73], v[72:73], v[224:225] op_sel:[0,0] op_sel_hi:[1,0]
    v_pk_mul_f32 v[74:75], v[74:75], v[224:225] op_sel:[0,0] op_sel_hi:[1,0]
    v_pk_mul_f32 v[76:77], v[76:77], v[224:225] op_sel:[0,0] op_sel_hi:[1,0]
    v_pk_mul_f32 v[78:79], v[78:79], v[224:225] op_sel:[0,0] op_sel_hi:[1,0]
    v_mfma_f32_16x16x32_bf16 v[96:99], v[208:211], v[200:203], v[96:99]
    v_cvt_pk_bf16_f32 v72, v72, v73
    v_cvt_pk_bf16_f32 v73, v74, v75
    v_mfma_f32_16x16x32_bf16 v[100:103], v[212:215], v[200:203], v[100:103]
    v_cvt_pk_bf16_f32 v74, v76, v77
    v_cvt_pk_bf16_f32 v75, v78, v79
    buffer_store_dwordx4 v[72:75], v29, s[20:23], s30 offen offset:0 sc1
    v_pk_mul_f32 v[80:81], v[80:81], v[224:225] op_sel:[0,1] op_sel_hi:[1,1]
    v_pk_mul_f32 v[82:83], v[82:83], v[224:225] op_sel:[0,1] op_sel_hi:[1,1]
    v_pk_mul_f32 v[84:85], v[84:85], v[224:225] op_sel:[0,1] op_sel_hi:[1,1]
    v_pk_mul_f32 v[86:87], v[86:87], v[224:225] op_sel:[0,1] op_sel_hi:[1,1]
    v_mfma_f32_16x16x32_bf16 v[104:107], v[216:219], v[200:203], v[104:107]
    v_cvt_pk_bf16_f32 v80, v80, v81
    v_cvt_pk_bf16_f32 v81, v82, v83
    v_mfma_f32_16x16x32_bf16 v[108:111], v[220:223], v[200:203], v[108:111]
    v_cvt_pk_bf16_f32 v82, v84, v85
    v_cvt_pk_bf16_f32 v83, v86, v87
    buffer_store_dwordx4 v[80:83], v28, s[20:23], s30 offen offset:128 sc1
    v_pk_mul_f32 v[88:89], v[88:89], v[224:225] op_sel:[0,1] op_sel_hi:[1,1]
    v_pk_mul_f32 v[90:91], v[90:91], v[224:225] op_sel:[0,1] op_sel_hi:[1,1]
    v_pk_mul_f32 v[92:93], v[92:93], v[224:225] op_sel:[0,1] op_sel_hi:[1,1]
    v_pk_mul_f32 v[94:95], v[94:95], v[224:225] op_sel:[0,1] op_sel_hi:[1,1]
    v_mfma_f32_16x16x32_bf16 v[112:115], v[208:211], v[204:207], v[112:115]
    v_cvt_pk_bf16_f32 v88, v88, v89
    v_cvt_pk_bf16_f32 v89, v90, v91
    v_mfma_f32_16x16x32_bf16 v[116:119], v[212:215], v[204:207], v[116:119]
    v_cvt_pk_bf16_f32 v90, v92, v93
    v_cvt_pk_bf16_f32 v91, v94, v95
    buffer_store_dwordx4 v[88:91], v29, s[20:23], s30 offen offset:128 sc1
    v_pk_mul_f32 v[96:97], v[96:97], v[226:227] op_sel:[0,0] op_sel_hi:[1,0]
    v_pk_mul_f32 v[98:99], v[98:99], v[226:227] op_sel:[0,0] op_sel_hi:[1,0]
    v_pk_mul_f32 v[100:101], v[100:101], v[226:227] op_sel:[0,0] op_sel_hi:[1,0]
    v_pk_mul_f32 v[102:103], v[102:103], v[226:227] op_sel:[0,0] op_sel_hi:[1,0]
    v_mfma_f32_16x16x32_bf16 v[120:123], v[216:219], v[204:207], v[120:123]
    v_cvt_pk_bf16_f32 v96, v96, v97
    v_cvt_pk_bf16_f32 v97, v98, v99
    v_mfma_f32_16x16x32_bf16 v[124:127], v[220:223], v[204:207], v[124:127]
    v_cvt_pk_bf16_f32 v98, v100, v101
    v_cvt_pk_bf16_f32 v99, v102, v103
    buffer_store_dwordx4 v[96:99], v28, s[20:23], s30 offen offset:512 sc1
    v_pk_mul_f32 v[104:105], v[104:105], v[226:227] op_sel:[0,0] op_sel_hi:[1,0]
    v_pk_mul_f32 v[106:107], v[106:107], v[226:227] op_sel:[0,0] op_sel_hi:[1,0]
    v_pk_mul_f32 v[108:109], v[108:109], v[226:227] op_sel:[0,0] op_sel_hi:[1,0]
    v_pk_mul_f32 v[110:111], v[110:111], v[226:227] op_sel:[0,0] op_sel_hi:[1,0]
    v_cvt_pk_bf16_f32 v104, v104, v105
    v_cvt_pk_bf16_f32 v105, v106, v107
    v_cvt_pk_bf16_f32 v106, v108, v109
    v_cvt_pk_bf16_f32 v107, v110, v111
    buffer_store_dwordx4 v[104:107], v29, s[20:23], s30 offen offset:512 sc1
    v_pk_mul_f32 v[112:113], v[112:113], v[226:227] op_sel:[0,1] op_sel_hi:[1,1]
    v_pk_mul_f32 v[114:115], v[114:115], v[226:227] op_sel:[0,1] op_sel_hi:[1,1]
    v_pk_mul_f32 v[116:117], v[116:117], v[226:227] op_sel:[0,1] op_sel_hi:[1,1]
    v_pk_mul_f32 v[118:119], v[118:119], v[226:227] op_sel:[0,1] op_sel_hi:[1,1]
    v_cvt_pk_bf16_f32 v112, v112, v113
    v_cvt_pk_bf16_f32 v113, v114, v115
    v_cvt_pk_bf16_f32 v114, v116, v117
    v_cvt_pk_bf16_f32 v115, v118, v119
    buffer_store_dwordx4 v[112:115], v28, s[20:23], s30 offen offset:640 sc1
    v_pk_mul_f32 v[120:121], v[120:121], v[226:227] op_sel:[0,1] op_sel_hi:[1,1]
    v_pk_mul_f32 v[122:123], v[122:123], v[226:227] op_sel:[0,1] op_sel_hi:[1,1]
    v_pk_mul_f32 v[124:125], v[124:125], v[226:227] op_sel:[0,1] op_sel_hi:[1,1]
    v_pk_mul_f32 v[126:127], v[126:127], v[226:227] op_sel:[0,1] op_sel_hi:[1,1]
    v_cvt_pk_bf16_f32 v120, v120, v121
    v_cvt_pk_bf16_f32 v121, v122, v123
    v_cvt_pk_bf16_f32 v122, v124, v125
    v_cvt_pk_bf16_f32 v123, v126, v127
    buffer_store_dwordx4 v[120:123], v29, s[20:23], s30 offen offset:640 sc1
    s_branch mega_kernel_a_pub
mega_kernel_vpath:
    s_mul_i32 s30, s52, 40960
    s_add_u32 s30, s30, 5242880
    s_sub_u32 s53, s25, 10
    s_lshl_b32 s53, s53, 11
    s_lshl_b32 s54, s29, 10
    s_add_u32 s53, s53, s54
    s_add_u32 s30, s30, s53
    s_add_u32 s31, s30, 40960
    v_mul_u32_u24 v5, 10240, v31
    v_and_b32 v6, 15, v1
    v_lshl_add_u32 v28, v6, 4, v5
    s_barrier
    ds_read_b128 v[128:131], v16 offset:0
    ds_read_b64_tr_b16 v[144:145], v20 offset:16384
    ds_read_b64_tr_b16 v[146:147], v20 offset:17408
    ds_read_b64_tr_b16 v[148:149], v21 offset:16384
    ds_read_b64_tr_b16 v[150:151], v21 offset:17408
    ds_read_b128 v[132:135], v16 offset:1024
    ds_read_b64_tr_b16 v[152:153], v22 offset:16384
    ds_read_b64_tr_b16 v[154:155], v22 offset:17408
    ds_read_b64_tr_b16 v[156:157], v23 offset:16384
    ds_read_b64_tr_b16 v[158:159], v23 offset:17408
    ds_read_b128 v[136:139], v16 offset:4096
    ds_read_b128 v[140:143], v16 offset:5120
    s_waitcnt lgkmcnt(0)
    v_mfma_f32_16x16x32_bf16 v[64:67], v[128:131], v[144:147], 0
    s_nop 9
    ds_read_b128 v[160:163], v17 offset:0
    ds_read_b64_tr_b16 v[176:177], v20 offset:24576
    v_mfma_f32_16x16x32_bf16 v[80:83], v[128:131], v[148:151], 0
    s_nop 9
    ds_read_b64_tr_b16 v[178:179], v20 offset:25600
    v_mfma_f32_16x16x32_bf16 v[84:87], v[132:135], v[148:151], 0
    s_nop 9
    ds_read_b64_tr_b16 v[180:181], v21 offset:24576
    ds_read_b64_tr_b16 v[182:183], v21 offset:25600
    v_mfma_f32_16x16x32_bf16 v[68:71], v[132:135], v[144:147], 0
    s_nop 9
    ds_read_b128 v[164:167], v17 offset:1024
    v_mfma_f32_16x16x32_bf16 v[100:103], v[132:135], v[152:155], 0
    s_nop 9
    ds_read_b64_tr_b16 v[184:185], v22 offset:24576
    ds_read_b64_tr_b16 v[186:187], v22 offset:25600
    v_mfma_f32_16x16x32_bf16 v[96:99], v[128:131], v[152:155], 0
    s_nop 9
    ds_read_b64_tr_b16 v[188:189], v23 offset:24576
    v_mfma_f32_16x16x32_bf16 v[112:115], v[128:131], v[156:159], 0
    s_nop 9
    ds_read_b64_tr_b16 v[190:191], v23 offset:25600
    ds_read_b128 v[168:171], v17 offset:4096
    v_mfma_f32_16x16x32_bf16 v[116:119], v[132:135], v[156:159], 0
    s_nop 9
    ds_read_b128 v[172:175], v17 offset:5120
    v_mfma_f32_16x16x32_bf16 v[120:123], v[136:139], v[156:159], 0
    s_nop 9
    v_mfma_f32_16x16x32_bf16 v[104:107], v[136:139], v[152:155], 0
    s_nop 9
    v_mfma_f32_16x16x32_bf16 v[88:91], v[136:139], v[148:151], 0
    s_nop 9
    v_mfma_f32_16x16x32_bf16 v[72:75], v[136:139], v[144:147], 0
    s_nop 9
    v_mfma_f32_16x16x32_bf16 v[76:79], v[140:143], v[144:147], 0
    s_nop 9
    v_mfma_f32_16x16x32_bf16 v[92:95], v[140:143], v[148:151], 0
    s_nop 9
    v_mfma_f32_16x16x32_bf16 v[108:111], v[140:143], v[152:155], 0
    s_nop 9
    v_mfma_f32_16x16x32_bf16 v[124:127], v[140:143], v[156:159], 0
    s_nop 9
    s_waitcnt lgkmcnt(0)
    s_barrier
    v_mfma_f32_16x16x32_bf16 v[64:67], v[160:163], v[176:179], v[64:67]
    s_nop 9
    ds_read_b128 v[128:131], v16 offset:32768
    ds_read_b64_tr_b16 v[144:145], v20 offset:49152
    v_mfma_f32_16x16x32_bf16 v[80:83], v[160:163], v[180:183], v[80:83]
    s_nop 9
    ds_read_b64_tr_b16 v[146:147], v20 offset:50176
    v_mfma_f32_16x16x32_bf16 v[84:87], v[164:167], v[180:183], v[84:87]
    s_nop 9
    ds_read_b64_tr_b16 v[148:149], v21 offset:49152
    ds_read_b64_tr_b16 v[150:151], v21 offset:50176
    v_mfma_f32_16x16x32_bf16 v[68:71], v[164:167], v[176:179], v[68:71]
    s_nop 9
    ds_read_b128 v[132:135], v16 offset:33792
    v_mfma_f32_16x16x32_bf16 v[100:103], v[164:167], v[184:187], v[100:103]
    s_nop 9
    ds_read_b64_tr_b16 v[152:153], v22 offset:49152
    ds_read_b64_tr_b16 v[154:155], v22 offset:50176
    v_mfma_f32_16x16x32_bf16 v[96:99], v[160:163], v[184:187], v[96:99]
    s_nop 9
    ds_read_b64_tr_b16 v[156:157], v23 offset:49152
    v_mfma_f32_16x16x32_bf16 v[112:115], v[160:163], v[188:191], v[112:115]
    s_nop 9
    ds_read_b64_tr_b16 v[158:159], v23 offset:50176
    ds_read_b128 v[136:139], v16 offset:36864
    v_mfma_f32_16x16x32_bf16 v[116:119], v[164:167], v[188:191], v[116:119]
    s_nop 9
    ds_read_b128 v[140:143], v16 offset:37888
    v_mfma_f32_16x16x32_bf16 v[120:123], v[168:171], v[188:191], v[120:123]
    s_nop 9
    v_mfma_f32_16x16x32_bf16 v[104:107], v[168:171], v[184:187], v[104:107]
    s_nop 9
    v_mfma_f32_16x16x32_bf16 v[88:91], v[168:171], v[180:183], v[88:91]
    s_nop 9
    v_mfma_f32_16x16x32_bf16 v[72:75], v[168:171], v[176:179], v[72:75]
    s_nop 9
    v_mfma_f32_16x16x32_bf16 v[76:79], v[172:175], v[176:179], v[76:79]
    s_nop 9
    v_mfma_f32_16x16x32_bf16 v[92:95], v[172:175], v[180:183], v[92:95]
    s_nop 9
    v_mfma_f32_16x16x32_bf16 v[108:111], v[172:175], v[184:187], v[108:111]
    s_nop 9
    v_mfma_f32_16x16x32_bf16 v[124:127], v[172:175], v[188:191], v[124:127]
    s_nop 9
    s_waitcnt lgkmcnt(0)
    v_mfma_f32_16x16x32_bf16 v[64:67], v[128:131], v[144:147], v[64:67]
    s_nop 5
    ds_read_b128 v[160:163], v17 offset:32768
    ds_read_b64_tr_b16 v[176:177], v20 offset:57344
    v_mfma_f32_16x16x32_bf16 v[80:83], v[128:131], v[148:151], v[80:83]
    s_nop 5
    ds_read_b64_tr_b16 v[178:179], v20 offset:58368
    v_mfma_f32_16x16x32_bf16 v[84:87], v[132:135], v[148:151], v[84:87]
    s_nop 5
    ds_read_b64_tr_b16 v[180:181], v21 offset:57344
    ds_read_b64_tr_b16 v[182:183], v21 offset:58368
    v_mfma_f32_16x16x32_bf16 v[68:71], v[132:135], v[144:147], v[68:71]
    s_nop 5
    ds_read_b128 v[164:167], v17 offset:33792
    v_mfma_f32_16x16x32_bf16 v[100:103], v[132:135], v[152:155], v[100:103]
    s_nop 5
    ds_read_b64_tr_b16 v[184:185], v22 offset:57344
    ds_read_b64_tr_b16 v[186:187], v22 offset:58368
    v_mfma_f32_16x16x32_bf16 v[96:99], v[128:131], v[152:155], v[96:99]
    s_nop 5
    ds_read_b64_tr_b16 v[188:189], v23 offset:57344
    v_mfma_f32_16x16x32_bf16 v[112:115], v[128:131], v[156:159], v[112:115]
    s_nop 5
    ds_read_b64_tr_b16 v[190:191], v23 offset:58368
    ds_read_b128 v[168:171], v17 offset:36864
    v_mfma_f32_16x16x32_bf16 v[116:119], v[132:135], v[156:159], v[116:119]
    s_nop 5
    ds_read_b128 v[172:175], v17 offset:37888
    v_mfma_f32_16x16x32_bf16 v[120:123], v[136:139], v[156:159], v[120:123]
    s_nop 5
    v_mfma_f32_16x16x32_bf16 v[104:107], v[136:139], v[152:155], v[104:107]
    s_nop 5
    v_mfma_f32_16x16x32_bf16 v[88:91], v[136:139], v[148:151], v[88:91]
    s_nop 5
    v_mfma_f32_16x16x32_bf16 v[72:75], v[136:139], v[144:147], v[72:75]
    s_nop 5
    v_mfma_f32_16x16x32_bf16 v[76:79], v[140:143], v[144:147], v[76:79]
    s_nop 5
    v_mfma_f32_16x16x32_bf16 v[92:95], v[140:143], v[148:151], v[92:95]
    s_nop 5
    v_mfma_f32_16x16x32_bf16 v[108:111], v[140:143], v[152:155], v[108:111]
    s_nop 5
    v_mfma_f32_16x16x32_bf16 v[124:127], v[140:143], v[156:159], v[124:127]
    s_nop 5
    s_waitcnt lgkmcnt(0)
    s_barrier
    v_mfma_f32_16x16x32_bf16 v[64:67], v[160:163], v[176:179], v[64:67]
    s_nop 5
    ds_read_b128 v[128:131], v18 offset:0
    ds_read_b64_tr_b16 v[144:145], v24 offset:16384
    v_mfma_f32_16x16x32_bf16 v[80:83], v[160:163], v[180:183], v[80:83]
    s_nop 5
    ds_read_b64_tr_b16 v[146:147], v24 offset:17408
    v_mfma_f32_16x16x32_bf16 v[84:87], v[164:167], v[180:183], v[84:87]
    s_nop 5
    ds_read_b64_tr_b16 v[148:149], v25 offset:16384
    ds_read_b64_tr_b16 v[150:151], v25 offset:17408
    v_mfma_f32_16x16x32_bf16 v[68:71], v[164:167], v[176:179], v[68:71]
    s_nop 5
    ds_read_b128 v[132:135], v18 offset:1024
    v_mfma_f32_16x16x32_bf16 v[100:103], v[164:167], v[184:187], v[100:103]
    s_nop 5
    ds_read_b64_tr_b16 v[152:153], v26 offset:16384
    ds_read_b64_tr_b16 v[154:155], v26 offset:17408
    v_mfma_f32_16x16x32_bf16 v[96:99], v[160:163], v[184:187], v[96:99]
    s_nop 5
    ds_read_b64_tr_b16 v[156:157], v27 offset:16384
    v_mfma_f32_16x16x32_bf16 v[112:115], v[160:163], v[188:191], v[112:115]
    s_nop 5
    ds_read_b64_tr_b16 v[158:159], v27 offset:17408
    ds_read_b128 v[136:139], v18 offset:4096
    v_mfma_f32_16x16x32_bf16 v[116:119], v[164:167], v[188:191], v[116:119]
    s_nop 5
    ds_read_b128 v[140:143], v18 offset:5120
    v_mfma_f32_16x16x32_bf16 v[120:123], v[168:171], v[188:191], v[120:123]
    s_nop 5
    v_mfma_f32_16x16x32_bf16 v[104:107], v[168:171], v[184:187], v[104:107]
    s_nop 5
    v_mfma_f32_16x16x32_bf16 v[88:91], v[168:171], v[180:183], v[88:91]
    s_nop 5
    v_mfma_f32_16x16x32_bf16 v[72:75], v[168:171], v[176:179], v[72:75]
    s_nop 5
    v_mfma_f32_16x16x32_bf16 v[76:79], v[172:175], v[176:179], v[76:79]
    s_nop 5
    v_mfma_f32_16x16x32_bf16 v[92:95], v[172:175], v[180:183], v[92:95]
    s_nop 5
    v_mfma_f32_16x16x32_bf16 v[108:111], v[172:175], v[184:187], v[108:111]
    s_nop 5
    v_mfma_f32_16x16x32_bf16 v[124:127], v[172:175], v[188:191], v[124:127]
    s_nop 5
    s_waitcnt lgkmcnt(0)
    v_mfma_f32_16x16x32_bf16 v[64:67], v[128:131], v[144:147], v[64:67]
    s_nop 2
    ds_read_b128 v[160:163], v19 offset:0
    ds_read_b64_tr_b16 v[176:177], v24 offset:24576
    v_mfma_f32_16x16x32_bf16 v[80:83], v[128:131], v[148:151], v[80:83]
    s_nop 2
    ds_read_b64_tr_b16 v[178:179], v24 offset:25600
    v_mfma_f32_16x16x32_bf16 v[84:87], v[132:135], v[148:151], v[84:87]
    s_nop 2
    ds_read_b64_tr_b16 v[180:181], v25 offset:24576
    ds_read_b64_tr_b16 v[182:183], v25 offset:25600
    v_mfma_f32_16x16x32_bf16 v[68:71], v[132:135], v[144:147], v[68:71]
    s_nop 2
    ds_read_b128 v[164:167], v19 offset:1024
    v_mfma_f32_16x16x32_bf16 v[100:103], v[132:135], v[152:155], v[100:103]
    s_nop 2
    ds_read_b64_tr_b16 v[184:185], v26 offset:24576
    ds_read_b64_tr_b16 v[186:187], v26 offset:25600
    v_mfma_f32_16x16x32_bf16 v[96:99], v[128:131], v[152:155], v[96:99]
    s_nop 2
    ds_read_b64_tr_b16 v[188:189], v27 offset:24576
    v_mfma_f32_16x16x32_bf16 v[112:115], v[128:131], v[156:159], v[112:115]
    s_nop 2
    ds_read_b64_tr_b16 v[190:191], v27 offset:25600
    ds_read_b128 v[168:171], v19 offset:4096
    v_mfma_f32_16x16x32_bf16 v[116:119], v[132:135], v[156:159], v[116:119]
    s_nop 2
    ds_read_b128 v[172:175], v19 offset:5120
    v_mfma_f32_16x16x32_bf16 v[120:123], v[136:139], v[156:159], v[120:123]
    s_nop 2
    v_mfma_f32_16x16x32_bf16 v[104:107], v[136:139], v[152:155], v[104:107]
    s_nop 2
    v_mfma_f32_16x16x32_bf16 v[88:91], v[136:139], v[148:151], v[88:91]
    s_nop 2
    v_mfma_f32_16x16x32_bf16 v[72:75], v[136:139], v[144:147], v[72:75]
    s_nop 2
    v_mfma_f32_16x16x32_bf16 v[76:79], v[140:143], v[144:147], v[76:79]
    s_nop 2
    v_mfma_f32_16x16x32_bf16 v[92:95], v[140:143], v[148:151], v[92:95]
    s_nop 2
    v_mfma_f32_16x16x32_bf16 v[108:111], v[140:143], v[152:155], v[108:111]
    s_nop 2
    v_mfma_f32_16x16x32_bf16 v[124:127], v[140:143], v[156:159], v[124:127]
    s_nop 2
    s_waitcnt lgkmcnt(0)
    s_barrier
    v_mfma_f32_16x16x32_bf16 v[64:67], v[160:163], v[176:179], v[64:67]
    s_nop 2
    ds_read_b128 v[128:131], v18 offset:32768
    ds_read_b64_tr_b16 v[144:145], v24 offset:49152
    v_mfma_f32_16x16x32_bf16 v[80:83], v[160:163], v[180:183], v[80:83]
    s_nop 2
    ds_read_b64_tr_b16 v[146:147], v24 offset:50176
    v_mfma_f32_16x16x32_bf16 v[84:87], v[164:167], v[180:183], v[84:87]
    s_nop 2
    ds_read_b64_tr_b16 v[148:149], v25 offset:49152
    ds_read_b64_tr_b16 v[150:151], v25 offset:50176
    v_mfma_f32_16x16x32_bf16 v[68:71], v[164:167], v[176:179], v[68:71]
    s_nop 2
    ds_read_b128 v[132:135], v18 offset:33792
    v_mfma_f32_16x16x32_bf16 v[100:103], v[164:167], v[184:187], v[100:103]
    s_nop 2
    ds_read_b64_tr_b16 v[152:153], v26 offset:49152
    ds_read_b64_tr_b16 v[154:155], v26 offset:50176
    v_mfma_f32_16x16x32_bf16 v[96:99], v[160:163], v[184:187], v[96:99]
    s_nop 2
    ds_read_b64_tr_b16 v[156:157], v27 offset:49152
    v_mfma_f32_16x16x32_bf16 v[112:115], v[160:163], v[188:191], v[112:115]
    s_nop 2
    ds_read_b64_tr_b16 v[158:159], v27 offset:50176
    ds_read_b128 v[136:139], v18 offset:36864
    v_mfma_f32_16x16x32_bf16 v[116:119], v[164:167], v[188:191], v[116:119]
    s_nop 2
    ds_read_b128 v[140:143], v18 offset:37888
    v_mfma_f32_16x16x32_bf16 v[120:123], v[168:171], v[188:191], v[120:123]
    s_nop 2
    v_mfma_f32_16x16x32_bf16 v[104:107], v[168:171], v[184:187], v[104:107]
    s_nop 2
    v_mfma_f32_16x16x32_bf16 v[88:91], v[168:171], v[180:183], v[88:91]
    s_nop 2
    v_mfma_f32_16x16x32_bf16 v[72:75], v[168:171], v[176:179], v[72:75]
    s_nop 2
    v_mfma_f32_16x16x32_bf16 v[76:79], v[172:175], v[176:179], v[76:79]
    s_nop 2
    v_mfma_f32_16x16x32_bf16 v[92:95], v[172:175], v[180:183], v[92:95]
    s_nop 2
    v_mfma_f32_16x16x32_bf16 v[108:111], v[172:175], v[184:187], v[108:111]
    s_nop 2
    v_mfma_f32_16x16x32_bf16 v[124:127], v[172:175], v[188:191], v[124:127]
    s_nop 2
    s_waitcnt lgkmcnt(0)
    v_mfma_f32_16x16x32_bf16 v[64:67], v[128:131], v[144:147], v[64:67]
    ds_read_b128 v[160:163], v19 offset:32768
    ds_read_b64_tr_b16 v[176:177], v24 offset:57344
    v_mfma_f32_16x16x32_bf16 v[80:83], v[128:131], v[148:151], v[80:83]
    ds_read_b64_tr_b16 v[178:179], v24 offset:58368
    v_mfma_f32_16x16x32_bf16 v[84:87], v[132:135], v[148:151], v[84:87]
    ds_read_b64_tr_b16 v[180:181], v25 offset:57344
    ds_read_b64_tr_b16 v[182:183], v25 offset:58368
    v_mfma_f32_16x16x32_bf16 v[68:71], v[132:135], v[144:147], v[68:71]
    ds_read_b128 v[164:167], v19 offset:33792
    v_mfma_f32_16x16x32_bf16 v[100:103], v[132:135], v[152:155], v[100:103]
    ds_read_b64_tr_b16 v[184:185], v26 offset:57344
    ds_read_b64_tr_b16 v[186:187], v26 offset:58368
    v_mfma_f32_16x16x32_bf16 v[96:99], v[128:131], v[152:155], v[96:99]
    ds_read_b64_tr_b16 v[188:189], v27 offset:57344
    v_mfma_f32_16x16x32_bf16 v[112:115], v[128:131], v[156:159], v[112:115]
    ds_read_b64_tr_b16 v[190:191], v27 offset:58368
    ds_read_b128 v[168:171], v19 offset:36864
    v_mfma_f32_16x16x32_bf16 v[116:119], v[132:135], v[156:159], v[116:119]
    ds_read_b128 v[172:175], v19 offset:37888
    v_mfma_f32_16x16x32_bf16 v[120:123], v[136:139], v[156:159], v[120:123]
    v_mfma_f32_16x16x32_bf16 v[104:107], v[136:139], v[152:155], v[104:107]
    v_mfma_f32_16x16x32_bf16 v[88:91], v[136:139], v[148:151], v[88:91]
    v_mfma_f32_16x16x32_bf16 v[72:75], v[136:139], v[144:147], v[72:75]
    v_mfma_f32_16x16x32_bf16 v[76:79], v[140:143], v[144:147], v[76:79]
    v_mfma_f32_16x16x32_bf16 v[92:95], v[140:143], v[148:151], v[92:95]
    v_mfma_f32_16x16x32_bf16 v[108:111], v[140:143], v[152:155], v[108:111]
    v_mfma_f32_16x16x32_bf16 v[124:127], v[140:143], v[156:159], v[124:127]
    s_waitcnt lgkmcnt(0)
    s_barrier
    v_mfma_f32_16x16x32_bf16 v[64:67], v[160:163], v[176:179], v[64:67]
    ds_read_b128 v[128:131], v16 offset:0
    ds_read_b64_tr_b16 v[144:145], v20 offset:16384
    v_mfma_f32_16x16x32_bf16 v[80:83], v[160:163], v[180:183], v[80:83]
    ds_read_b64_tr_b16 v[146:147], v20 offset:17408
    v_mfma_f32_16x16x32_bf16 v[84:87], v[164:167], v[180:183], v[84:87]
    ds_read_b64_tr_b16 v[148:149], v21 offset:16384
    ds_read_b64_tr_b16 v[150:151], v21 offset:17408
    v_mfma_f32_16x16x32_bf16 v[68:71], v[164:167], v[176:179], v[68:71]
    ds_read_b128 v[132:135], v16 offset:1024
    v_mfma_f32_16x16x32_bf16 v[100:103], v[164:167], v[184:187], v[100:103]
    ds_read_b64_tr_b16 v[152:153], v22 offset:16384
    ds_read_b64_tr_b16 v[154:155], v22 offset:17408
    v_mfma_f32_16x16x32_bf16 v[96:99], v[160:163], v[184:187], v[96:99]
    ds_read_b64_tr_b16 v[156:157], v23 offset:16384
    v_mfma_f32_16x16x32_bf16 v[112:115], v[160:163], v[188:191], v[112:115]
    ds_read_b64_tr_b16 v[158:159], v23 offset:17408
    ds_read_b128 v[136:139], v16 offset:4096
    v_mfma_f32_16x16x32_bf16 v[116:119], v[164:167], v[188:191], v[116:119]
    ds_read_b128 v[140:143], v16 offset:5120
    v_mfma_f32_16x16x32_bf16 v[120:123], v[168:171], v[188:191], v[120:123]
    v_mfma_f32_16x16x32_bf16 v[104:107], v[168:171], v[184:187], v[104:107]
    v_mfma_f32_16x16x32_bf16 v[88:91], v[168:171], v[180:183], v[88:91]
    v_mfma_f32_16x16x32_bf16 v[72:75], v[168:171], v[176:179], v[72:75]
    v_mfma_f32_16x16x32_bf16 v[76:79], v[172:175], v[176:179], v[76:79]
    v_mfma_f32_16x16x32_bf16 v[92:95], v[172:175], v[180:183], v[92:95]
    v_mfma_f32_16x16x32_bf16 v[108:111], v[172:175], v[184:187], v[108:111]
    v_mfma_f32_16x16x32_bf16 v[124:127], v[172:175], v[188:191], v[124:127]
    s_waitcnt lgkmcnt(0)
    v_mfma_f32_16x16x32_bf16 v[64:67], v[128:131], v[144:147], v[64:67]
    ds_read_b128 v[160:163], v17 offset:0
    ds_read_b64_tr_b16 v[176:177], v20 offset:24576
    v_mfma_f32_16x16x32_bf16 v[80:83], v[128:131], v[148:151], v[80:83]
    ds_read_b64_tr_b16 v[178:179], v20 offset:25600
    v_mfma_f32_16x16x32_bf16 v[84:87], v[132:135], v[148:151], v[84:87]
    ds_read_b64_tr_b16 v[180:181], v21 offset:24576
    ds_read_b64_tr_b16 v[182:183], v21 offset:25600
    v_mfma_f32_16x16x32_bf16 v[68:71], v[132:135], v[144:147], v[68:71]
    ds_read_b128 v[164:167], v17 offset:1024
    v_mfma_f32_16x16x32_bf16 v[100:103], v[132:135], v[152:155], v[100:103]
    ds_read_b64_tr_b16 v[184:185], v22 offset:24576
    ds_read_b64_tr_b16 v[186:187], v22 offset:25600
    v_mfma_f32_16x16x32_bf16 v[96:99], v[128:131], v[152:155], v[96:99]
    ds_read_b64_tr_b16 v[188:189], v23 offset:24576
    v_mfma_f32_16x16x32_bf16 v[112:115], v[128:131], v[156:159], v[112:115]
    ds_read_b64_tr_b16 v[190:191], v23 offset:25600
    ds_read_b128 v[168:171], v17 offset:4096
    v_mfma_f32_16x16x32_bf16 v[116:119], v[132:135], v[156:159], v[116:119]
    ds_read_b128 v[172:175], v17 offset:5120
    v_mfma_f32_16x16x32_bf16 v[120:123], v[136:139], v[156:159], v[120:123]
    v_mfma_f32_16x16x32_bf16 v[104:107], v[136:139], v[152:155], v[104:107]
    v_mfma_f32_16x16x32_bf16 v[88:91], v[136:139], v[148:151], v[88:91]
    v_mfma_f32_16x16x32_bf16 v[72:75], v[136:139], v[144:147], v[72:75]
    v_mfma_f32_16x16x32_bf16 v[76:79], v[140:143], v[144:147], v[76:79]
    v_mfma_f32_16x16x32_bf16 v[92:95], v[140:143], v[148:151], v[92:95]
    v_mfma_f32_16x16x32_bf16 v[108:111], v[140:143], v[152:155], v[108:111]
    v_mfma_f32_16x16x32_bf16 v[124:127], v[140:143], v[156:159], v[124:127]
    s_waitcnt lgkmcnt(0)
    s_barrier
    v_mfma_f32_16x16x32_bf16 v[64:67], v[160:163], v[176:179], v[64:67]
    ds_read_b128 v[128:131], v16 offset:32768
    ds_read_b64_tr_b16 v[144:145], v20 offset:49152
    v_mfma_f32_16x16x32_bf16 v[80:83], v[160:163], v[180:183], v[80:83]
    ds_read_b64_tr_b16 v[146:147], v20 offset:50176
    v_mfma_f32_16x16x32_bf16 v[84:87], v[164:167], v[180:183], v[84:87]
    ds_read_b64_tr_b16 v[148:149], v21 offset:49152
    ds_read_b64_tr_b16 v[150:151], v21 offset:50176
    v_mfma_f32_16x16x32_bf16 v[68:71], v[164:167], v[176:179], v[68:71]
    ds_read_b128 v[132:135], v16 offset:33792
    v_mfma_f32_16x16x32_bf16 v[100:103], v[164:167], v[184:187], v[100:103]
    ds_read_b64_tr_b16 v[152:153], v22 offset:49152
    ds_read_b64_tr_b16 v[154:155], v22 offset:50176
    v_mfma_f32_16x16x32_bf16 v[96:99], v[160:163], v[184:187], v[96:99]
    ds_read_b64_tr_b16 v[156:157], v23 offset:49152
    v_mfma_f32_16x16x32_bf16 v[112:115], v[160:163], v[188:191], v[112:115]
    ds_read_b64_tr_b16 v[158:159], v23 offset:50176
    ds_read_b128 v[136:139], v16 offset:36864
    v_mfma_f32_16x16x32_bf16 v[116:119], v[164:167], v[188:191], v[116:119]
    ds_read_b128 v[140:143], v16 offset:37888
    v_mfma_f32_16x16x32_bf16 v[120:123], v[168:171], v[188:191], v[120:123]
    v_mfma_f32_16x16x32_bf16 v[104:107], v[168:171], v[184:187], v[104:107]
    v_mfma_f32_16x16x32_bf16 v[88:91], v[168:171], v[180:183], v[88:91]
    v_mfma_f32_16x16x32_bf16 v[72:75], v[168:171], v[176:179], v[72:75]
    v_mfma_f32_16x16x32_bf16 v[76:79], v[172:175], v[176:179], v[76:79]
    v_mfma_f32_16x16x32_bf16 v[92:95], v[172:175], v[180:183], v[92:95]
    v_mfma_f32_16x16x32_bf16 v[108:111], v[172:175], v[184:187], v[108:111]
    v_mfma_f32_16x16x32_bf16 v[124:127], v[172:175], v[188:191], v[124:127]
    s_waitcnt lgkmcnt(0)
    v_mfma_f32_16x16x32_bf16 v[64:67], v[128:131], v[144:147], v[64:67]
    ds_read_b128 v[160:163], v17 offset:32768
    ds_read_b64_tr_b16 v[176:177], v20 offset:57344
    v_mfma_f32_16x16x32_bf16 v[80:83], v[128:131], v[148:151], v[80:83]
    ds_read_b64_tr_b16 v[178:179], v20 offset:58368
    v_mfma_f32_16x16x32_bf16 v[84:87], v[132:135], v[148:151], v[84:87]
    ds_read_b64_tr_b16 v[180:181], v21 offset:57344
    ds_read_b64_tr_b16 v[182:183], v21 offset:58368
    v_mfma_f32_16x16x32_bf16 v[68:71], v[132:135], v[144:147], v[68:71]
    ds_read_b128 v[164:167], v17 offset:33792
    v_mfma_f32_16x16x32_bf16 v[100:103], v[132:135], v[152:155], v[100:103]
    ds_read_b64_tr_b16 v[184:185], v22 offset:57344
    ds_read_b64_tr_b16 v[186:187], v22 offset:58368
    v_mfma_f32_16x16x32_bf16 v[96:99], v[128:131], v[152:155], v[96:99]
    ds_read_b64_tr_b16 v[188:189], v23 offset:57344
    v_mfma_f32_16x16x32_bf16 v[112:115], v[128:131], v[156:159], v[112:115]
    ds_read_b64_tr_b16 v[190:191], v23 offset:58368
    ds_read_b128 v[168:171], v17 offset:36864
    v_mfma_f32_16x16x32_bf16 v[116:119], v[132:135], v[156:159], v[116:119]
    ds_read_b128 v[172:175], v17 offset:37888
    v_mfma_f32_16x16x32_bf16 v[120:123], v[136:139], v[156:159], v[120:123]
    v_mfma_f32_16x16x32_bf16 v[104:107], v[136:139], v[152:155], v[104:107]
    v_mfma_f32_16x16x32_bf16 v[88:91], v[136:139], v[148:151], v[88:91]
    v_mfma_f32_16x16x32_bf16 v[72:75], v[136:139], v[144:147], v[72:75]
    v_mfma_f32_16x16x32_bf16 v[76:79], v[140:143], v[144:147], v[76:79]
    v_mfma_f32_16x16x32_bf16 v[92:95], v[140:143], v[148:151], v[92:95]
    v_mfma_f32_16x16x32_bf16 v[108:111], v[140:143], v[152:155], v[108:111]
    v_mfma_f32_16x16x32_bf16 v[124:127], v[140:143], v[156:159], v[124:127]
    s_waitcnt lgkmcnt(0)
    s_barrier
    v_mfma_f32_16x16x32_bf16 v[64:67], v[160:163], v[176:179], v[64:67]
    ds_read_b128 v[128:131], v18 offset:0
    ds_read_b64_tr_b16 v[144:145], v24 offset:16384
    v_mfma_f32_16x16x32_bf16 v[80:83], v[160:163], v[180:183], v[80:83]
    ds_read_b64_tr_b16 v[146:147], v24 offset:17408
    v_mfma_f32_16x16x32_bf16 v[84:87], v[164:167], v[180:183], v[84:87]
    ds_read_b64_tr_b16 v[148:149], v25 offset:16384
    ds_read_b64_tr_b16 v[150:151], v25 offset:17408
    v_mfma_f32_16x16x32_bf16 v[68:71], v[164:167], v[176:179], v[68:71]
    ds_read_b128 v[132:135], v18 offset:1024
    v_mfma_f32_16x16x32_bf16 v[100:103], v[164:167], v[184:187], v[100:103]
    ds_read_b64_tr_b16 v[152:153], v26 offset:16384
    ds_read_b64_tr_b16 v[154:155], v26 offset:17408
    v_mfma_f32_16x16x32_bf16 v[96:99], v[160:163], v[184:187], v[96:99]
    ds_read_b64_tr_b16 v[156:157], v27 offset:16384
    v_mfma_f32_16x16x32_bf16 v[112:115], v[160:163], v[188:191], v[112:115]
    ds_read_b64_tr_b16 v[158:159], v27 offset:17408
    ds_read_b128 v[136:139], v18 offset:4096
    v_mfma_f32_16x16x32_bf16 v[116:119], v[164:167], v[188:191], v[116:119]
    ds_read_b128 v[140:143], v18 offset:5120
    v_mfma_f32_16x16x32_bf16 v[120:123], v[168:171], v[188:191], v[120:123]
    v_mfma_f32_16x16x32_bf16 v[104:107], v[168:171], v[184:187], v[104:107]
    v_mfma_f32_16x16x32_bf16 v[88:91], v[168:171], v[180:183], v[88:91]
    v_mfma_f32_16x16x32_bf16 v[72:75], v[168:171], v[176:179], v[72:75]
    v_mfma_f32_16x16x32_bf16 v[76:79], v[172:175], v[176:179], v[76:79]
    v_mfma_f32_16x16x32_bf16 v[92:95], v[172:175], v[180:183], v[92:95]
    v_mfma_f32_16x16x32_bf16 v[108:111], v[172:175], v[184:187], v[108:111]
    v_mfma_f32_16x16x32_bf16 v[124:127], v[172:175], v[188:191], v[124:127]
    s_waitcnt lgkmcnt(0)
    v_mfma_f32_16x16x32_bf16 v[64:67], v[128:131], v[144:147], v[64:67]
    ds_read_b128 v[160:163], v19 offset:0
    ds_read_b64_tr_b16 v[176:177], v24 offset:24576
    v_mfma_f32_16x16x32_bf16 v[80:83], v[128:131], v[148:151], v[80:83]
    ds_read_b64_tr_b16 v[178:179], v24 offset:25600
    v_mfma_f32_16x16x32_bf16 v[84:87], v[132:135], v[148:151], v[84:87]
    ds_read_b64_tr_b16 v[180:181], v25 offset:24576
    ds_read_b64_tr_b16 v[182:183], v25 offset:25600
    v_mfma_f32_16x16x32_bf16 v[68:71], v[132:135], v[144:147], v[68:71]
    ds_read_b128 v[164:167], v19 offset:1024
    v_mfma_f32_16x16x32_bf16 v[100:103], v[132:135], v[152:155], v[100:103]
    ds_read_b64_tr_b16 v[184:185], v26 offset:24576
    ds_read_b64_tr_b16 v[186:187], v26 offset:25600
    v_mfma_f32_16x16x32_bf16 v[96:99], v[128:131], v[152:155], v[96:99]
    ds_read_b64_tr_b16 v[188:189], v27 offset:24576
    v_mfma_f32_16x16x32_bf16 v[112:115], v[128:131], v[156:159], v[112:115]
    ds_read_b64_tr_b16 v[190:191], v27 offset:25600
    ds_read_b128 v[168:171], v19 offset:4096
    v_mfma_f32_16x16x32_bf16 v[116:119], v[132:135], v[156:159], v[116:119]
    ds_read_b128 v[172:175], v19 offset:5120
    v_mfma_f32_16x16x32_bf16 v[120:123], v[136:139], v[156:159], v[120:123]
    v_mfma_f32_16x16x32_bf16 v[104:107], v[136:139], v[152:155], v[104:107]
    v_mfma_f32_16x16x32_bf16 v[88:91], v[136:139], v[148:151], v[88:91]
    v_mfma_f32_16x16x32_bf16 v[72:75], v[136:139], v[144:147], v[72:75]
    v_mfma_f32_16x16x32_bf16 v[76:79], v[140:143], v[144:147], v[76:79]
    v_mfma_f32_16x16x32_bf16 v[92:95], v[140:143], v[148:151], v[92:95]
    v_mfma_f32_16x16x32_bf16 v[108:111], v[140:143], v[152:155], v[108:111]
    v_mfma_f32_16x16x32_bf16 v[124:127], v[140:143], v[156:159], v[124:127]
    s_waitcnt lgkmcnt(0)
    s_barrier
    v_mfma_f32_16x16x32_bf16 v[64:67], v[160:163], v[176:179], v[64:67]
    ds_read_b128 v[128:131], v18 offset:32768
    ds_read_b64_tr_b16 v[144:145], v24 offset:49152
    v_mfma_f32_16x16x32_bf16 v[80:83], v[160:163], v[180:183], v[80:83]
    ds_read_b64_tr_b16 v[146:147], v24 offset:50176
    v_mfma_f32_16x16x32_bf16 v[84:87], v[164:167], v[180:183], v[84:87]
    ds_read_b64_tr_b16 v[148:149], v25 offset:49152
    ds_read_b64_tr_b16 v[150:151], v25 offset:50176
    v_mfma_f32_16x16x32_bf16 v[68:71], v[164:167], v[176:179], v[68:71]
    ds_read_b128 v[132:135], v18 offset:33792
    v_mfma_f32_16x16x32_bf16 v[100:103], v[164:167], v[184:187], v[100:103]
    ds_read_b64_tr_b16 v[152:153], v26 offset:49152
    ds_read_b64_tr_b16 v[154:155], v26 offset:50176
    v_mfma_f32_16x16x32_bf16 v[96:99], v[160:163], v[184:187], v[96:99]
    ds_read_b64_tr_b16 v[156:157], v27 offset:49152
    v_mfma_f32_16x16x32_bf16 v[112:115], v[160:163], v[188:191], v[112:115]
    ds_read_b64_tr_b16 v[158:159], v27 offset:50176
    ds_read_b128 v[136:139], v18 offset:36864
    v_mfma_f32_16x16x32_bf16 v[116:119], v[164:167], v[188:191], v[116:119]
    ds_read_b128 v[140:143], v18 offset:37888
    v_mfma_f32_16x16x32_bf16 v[120:123], v[168:171], v[188:191], v[120:123]
    v_mfma_f32_16x16x32_bf16 v[104:107], v[168:171], v[184:187], v[104:107]
    v_mfma_f32_16x16x32_bf16 v[88:91], v[168:171], v[180:183], v[88:91]
    v_mfma_f32_16x16x32_bf16 v[72:75], v[168:171], v[176:179], v[72:75]
    v_mfma_f32_16x16x32_bf16 v[76:79], v[172:175], v[176:179], v[76:79]
    v_mfma_f32_16x16x32_bf16 v[92:95], v[172:175], v[180:183], v[92:95]
    v_mfma_f32_16x16x32_bf16 v[108:111], v[172:175], v[184:187], v[108:111]
    v_mfma_f32_16x16x32_bf16 v[124:127], v[172:175], v[188:191], v[124:127]
    s_waitcnt lgkmcnt(0)
    v_mfma_f32_16x16x32_bf16 v[64:67], v[128:131], v[144:147], v[64:67]
    ds_read_b128 v[160:163], v19 offset:32768
    ds_read_b64_tr_b16 v[176:177], v24 offset:57344
    v_mfma_f32_16x16x32_bf16 v[80:83], v[128:131], v[148:151], v[80:83]
    ds_read_b64_tr_b16 v[178:179], v24 offset:58368
    v_mfma_f32_16x16x32_bf16 v[84:87], v[132:135], v[148:151], v[84:87]
    ds_read_b64_tr_b16 v[180:181], v25 offset:57344
    ds_read_b64_tr_b16 v[182:183], v25 offset:58368
    v_mfma_f32_16x16x32_bf16 v[68:71], v[132:135], v[144:147], v[68:71]
    ds_read_b128 v[164:167], v19 offset:33792
    v_mfma_f32_16x16x32_bf16 v[100:103], v[132:135], v[152:155], v[100:103]
    ds_read_b64_tr_b16 v[184:185], v26 offset:57344
    ds_read_b64_tr_b16 v[186:187], v26 offset:58368
    v_mfma_f32_16x16x32_bf16 v[96:99], v[128:131], v[152:155], v[96:99]
    ds_read_b64_tr_b16 v[188:189], v27 offset:57344
    v_mfma_f32_16x16x32_bf16 v[112:115], v[128:131], v[156:159], v[112:115]
    ds_read_b64_tr_b16 v[190:191], v27 offset:58368
    ds_read_b128 v[168:171], v19 offset:36864
    v_mfma_f32_16x16x32_bf16 v[116:119], v[132:135], v[156:159], v[116:119]
    ds_read_b128 v[172:175], v19 offset:37888
    v_mfma_f32_16x16x32_bf16 v[120:123], v[136:139], v[156:159], v[120:123]
    v_mfma_f32_16x16x32_bf16 v[104:107], v[136:139], v[152:155], v[104:107]
    v_mfma_f32_16x16x32_bf16 v[88:91], v[136:139], v[148:151], v[88:91]
    v_mfma_f32_16x16x32_bf16 v[72:75], v[136:139], v[144:147], v[72:75]
    v_mfma_f32_16x16x32_bf16 v[76:79], v[140:143], v[144:147], v[76:79]
    v_mfma_f32_16x16x32_bf16 v[92:95], v[140:143], v[148:151], v[92:95]
    v_mfma_f32_16x16x32_bf16 v[108:111], v[140:143], v[152:155], v[108:111]
    v_mfma_f32_16x16x32_bf16 v[124:127], v[140:143], v[156:159], v[124:127]
    s_waitcnt lgkmcnt(0)
    s_barrier
    v_mfma_f32_16x16x32_bf16 v[64:67], v[160:163], v[176:179], v[64:67]
    ds_read_b128 v[128:131], v16 offset:0
    ds_read_b64_tr_b16 v[144:145], v20 offset:16384
    v_mfma_f32_16x16x32_bf16 v[80:83], v[160:163], v[180:183], v[80:83]
    ds_read_b64_tr_b16 v[146:147], v20 offset:17408
    v_mfma_f32_16x16x32_bf16 v[84:87], v[164:167], v[180:183], v[84:87]
    ds_read_b64_tr_b16 v[148:149], v21 offset:16384
    ds_read_b64_tr_b16 v[150:151], v21 offset:17408
    v_mfma_f32_16x16x32_bf16 v[68:71], v[164:167], v[176:179], v[68:71]
    ds_read_b128 v[132:135], v16 offset:1024
    v_mfma_f32_16x16x32_bf16 v[100:103], v[164:167], v[184:187], v[100:103]
    ds_read_b64_tr_b16 v[152:153], v22 offset:16384
    ds_read_b64_tr_b16 v[154:155], v22 offset:17408
    v_mfma_f32_16x16x32_bf16 v[96:99], v[160:163], v[184:187], v[96:99]
    ds_read_b64_tr_b16 v[156:157], v23 offset:16384
    v_mfma_f32_16x16x32_bf16 v[112:115], v[160:163], v[188:191], v[112:115]
    ds_read_b64_tr_b16 v[158:159], v23 offset:17408
    ds_read_b128 v[136:139], v16 offset:4096
    v_mfma_f32_16x16x32_bf16 v[116:119], v[164:167], v[188:191], v[116:119]
    ds_read_b128 v[140:143], v16 offset:5120
    v_mfma_f32_16x16x32_bf16 v[120:123], v[168:171], v[188:191], v[120:123]
    v_mfma_f32_16x16x32_bf16 v[104:107], v[168:171], v[184:187], v[104:107]
    v_mfma_f32_16x16x32_bf16 v[88:91], v[168:171], v[180:183], v[88:91]
    v_mfma_f32_16x16x32_bf16 v[72:75], v[168:171], v[176:179], v[72:75]
    v_mfma_f32_16x16x32_bf16 v[76:79], v[172:175], v[176:179], v[76:79]
    v_mfma_f32_16x16x32_bf16 v[92:95], v[172:175], v[180:183], v[92:95]
    v_mfma_f32_16x16x32_bf16 v[108:111], v[172:175], v[184:187], v[108:111]
    v_mfma_f32_16x16x32_bf16 v[124:127], v[172:175], v[188:191], v[124:127]
    s_waitcnt lgkmcnt(0)
    v_mfma_f32_16x16x32_bf16 v[64:67], v[128:131], v[144:147], v[64:67]
    ds_read_b128 v[160:163], v17 offset:0
    ds_read_b64_tr_b16 v[176:177], v20 offset:24576
    v_mfma_f32_16x16x32_bf16 v[80:83], v[128:131], v[148:151], v[80:83]
    ds_read_b64_tr_b16 v[178:179], v20 offset:25600
    v_mfma_f32_16x16x32_bf16 v[84:87], v[132:135], v[148:151], v[84:87]
    ds_read_b64_tr_b16 v[180:181], v21 offset:24576
    ds_read_b64_tr_b16 v[182:183], v21 offset:25600
    v_mfma_f32_16x16x32_bf16 v[68:71], v[132:135], v[144:147], v[68:71]
    ds_read_b128 v[164:167], v17 offset:1024
    v_mfma_f32_16x16x32_bf16 v[100:103], v[132:135], v[152:155], v[100:103]
    ds_read_b64_tr_b16 v[184:185], v22 offset:24576
    ds_read_b64_tr_b16 v[186:187], v22 offset:25600
    v_mfma_f32_16x16x32_bf16 v[96:99], v[128:131], v[152:155], v[96:99]
    ds_read_b64_tr_b16 v[188:189], v23 offset:24576
    v_mfma_f32_16x16x32_bf16 v[112:115], v[128:131], v[156:159], v[112:115]
    ds_read_b64_tr_b16 v[190:191], v23 offset:25600
    ds_read_b128 v[168:171], v17 offset:4096
    v_mfma_f32_16x16x32_bf16 v[116:119], v[132:135], v[156:159], v[116:119]
    ds_read_b128 v[172:175], v17 offset:5120
    v_mfma_f32_16x16x32_bf16 v[120:123], v[136:139], v[156:159], v[120:123]
    v_mfma_f32_16x16x32_bf16 v[104:107], v[136:139], v[152:155], v[104:107]
    v_mfma_f32_16x16x32_bf16 v[88:91], v[136:139], v[148:151], v[88:91]
    v_mfma_f32_16x16x32_bf16 v[72:75], v[136:139], v[144:147], v[72:75]
    v_mfma_f32_16x16x32_bf16 v[76:79], v[140:143], v[144:147], v[76:79]
    v_mfma_f32_16x16x32_bf16 v[92:95], v[140:143], v[148:151], v[92:95]
    v_mfma_f32_16x16x32_bf16 v[108:111], v[140:143], v[152:155], v[108:111]
    v_mfma_f32_16x16x32_bf16 v[124:127], v[140:143], v[156:159], v[124:127]
    s_waitcnt lgkmcnt(0)
    s_barrier
    v_mfma_f32_16x16x32_bf16 v[64:67], v[160:163], v[176:179], v[64:67]
    ds_read_b128 v[128:131], v16 offset:32768
    ds_read_b64_tr_b16 v[144:145], v20 offset:49152
    v_mfma_f32_16x16x32_bf16 v[80:83], v[160:163], v[180:183], v[80:83]
    ds_read_b64_tr_b16 v[146:147], v20 offset:50176
    v_mfma_f32_16x16x32_bf16 v[84:87], v[164:167], v[180:183], v[84:87]
    ds_read_b64_tr_b16 v[148:149], v21 offset:49152
    ds_read_b64_tr_b16 v[150:151], v21 offset:50176
    v_mfma_f32_16x16x32_bf16 v[68:71], v[164:167], v[176:179], v[68:71]
    ds_read_b128 v[132:135], v16 offset:33792
    v_mfma_f32_16x16x32_bf16 v[100:103], v[164:167], v[184:187], v[100:103]
    ds_read_b64_tr_b16 v[152:153], v22 offset:49152
    ds_read_b64_tr_b16 v[154:155], v22 offset:50176
    v_mfma_f32_16x16x32_bf16 v[96:99], v[160:163], v[184:187], v[96:99]
    ds_read_b64_tr_b16 v[156:157], v23 offset:49152
    v_mfma_f32_16x16x32_bf16 v[112:115], v[160:163], v[188:191], v[112:115]
    ds_read_b64_tr_b16 v[158:159], v23 offset:50176
    ds_read_b128 v[136:139], v16 offset:36864
    v_mfma_f32_16x16x32_bf16 v[116:119], v[164:167], v[188:191], v[116:119]
    ds_read_b128 v[140:143], v16 offset:37888
    v_mfma_f32_16x16x32_bf16 v[120:123], v[168:171], v[188:191], v[120:123]
    v_mfma_f32_16x16x32_bf16 v[104:107], v[168:171], v[184:187], v[104:107]
    v_mfma_f32_16x16x32_bf16 v[88:91], v[168:171], v[180:183], v[88:91]
    v_mfma_f32_16x16x32_bf16 v[72:75], v[168:171], v[176:179], v[72:75]
    v_mfma_f32_16x16x32_bf16 v[76:79], v[172:175], v[176:179], v[76:79]
    v_mfma_f32_16x16x32_bf16 v[92:95], v[172:175], v[180:183], v[92:95]
    v_mfma_f32_16x16x32_bf16 v[108:111], v[172:175], v[184:187], v[108:111]
    v_mfma_f32_16x16x32_bf16 v[124:127], v[172:175], v[188:191], v[124:127]
    s_waitcnt lgkmcnt(0)
    v_mfma_f32_16x16x32_bf16 v[64:67], v[128:131], v[144:147], v[64:67]
    ds_read_b128 v[160:163], v17 offset:32768
    ds_read_b64_tr_b16 v[176:177], v20 offset:57344
    v_mfma_f32_16x16x32_bf16 v[80:83], v[128:131], v[148:151], v[80:83]
    ds_read_b64_tr_b16 v[178:179], v20 offset:58368
    v_mfma_f32_16x16x32_bf16 v[84:87], v[132:135], v[148:151], v[84:87]
    ds_read_b64_tr_b16 v[180:181], v21 offset:57344
    ds_read_b64_tr_b16 v[182:183], v21 offset:58368
    v_mfma_f32_16x16x32_bf16 v[68:71], v[132:135], v[144:147], v[68:71]
    ds_read_b128 v[164:167], v17 offset:33792
    v_mfma_f32_16x16x32_bf16 v[100:103], v[132:135], v[152:155], v[100:103]
    ds_read_b64_tr_b16 v[184:185], v22 offset:57344
    ds_read_b64_tr_b16 v[186:187], v22 offset:58368
    v_mfma_f32_16x16x32_bf16 v[96:99], v[128:131], v[152:155], v[96:99]
    ds_read_b64_tr_b16 v[188:189], v23 offset:57344
    v_mfma_f32_16x16x32_bf16 v[112:115], v[128:131], v[156:159], v[112:115]
    ds_read_b64_tr_b16 v[190:191], v23 offset:58368
    ds_read_b128 v[168:171], v17 offset:36864
    v_mfma_f32_16x16x32_bf16 v[116:119], v[132:135], v[156:159], v[116:119]
    ds_read_b128 v[172:175], v17 offset:37888
    v_mfma_f32_16x16x32_bf16 v[120:123], v[136:139], v[156:159], v[120:123]
    v_mfma_f32_16x16x32_bf16 v[104:107], v[136:139], v[152:155], v[104:107]
    v_mfma_f32_16x16x32_bf16 v[88:91], v[136:139], v[148:151], v[88:91]
    v_mfma_f32_16x16x32_bf16 v[72:75], v[136:139], v[144:147], v[72:75]
    v_mfma_f32_16x16x32_bf16 v[76:79], v[140:143], v[144:147], v[76:79]
    v_mfma_f32_16x16x32_bf16 v[92:95], v[140:143], v[148:151], v[92:95]
    v_mfma_f32_16x16x32_bf16 v[108:111], v[140:143], v[152:155], v[108:111]
    v_mfma_f32_16x16x32_bf16 v[124:127], v[140:143], v[156:159], v[124:127]
    s_waitcnt lgkmcnt(0)
    v_mfma_f32_16x16x32_bf16 v[64:67], v[160:163], v[176:179], v[64:67]
    v_mfma_f32_16x16x32_bf16 v[80:83], v[160:163], v[180:183], v[80:83]
    v_mfma_f32_16x16x32_bf16 v[84:87], v[164:167], v[180:183], v[84:87]
    v_mfma_f32_16x16x32_bf16 v[68:71], v[164:167], v[176:179], v[68:71]
    v_mfma_f32_16x16x32_bf16 v[100:103], v[164:167], v[184:187], v[100:103]
    v_mfma_f32_16x16x32_bf16 v[96:99], v[160:163], v[184:187], v[96:99]
    v_mfma_f32_16x16x32_bf16 v[112:115], v[160:163], v[188:191], v[112:115]
    v_mfma_f32_16x16x32_bf16 v[116:119], v[164:167], v[188:191], v[116:119]
    v_mfma_f32_16x16x32_bf16 v[120:123], v[168:171], v[188:191], v[120:123]
    v_mfma_f32_16x16x32_bf16 v[104:107], v[168:171], v[184:187], v[104:107]
    v_mfma_f32_16x16x32_bf16 v[88:91], v[168:171], v[180:183], v[88:91]
    v_mfma_f32_16x16x32_bf16 v[72:75], v[168:171], v[176:179], v[72:75]
    v_mfma_f32_16x16x32_bf16 v[76:79], v[172:175], v[176:179], v[76:79]
    v_mfma_f32_16x16x32_bf16 v[92:95], v[172:175], v[180:183], v[92:95]
    v_mfma_f32_16x16x32_bf16 v[108:111], v[172:175], v[184:187], v[108:111]
    v_mfma_f32_16x16x32_bf16 v[124:127], v[172:175], v[188:191], v[124:127]
    s_lshl_b32 s53, s28, 8
    s_add_u32 s53, s53, 106496
    v_lshl_add_u32 v5, v30, 2, s53
    s_lshl_b32 s54, s29, 9
    s_add_u32 s54, s54, 107520
    v_and_b32 v6, 15, v1
    v_lshl_add_u32 v6, v6, 3, s54
    v_mov_b32 v8, 106496
    v_lshl_add_u32 v7, v3, 6, s53
    v_and_b32 v224, 16, v1
    v_add_u32 v7, v7, v224
    v_cmp_gt_u32 vcc, 16, v1
    s_barrier
    ds_read_b32 v192, v5 offset:0
    ds_read_b32 v196, v5 offset:32
    ds_read_b32 v200, v5 offset:128
    ds_read_b32 v204, v5 offset:160
    ds_read_b64 v[208:209], v6 offset:0
    ds_read_b64 v[212:213], v6 offset:128
    ds_read_b64 v[216:217], v6 offset:256
    ds_read_b64 v[220:221], v6 offset:384
    ds_read_b32 v8, v8 offset:2048
    ds_read_b128 v[224:227], v7 offset:512
    ds_read_b128 v[228:231], v7 offset:544
    ds_read_b128 v[232:235], v7 offset:640
    ds_read_b128 v[236:239], v7 offset:672
    s_waitcnt lgkmcnt(4)
    v_cndmask_b32 v192, 0, v192, vcc
    v_and_b32 v193, 0xffff, v192
    v_cndmask_b32 v196, 0, v196, vcc
    v_and_b32 v197, 0xffff, v196
    v_cndmask_b32 v200, 0, v200, vcc
    v_and_b32 v201, 0xffff, v200
    v_cndmask_b32 v204, 0, v204, vcc
    v_and_b32 v205, 0xffff, v204
    v_readfirstlane_b32 s3, v8
    v_mfma_f32_16x16x32_bf16 v[64:67], v[192:195], v[208:211], v[64:67]
    v_mfma_f32_16x16x32_bf16 v[68:71], v[196:199], v[208:211], v[68:71]
    v_mfma_f32_16x16x32_bf16 v[72:75], v[200:203], v[208:211], v[72:75]
    v_mfma_f32_16x16x32_bf16 v[76:79], v[204:207], v[208:211], v[76:79]
    v_mfma_f32_16x16x32_bf16 v[80:83], v[192:195], v[212:215], v[80:83]
    v_mfma_f32_16x16x32_bf16 v[84:87], v[196:199], v[212:215], v[84:87]
    s_waitcnt lgkmcnt(0)
    s_nop 1
    v_pk_mul_f32 v[64:65], v[64:65], v[224:225]
    v_pk_mul_f32 v[66:67], v[66:67], v[226:227]
    v_pk_mul_f32 v[68:69], v[68:69], v[228:229]
    v_pk_mul_f32 v[70:71], v[70:71], v[230:231]
    v_mfma_f32_16x16x32_bf16 v[88:91], v[200:203], v[212:215], v[88:91]
    v_cvt_pk_bf16_f32 v64, v64, v65
    v_cvt_pk_bf16_f32 v65, v66, v67
    v_mfma_f32_16x16x32_bf16 v[92:95], v[204:207], v[212:215], v[92:95]
    v_cvt_pk_bf16_f32 v66, v68, v69
    v_cvt_pk_bf16_f32 v67, v70, v71
    buffer_store_dwordx4 v[64:67], v28, s[20:23], s30 offen offset:0 sc1
    v_pk_mul_f32 v[72:73], v[72:73], v[232:233]
    v_pk_mul_f32 v[74:75], v[74:75], v[234:235]
    v_pk_mul_f32 v[76:77], v[76:77], v[236:237]
    v_pk_mul_f32 v[78:79], v[78:79], v[238:239]
    v_mfma_f32_16x16x32_bf16 v[96:99], v[192:195], v[216:219], v[96:99]
    v_cvt_pk_bf16_f32 v72, v72, v73
    v_cvt_pk_bf16_f32 v73, v74, v75
    v_mfma_f32_16x16x32_bf16 v[100:103], v[196:199], v[216:219], v[100:103]
    v_cvt_pk_bf16_f32 v74, v76, v77
    v_cvt_pk_bf16_f32 v75, v78, v79
    buffer_store_dwordx4 v[72:75], v28, s[20:23], s31 offen offset:0 sc1
    v_pk_mul_f32 v[80:81], v[80:81], v[224:225]
    v_pk_mul_f32 v[82:83], v[82:83], v[226:227]
    v_pk_mul_f32 v[84:85], v[84:85], v[228:229]
    v_pk_mul_f32 v[86:87], v[86:87], v[230:231]
    v_mfma_f32_16x16x32_bf16 v[104:107], v[200:203], v[216:219], v[104:107]
    v_cvt_pk_bf16_f32 v80, v80, v81
    v_cvt_pk_bf16_f32 v81, v82, v83
    v_mfma_f32_16x16x32_bf16 v[108:111], v[204:207], v[216:219], v[108:111]
    v_cvt_pk_bf16_f32 v82, v84, v85
    v_cvt_pk_bf16_f32 v83, v86, v87
    buffer_store_dwordx4 v[80:83], v28, s[20:23], s30 offen offset:256 sc1
    v_pk_mul_f32 v[88:89], v[88:89], v[232:233]
    v_pk_mul_f32 v[90:91], v[90:91], v[234:235]
    v_pk_mul_f32 v[92:93], v[92:93], v[236:237]
    v_pk_mul_f32 v[94:95], v[94:95], v[238:239]
    v_mfma_f32_16x16x32_bf16 v[112:115], v[192:195], v[220:223], v[112:115]
    v_cvt_pk_bf16_f32 v88, v88, v89
    v_cvt_pk_bf16_f32 v89, v90, v91
    v_mfma_f32_16x16x32_bf16 v[116:119], v[196:199], v[220:223], v[116:119]
    v_cvt_pk_bf16_f32 v90, v92, v93
    v_cvt_pk_bf16_f32 v91, v94, v95
    buffer_store_dwordx4 v[88:91], v28, s[20:23], s31 offen offset:256 sc1
    v_pk_mul_f32 v[96:97], v[96:97], v[224:225]
    v_pk_mul_f32 v[98:99], v[98:99], v[226:227]
    v_pk_mul_f32 v[100:101], v[100:101], v[228:229]
    v_pk_mul_f32 v[102:103], v[102:103], v[230:231]
    v_mfma_f32_16x16x32_bf16 v[120:123], v[200:203], v[220:223], v[120:123]
    v_cvt_pk_bf16_f32 v96, v96, v97
    v_cvt_pk_bf16_f32 v97, v98, v99
    v_mfma_f32_16x16x32_bf16 v[124:127], v[204:207], v[220:223], v[124:127]
    v_cvt_pk_bf16_f32 v98, v100, v101
    v_cvt_pk_bf16_f32 v99, v102, v103
    buffer_store_dwordx4 v[96:99], v28, s[20:23], s30 offen offset:512 sc1
    v_pk_mul_f32 v[104:105], v[104:105], v[232:233]
    v_pk_mul_f32 v[106:107], v[106:107], v[234:235]
    v_pk_mul_f32 v[108:109], v[108:109], v[236:237]
    v_pk_mul_f32 v[110:111], v[110:111], v[238:239]
    v_cvt_pk_bf16_f32 v104, v104, v105
    v_cvt_pk_bf16_f32 v105, v106, v107
    v_cvt_pk_bf16_f32 v106, v108, v109
    v_cvt_pk_bf16_f32 v107, v110, v111
    buffer_store_dwordx4 v[104:107], v28, s[20:23], s31 offen offset:512 sc1
    v_pk_mul_f32 v[112:113], v[112:113], v[224:225]
    v_pk_mul_f32 v[114:115], v[114:115], v[226:227]
    v_pk_mul_f32 v[116:117], v[116:117], v[228:229]
    v_pk_mul_f32 v[118:119], v[118:119], v[230:231]
    v_cvt_pk_bf16_f32 v112, v112, v113
    v_cvt_pk_bf16_f32 v113, v114, v115
    v_cvt_pk_bf16_f32 v114, v116, v117
    v_cvt_pk_bf16_f32 v115, v118, v119
    buffer_store_dwordx4 v[112:115], v28, s[20:23], s30 offen offset:768 sc1
    v_pk_mul_f32 v[120:121], v[120:121], v[232:233]
    v_pk_mul_f32 v[122:123], v[122:123], v[234:235]
    v_pk_mul_f32 v[124:125], v[124:125], v[236:237]
    v_pk_mul_f32 v[126:127], v[126:127], v[238:239]
    v_cvt_pk_bf16_f32 v120, v120, v121
    v_cvt_pk_bf16_f32 v121, v122, v123
    v_cvt_pk_bf16_f32 v122, v124, v125
    v_cvt_pk_bf16_f32 v123, v126, v127
    buffer_store_dwordx4 v[120:123], v28, s[20:23], s31 offen offset:768 sc1
    s_branch mega_kernel_a_pub
mega_kernel_a_pub:
    s_lshr_b32 s52, s26, 1
    s_lshl_b32 s53, s52, 13
    s_and_b32 s54, s26, 1
    s_add_u32 s54, s54, 2
    s_lshl_b32 s54, s54, 4
    s_add_u32 s54, s54, s25
    s_lshl_b32 s54, s54, 2
    s_add_u32 s53, s53, s54
    s_add_u32 s53, s53, 22353920
    v_mul_u32_u24 v5, 8064, v3
    v_lshl_add_u32 v5, v4, 8, v5
    v_mov_b32 v7, s3
    s_cmp_eq_u32 s52, 7
    s_cselect_b32 s55, 0, -1
    s_cmp_lt_u32 s25, 5
    s_cselect_b32 s55, 0, s55
    s_cmp_ge_u32 s25, 5
    s_cselect_b32 s52, 5, 0
    s_sub_u32 s54, s25, s52
    s_cmp_ge_u32 s25, 10
    s_cselect_b32 s52, 5, 0
    s_sub_u32 s54, s54, s52
    v_lshrrev_b32 v6, 1, v4
    v_mul_u32_u24 v6, 5, v6
    v_add_u32 v8, 4, v6
    v_lshrrev_b32 v6, 4, v6
    v_lshrrev_b32 v8, 4, v8
    v_cmp_eq_u32 vcc, s54, v6
    v_cmp_eq_u32 s[56:57], s54, v8
    s_nop 0
    s_or_b64 s[56:57], s[56:57], vcc
    s_and_b32 s57, s57, s55
    s_waitcnt vmcnt(0)
    s_barrier
    s_cmp_lg_u32 s24, 0
    s_cbranch_scc1 mega_kernel_a_done
    s_mov_b64 exec, s[56:57]
    buffer_store_dword v7, v5, s[20:23], s53 offen sc1
    s_mov_b64 exec, -1
mega_kernel_a_done:
    s_and_b32 s52, s2, 7
    s_lshr_b32 s53, s2, 3
    s_lshr_b32 s54, s53, 3
    s_lshl_b32 s25, s52, 2
    s_add_u32 s25, s25, s54
    s_and_b32 s26, s53, 7
    s_and_b32 s31, s24, 3
    v_add_u32 v5, 0, v1
    v_mul_u32_u24 v6, 6554, v5
    v_lshrrev_b32 v6, 16, v6
    v_lshrrev_b32 v7, 4, v6
    v_mul_u32_u24 v7, 5120, v7
    v_mul_u32_u24 v6, 1120, v6
    v_lshl_add_u32 v88, v5, 4, v6
    v_add_u32 v88, v88, v7
    v_add_u32 v5, 64, v1
    v_mul_u32_u24 v6, 6554, v5
    v_lshrrev_b32 v6, 16, v6
    v_lshrrev_b32 v7, 4, v6
    v_mul_u32_u24 v7, 5120, v7
    v_mul_u32_u24 v6, 1120, v6
    v_lshl_add_u32 v89, v5, 4, v6
    v_add_u32 v89, v89, v7
    v_subrev_u32 v89, 1024, v89
    v_add_u32 v5, 128, v1
    v_mul_u32_u24 v6, 6554, v5
    v_lshrrev_b32 v6, 16, v6
    v_lshrrev_b32 v7, 4, v6
    v_mul_u32_u24 v7, 5120, v7
    v_mul_u32_u24 v6, 1120, v6
    v_lshl_add_u32 v90, v5, 4, v6
    v_add_u32 v90, v90, v7
    v_subrev_u32 v90, 2048, v90
    v_add_u32 v5, 192, v1
    v_mul_u32_u24 v6, 6554, v5
    v_lshrrev_b32 v6, 16, v6
    v_lshrrev_b32 v7, 4, v6
    v_mul_u32_u24 v7, 5120, v7
    v_mul_u32_u24 v6, 1120, v6
    v_lshl_add_u32 v91, v5, 4, v6
    v_add_u32 v91, v91, v7
    v_subrev_u32 v91, 3072, v91
    v_add_u32 v5, 256, v1
    v_mul_u32_u24 v6, 6554, v5
    v_lshrrev_b32 v6, 16, v6
    v_lshrrev_b32 v7, 4, v6
    v_mul_u32_u24 v7, 5120, v7
    v_mul_u32_u24 v6, 1120, v6
    v_lshl_add_u32 v92, v5, 4, v6
    v_add_u32 v92, v92, v7
    s_mov_b32 s16, s36
    s_mov_b32 s17, s37
    s_mov_b32 s18, 819200
    s_mov_b32 s19, 0x20000
    s_mul_i32 s60, s26, 160
    s_add_u32 s0, s24, s26
    s_and_b32 s0, s0, 7
    s_mul_i32 s0, s0, 51200
    s_add_u32 s52, s0, s60
    s_add_u32 s53, s52, 409600
    s_bitcmp1_b32 s2, 7
    s_cselect_b32 s0, s53, s52
    s_cselect_b32 s1, s52, s53
    s_mul_i32 s48, s24, 5120
    s_lshr_b32 s52, s25, 1
    s_mul_i32 s52, s52, 5
    s_and_b32 s53, s25, 1
    s_lshl_b32 s53, s53, 1
    s_add_u32 s53, s53, s52
    s_lshl_b32 s4, s53, 15
    s_add_u32 s5, s4, 32768
    s_add_u32 s53, s52, 4
    s_lshl_b32 s6, s53, 15
    s_lshr_b32 s52, s52, 4
    s_lshr_b32 s53, s53, 4
    s_lshl_b32 s52, 0x04210421, s52
    s_lshl_b32 s53, 0x04210421, s53
    s_or_b32 s30, s52, s53
    s_lshl_b32 s54, s26, 1
    s_add_u32 s54, s54, s31
    s_cmp_lt_u32 s54, 2
    s_cselect_b32 s55, 0, 2
    s_sub_u32 s54, s54, s55
    s_lshl_b32 s7, s54, 11
    s_add_u32 s7, s7, 2621440
    s_lshl_b32 s8, s26, 12
    s_lshl_b32 s55, s31, 10
    s_add_u32 s8, s8, s55
    s_mul_i32 s9, s54, 163840
    s_mul_i32 s55, s25, 320
    s_add_u32 s9, s9, s55
    s_add_u32 s9, s9, 5242880
    s_lshl_b32 s10, s26, 13
    s_lshl_b32 s55, s25, 8
    s_add_u32 s10, s10, s55
    s_add_u32 s10, s10, 22353920
    s_cmp_eq_u32 s26, 0
    s_cselect_b32 s11, 0, 0x7fe07fe0
    s_and_b32 s11, s11, s30
    s_and_b32 s27, s2, 4
    s_xor_b32 s27, s27, s24
    s_lshl_b32 s52, s27, 9
    s_add_u32 s53, s52, 139264
    v_lshl_add_u32 v83, v4, 4, s53
    v_lshl_add_u32 v82, v3, 13, v83
    s_mul_i32 s53, s27, 1280
    s_add_u32 s53, s53, 106496
    v_mul_u32_u24 v6, 320, v3
    v_lshl_add_u32 v6, v4, 4, v6
    v_add_u32 v93, s53, v6
    s_add_u32 s53, s52, 126976
    v_lshl_add_u32 v80, v4, 4, s53
    v_lshl_add_u32 v81, v3, 12, v80
    s_lshl_b32 s52, s26, 3
    s_add_u32 s27, s27, s52
    v_lshrrev_b32 v5, 4, v4
    v_mul_u32_u24 v5, 20480, v5
    v_and_b32 v6, 15, v1
    v_lshl_add_u32 v95, v6, 3, v5
    v_lshl_add_u32 v5, v6, 4, v5
    v_lshl_add_u32 v94, v3, 8, v5
    s_and_b32 s52, s2, 0x3c
    s_xor_b32 s52, s52, s24
    s_mul_i32 s52, s52, 40960
    s_add_u32 s52, s52, 7864320
    s_and_b32 s53, s2, 7
    s_lshl_b32 s53, s53, 2
    s_lshr_b32 s54, s2, 6
    s_add_u32 s53, s53, s54
    s_lshl_b32 s54, s53, 9
    s_add_u32 s50, s54, s52
    s_lshl_b32 s54, s53, 7
    s_add_u32 s54, s54, s52
    s_add_u32 s51, s54, 16384
    v_lshlrev_b32 v85, 2, v4
    v_lshl_or_b32 v85, v3, 6, v85
    v_lshl_or_b32 v85, v3, 15, v85
    s_bitcmp1_b32 s25, 0
    s_cselect_b32 s28, 0, -1
    s_cselect_b32 s56, -1, 0
    s_mov_b32 s29, 0
    s_mov_b32 s57, 0
    s_mov_b32 s58, 0x000fffff
    s_mov_b32 s59, 0x000fffff
    s_cmp_lt_u32 s24, 4
    s_cbranch_scc1 mega_kernel_b_k
    v_and_b32 v5, 15, v1
    v_mul_u32_u24 v5, 1280, v5
    v_lshrrev_b32 v6, 4, v1
    v_lshl_add_u32 v5, v6, 3, v5
    s_lshl_b32 s52, s25, 2
    s_add_u32 s52, s52, s31
    s_mul_i32 s52, s52, 20480
    s_add_u32 s52, s52, s60
    buffer_load_dwordx2 v[10:11], v5, s[12:15], s52 offen offset:0
    buffer_load_dwordx2 v[12:13], v5, s[12:15], s52 offen offset:32
    buffer_load_dwordx2 v[14:15], v5, s[12:15], s52 offen offset:64
    buffer_load_dwordx2 v[16:17], v5, s[12:15], s52 offen offset:96
    buffer_load_dwordx2 v[18:19], v5, s[12:15], s52 offen offset:128
    v_add_u32 v5, 0, v1
    v_mul_u32_u24 v6, 3277, v5
    v_lshrrev_b32 v6, 16, v6
    v_mul_u32_u24 v6, 9920, v6
    v_lshl_add_u32 v20, v5, 4, v6
    v_add_u32 v5, 64, v1
    v_mul_u32_u24 v6, 3277, v5
    v_lshrrev_b32 v6, 16, v6
    v_mul_u32_u24 v6, 9920, v6
    v_lshl_add_u32 v21, v5, 4, v6
    v_subrev_u32 v21, 1024, v21
    v_add_u32 v5, 128, v1
    v_mul_u32_u24 v6, 3277, v5
    v_lshrrev_b32 v6, 16, v6
    v_mul_u32_u24 v6, 9920, v6
    v_lshl_add_u32 v22, v5, 4, v6
    v_subrev_u32 v22, 2048, v22
    v_add_u32 v5, 192, v1
    v_mul_u32_u24 v6, 3277, v5
    v_lshrrev_b32 v6, 16, v6
    v_mul_u32_u24 v6, 9920, v6
    v_lshl_add_u32 v23, v5, 4, v6
    v_subrev_u32 v23, 3072, v23
    v_add_u32 v5, 256, v1
    v_mul_u32_u24 v6, 3277, v5
    v_lshrrev_b32 v6, 16, v6
    v_mul_u32_u24 v6, 9920, v6
    v_lshl_add_u32 v24, v5, 4, v6
    v_lshlrev_b32 v6, 2, v3
    v_sub_u32 v6, v4, v6
    v_mov_b32 v7, 0xf149f2ca
    s_cmp_ge_u32 s27, 8
    s_cselect_b32 s55, 0, 0xf149f2ca
    v_mov_b32 v8, s55
    v_cmp_le_i32 vcc, 0, v6
    s_nop 1
    v_cndmask_b32_e64 v240, v7, 0, vcc
    v_cndmask_b32 v112, v8, v7, vcc
    v_cmp_le_i32 vcc, 1, v6
    s_nop 1
    v_cndmask_b32_e64 v241, v7, 0, vcc
    v_cndmask_b32 v113, v8, v7, vcc
    v_cmp_le_i32 vcc, 2, v6
    s_nop 1
    v_cndmask_b32_e64 v242, v7, 0, vcc
    v_cndmask_b32 v114, v8, v7, vcc
    v_cmp_le_i32 vcc, 3, v6
    s_nop 1
    v_cndmask_b32_e64 v243, v7, 0, vcc
    v_cndmask_b32 v115, v8, v7, vcc
    v_cmp_le_i32 vcc, 8, v6
    s_nop 1
    v_cndmask_b32_e64 v244, v7, 0, vcc
    v_cndmask_b32 v116, v8, v7, vcc
    v_cmp_le_i32 vcc, 9, v6
    s_nop 1
    v_cndmask_b32_e64 v245, v7, 0, vcc
    v_cndmask_b32 v117, v8, v7, vcc
    v_cmp_le_i32 vcc, 10, v6
    s_nop 1
    v_cndmask_b32_e64 v246, v7, 0, vcc
    v_cndmask_b32 v118, v8, v7, vcc
    v_cmp_le_i32 vcc, 11, v6
    s_nop 1
    v_cndmask_b32_e64 v247, v7, 0, vcc
    v_cndmask_b32 v119, v8, v7, vcc
    v_cmp_le_i32 vcc, 16, v6
    s_nop 1
    v_cndmask_b32_e64 v248, v7, 0, vcc
    v_cndmask_b32 v120, v8, v7, vcc
    v_cmp_le_i32 vcc, 17, v6
    s_nop 1
    v_cndmask_b32_e64 v249, v7, 0, vcc
    v_cndmask_b32 v121, v8, v7, vcc
    v_cmp_le_i32 vcc, 18, v6
    s_nop 1
    v_cndmask_b32_e64 v250, v7, 0, vcc
    v_cndmask_b32 v122, v8, v7, vcc
    v_cmp_le_i32 vcc, 19, v6
    s_nop 1
    v_cndmask_b32_e64 v251, v7, 0, vcc
    v_cndmask_b32 v123, v8, v7, vcc
    v_cmp_le_i32 vcc, 24, v6
    s_nop 1
    v_cndmask_b32_e64 v252, v7, 0, vcc
    v_cndmask_b32 v124, v8, v7, vcc
    v_cmp_le_i32 vcc, 25, v6
    s_nop 1
    v_cndmask_b32_e64 v253, v7, 0, vcc
    v_cndmask_b32 v125, v8, v7, vcc
    v_cmp_le_i32 vcc, 26, v6
    s_nop 1
    v_cndmask_b32_e64 v254, v7, 0, vcc
    v_cndmask_b32 v126, v8, v7, vcc
    v_cmp_le_i32 vcc, 27, v6
    s_nop 1
    v_cndmask_b32_e64 v255, v7, 0, vcc
    v_cndmask_b32 v127, v8, v7, vcc
    s_cmp_ge_u32 s27, 7
    s_cselect_b32 s54, 0, 0xf149f2ca
    s_mov_b32 s55, s54
    v_mov_b64 v[128:129], s[54:55]
    v_mov_b64 v[130:131], s[54:55]
    v_mov_b64 v[132:133], s[54:55]
    v_mov_b64 v[134:135], s[54:55]
    v_mov_b64 v[136:137], s[54:55]
    v_mov_b64 v[138:139], s[54:55]
    v_mov_b64 v[140:141], s[54:55]
    v_mov_b64 v[142:143], s[54:55]
    s_cmp_ge_u32 s27, 6
    s_cselect_b32 s54, 0, 0xf149f2ca
    s_mov_b32 s55, s54
    v_mov_b64 v[144:145], s[54:55]
    v_mov_b64 v[146:147], s[54:55]
    v_mov_b64 v[148:149], s[54:55]
    v_mov_b64 v[150:151], s[54:55]
    v_mov_b64 v[152:153], s[54:55]
    v_mov_b64 v[154:155], s[54:55]
    v_mov_b64 v[156:157], s[54:55]
    v_mov_b64 v[158:159], s[54:55]
    s_cmp_ge_u32 s27, 5
    s_cselect_b32 s54, 0, 0xf149f2ca
    s_mov_b32 s55, s54
    v_mov_b64 v[160:161], s[54:55]
    v_mov_b64 v[162:163], s[54:55]
    v_mov_b64 v[164:165], s[54:55]
    v_mov_b64 v[166:167], s[54:55]
    v_mov_b64 v[168:169], s[54:55]
    v_mov_b64 v[170:171], s[54:55]
    v_mov_b64 v[172:173], s[54:55]
    v_mov_b64 v[174:175], s[54:55]
    s_cmp_ge_u32 s27, 4
    s_cselect_b32 s54, 0, 0xf149f2ca
    s_mov_b32 s55, s54
    v_mov_b64 v[176:177], s[54:55]
    v_mov_b64 v[178:179], s[54:55]
    v_mov_b64 v[180:181], s[54:55]
    v_mov_b64 v[182:183], s[54:55]
    v_mov_b64 v[184:185], s[54:55]
    v_mov_b64 v[186:187], s[54:55]
    v_mov_b64 v[188:189], s[54:55]
    v_mov_b64 v[190:191], s[54:55]
    s_cmp_ge_u32 s27, 3
    s_cselect_b32 s54, 0, 0xf149f2ca
    s_mov_b32 s55, s54
    v_mov_b64 v[192:193], s[54:55]
    v_mov_b64 v[194:195], s[54:55]
    v_mov_b64 v[196:197], s[54:55]
    v_mov_b64 v[198:199], s[54:55]
    v_mov_b64 v[200:201], s[54:55]
    v_mov_b64 v[202:203], s[54:55]
    v_mov_b64 v[204:205], s[54:55]
    v_mov_b64 v[206:207], s[54:55]
    s_cmp_ge_u32 s27, 2
    s_cselect_b32 s54, 0, 0xf149f2ca
    s_mov_b32 s55, s54
    v_mov_b64 v[208:209], s[54:55]
    v_mov_b64 v[210:211], s[54:55]
    v_mov_b64 v[212:213], s[54:55]
    v_mov_b64 v[214:215], s[54:55]
    v_mov_b64 v[216:217], s[54:55]
    v_mov_b64 v[218:219], s[54:55]
    v_mov_b64 v[220:221], s[54:55]
    v_mov_b64 v[222:223], s[54:55]
    s_cmp_ge_u32 s27, 1
    s_cselect_b32 s54, 0, 0xf149f2ca
    s_mov_b32 s55, s54
    v_mov_b64 v[224:225], s[54:55]
    v_mov_b64 v[226:227], s[54:55]
    v_mov_b64 v[228:229], s[54:55]
    v_mov_b64 v[230:231], s[54:55]
    v_mov_b64 v[232:233], s[54:55]
    v_mov_b64 v[234:235], s[54:55]
    v_mov_b64 v[236:237], s[54:55]
    v_mov_b64 v[238:239], s[54:55]
    s_mov_b32 s54, 0x3f803f80
    s_mov_b32 s55, 0x3f803f80
    v_mov_b64 v[60:61], s[54:55]
    v_mov_b64 v[62:63], s[54:55]
    v_mov_b64 v[64:65], s[54:55]
    v_mov_b64 v[66:67], s[54:55]
    v_mov_b64 v[68:69], s[54:55]
    v_mov_b64 v[70:71], s[54:55]
    v_mov_b32 v72, 0x3f803f80
    v_mov_b32 v73, 0x3f80
    v_mov_b64 v[74:75], 0
    v_mov_b64 v[78:79], 0
    s_lshl_b32 s52, s26, 12
    s_lshl_b32 s53, s25, 2
    s_add_u32 s52, s52, s53
    s_add_u32 s52, s52, 22419456
    v_lshlrev_b32 v5, 7, v1
    s_cmp_ge_u32 s2, 240
    s_cbranch_scc1 mega_kernel_b_sp
    s_waitcnt vmcnt(5)
    s_barrier
mega_kernel_b_sp:
    s_cmp_lg_u32 s24, 5
    s_cbranch_scc1 mega_kernel_b_nf
    s_nop 15
    s_nop 15
    s_nop 15
    s_nop 15
    s_nop 15
    s_nop 15
    s_nop 15
    s_nop 15
    v_mov_b32 v8, s3
    s_cmp_eq_u32 s24, 5
    s_cselect_b32 exec_lo, -1, 0
    s_mov_b32 exec_hi, 0
    buffer_store_dword v8, v5, s[20:23], s52 offen sc1
    s_mov_b64 exec, -1
mega_kernel_b_nf:
    s_and_b32 s52, s2, 7
    s_lshr_b32 s53, s2, 3
    s_lshr_b32 s54, s53, 3
    s_lshr_b32 s55, s52, 1
    s_lshl_b32 s96, s55, 2
    s_add_u32 s96, s96, s54
    s_and_b32 s52, s52, 1
    s_lshl_b32 s52, s52, 3
    s_and_b32 s53, s53, 7
    s_add_u32 s97, s52, s53
    s_mul_i32 s54, s54, 5
    s_add_u32 s54, s54, 1
    s_lshr_b32 s54, s54, 1
    s_add_u32 s54, s54, s55
    s_cmp_ge_u32 s54, 10
    s_cselect_b32 s55, 10, 0
    s_sub_u32 s98, s54, s55
    s_bitcmp1_b32 s24, 1
    s_cselect_b32 s32, s42, s40
    s_cselect_b32 s33, s43, s41
    s_mov_b32 s34, 1966080
    s_mov_b32 s35, 0x20000
    v_add_u32 v5, 0, v1
    v_mul_u32_u24 v6, 5462, v5
    v_lshrrev_b32 v6, 16, v6
    v_and_b32 v7, 8, v6
    v_lshrrev_b32 v7, 2, v7
    v_xor_b32 v5, v7, v5
    v_mul_u32_u24 v6, 2880, v6
    v_lshl_add_u32 v32, v5, 4, v6
    v_add_u32 v5, 64, v1
    v_mul_u32_u24 v6, 5462, v5
    v_lshrrev_b32 v6, 16, v6
    v_and_b32 v7, 8, v6
    v_lshrrev_b32 v7, 2, v7
    v_xor_b32 v5, v7, v5
    v_mul_u32_u24 v6, 2880, v6
    v_lshl_add_u32 v33, v5, 4, v6
    v_subrev_u32 v33, 1024, v33
    v_add_u32 v5, 128, v1
    v_mul_u32_u24 v6, 5462, v5
    v_lshrrev_b32 v6, 16, v6
    v_and_b32 v7, 8, v6
    v_lshrrev_b32 v7, 2, v7
    v_xor_b32 v5, v7, v5
    v_mul_u32_u24 v6, 2880, v6
    v_lshl_add_u32 v34, v5, 4, v6
    v_subrev_u32 v34, 2048, v34
    s_and_b32 s52, s24, 3
    s_mul_i32 s39, s52, 6144
    s_and_b32 s52, s24, 1
    s_mul_i32 s52, s52, 98304
    s_mul_i32 s53, s97, 192
    s_add_u32 s52, s52, s53
    s_add_u32 s38, s52, 1966080
    s_mul_i32 s53, s98, 196608
    s_add_u32 s99, s52, s53
    s_lshl_b32 s53, s31, 10
    s_cmp_lg_u32 s24, 4
    s_cbranch_scc1 mega_kernel_b_np
    v_lshlrev_b32 v7, 2, v1
    s_nop 15
    s_nop 15
    s_mov_b32 exec_lo, s11
    s_mov_b32 exec_hi, s30
    s_mov_b32 s61, 0
mega_kernel_pl2:
    buffer_load_dword v36, v7, s[20:23], s10 offen sc1
    s_waitcnt vmcnt(0)
    v_cmp_ne_u32 vcc, s3, v36
    s_add_u32 s61, s61, 1
    s_cbranch_vccz mega_kernel_pd2
    s_cmp_lt_u32 s61, 40000
    s_cbranch_scc1 mega_kernel_pl2
mega_kernel_pd2:
    s_mov_b64 exec, -1
mega_kernel_b_np:
    s_barrier
    s_add_u32 m0, s53, 126976
    s_add_u32 s54, s4, s8
    buffer_load_dwordx4 v2, s[20:23], s54 offen sc1 lds
    s_add_u32 m0, s53, 131072
    s_add_u32 s54, s5, s8
    buffer_load_dwordx4 v2, s[20:23], s54 offen sc1 lds
    s_add_u32 m0, s53, 135168
    s_add_u32 s54, s6, s8
    buffer_load_dwordx4 v2, s[20:23], s54 offen sc1 lds
    s_mul_i32 s52, s31, 5120
    s_add_u32 m0, s52, 106496
    s_nop 0
    buffer_load_dwordx4 v20, s[20:23], s9 offen offset:0 sc1 lds
    buffer_load_dwordx4 v21, s[20:23], s9 offen offset:1024 sc1 lds
    buffer_load_dwordx4 v22, s[20:23], s9 offen offset:2048 sc1 lds
    buffer_load_dwordx4 v23, s[20:23], s9 offen offset:3072 sc1 lds
    s_add_u32 m0, s52, 110592
    s_nop 0
    buffer_load_dwordx4 v24, s[20:23], s9 offen offset:0 sc1 lds
    v_mov_b32 v5, 102400
    v_mov_b64 v[6:7], 0
    ds_write2_b64 v5, v[6:7], v[6:7] offset1:1
    s_setprio 0
    s_waitcnt vmcnt(5) lgkmcnt(0)
    s_branch mega_kernel_b_go
mega_kernel_b_k:
    s_and_b32 s52, s2, 7
    s_lshr_b32 s53, s2, 3
    s_lshr_b32 s54, s53, 3
    s_lshr_b32 s55, s52, 1
    s_lshl_b32 s96, s55, 2
    s_add_u32 s96, s96, s54
    s_and_b32 s52, s52, 1
    s_lshl_b32 s52, s52, 3
    s_and_b32 s53, s53, 7
    s_add_u32 s97, s52, s53
    s_mul_i32 s54, s54, 5
    s_add_u32 s54, s54, 1
    s_lshr_b32 s54, s54, 1
    s_add_u32 s54, s54, s55
    s_cmp_ge_u32 s54, 10
    s_cselect_b32 s55, 10, 0
    s_sub_u32 s98, s54, s55
    s_bitcmp1_b32 s24, 1
    s_cselect_b32 s32, s42, s40
    s_cselect_b32 s33, s43, s41
    s_mov_b32 s34, 1966080
    s_mov_b32 s35, 0x20000
    v_add_u32 v5, 0, v1
    v_mul_u32_u24 v6, 5462, v5
    v_lshrrev_b32 v6, 16, v6
    v_and_b32 v7, 8, v6
    v_lshrrev_b32 v7, 2, v7
    v_xor_b32 v5, v7, v5
    v_mul_u32_u24 v6, 2880, v6
    v_lshl_add_u32 v32, v5, 4, v6
    v_add_u32 v5, 64, v1
    v_mul_u32_u24 v6, 5462, v5
    v_lshrrev_b32 v6, 16, v6
    v_and_b32 v7, 8, v6
    v_lshrrev_b32 v7, 2, v7
    v_xor_b32 v5, v7, v5
    v_mul_u32_u24 v6, 2880, v6
    v_lshl_add_u32 v33, v5, 4, v6
    v_subrev_u32 v33, 1024, v33
    v_add_u32 v5, 128, v1
    v_mul_u32_u24 v6, 5462, v5
    v_lshrrev_b32 v6, 16, v6
    v_and_b32 v7, 8, v6
    v_lshrrev_b32 v7, 2, v7
    v_xor_b32 v5, v7, v5
    v_mul_u32_u24 v6, 2880, v6
    v_lshl_add_u32 v34, v5, 4, v6
    v_subrev_u32 v34, 2048, v34
    s_and_b32 s52, s24, 3
    s_mul_i32 s39, s52, 6144
    s_and_b32 s52, s24, 1
    s_mul_i32 s52, s52, 98304
    s_mul_i32 s53, s97, 192
    s_add_u32 s52, s52, s53
    s_add_u32 s38, s52, 1966080
    s_mul_i32 s53, s98, 196608
    s_add_u32 s99, s52, s53
    v_add_u32 v5, 0, v1
    v_mul_u32_u24 v6, 6554, v5
    v_lshrrev_b32 v6, 16, v6
    v_lshrrev_b32 v7, 2, v6
    v_mul_u32_u24 v7, 20480, v7
    v_mul_u32_u24 v6, 1120, v6
    v_lshl_add_u32 v20, v5, 4, v6
    v_add_u32 v20, v20, v7
    v_add_u32 v5, 64, v1
    v_mul_u32_u24 v6, 6554, v5
    v_lshrrev_b32 v6, 16, v6
    v_lshrrev_b32 v7, 2, v6
    v_mul_u32_u24 v7, 20480, v7
    v_mul_u32_u24 v6, 1120, v6
    v_lshl_add_u32 v21, v5, 4, v6
    v_add_u32 v21, v21, v7
    v_subrev_u32 v21, 1024, v21
    v_add_u32 v5, 128, v1
    v_mul_u32_u24 v6, 6554, v5
    v_lshrrev_b32 v6, 16, v6
    v_lshrrev_b32 v7, 2, v6
    v_mul_u32_u24 v7, 20480, v7
    v_mul_u32_u24 v6, 1120, v6
    v_lshl_add_u32 v22, v5, 4, v6
    v_add_u32 v22, v22, v7
    v_subrev_u32 v22, 2048, v22
    v_add_u32 v5, 192, v1
    v_mul_u32_u24 v6, 6554, v5
    v_lshrrev_b32 v6, 16, v6
    v_lshrrev_b32 v7, 2, v6
    v_mul_u32_u24 v7, 20480, v7
    v_mul_u32_u24 v6, 1120, v6
    v_lshl_add_u32 v23, v5, 4, v6
    v_add_u32 v23, v23, v7
    v_subrev_u32 v23, 3072, v23
    v_add_u32 v5, 256, v1
    v_mul_u32_u24 v6, 6554, v5
    v_lshrrev_b32 v6, 16, v6
    v_lshrrev_b32 v7, 2, v6
    v_mul_u32_u24 v7, 20480, v7
    v_mul_u32_u24 v6, 1120, v6
    v_lshl_add_u32 v24, v5, 4, v6
    v_add_u32 v24, v24, v7
    s_mul_i32 s9, s31, 204800
    s_add_u32 s9, s9, s60
    s_add_u32 s9, s9, 20480
    s_lshr_b32 s10, s2, 6
    s_xor_b32 s10, s10, s31
    s_and_b32 s10, s10, 2
    s_mul_i32 s10, s10, 5
    s_and_b32 s8, s31, 1
    s_add_u32 s8, s8, s10
    s_mul_i32 s8, s8, 5120
    s_lshl_b32 s52, s31, 11
    v_mov_b64 v[10:11], 0
    v_mov_b64 v[12:13], 0
    v_mov_b64 v[14:15], 0
    v_mov_b64 v[16:17], 0
    v_mov_b64 v[18:19], 0
    s_barrier
    s_add_u32 m0, s52, 139264
    s_add_u32 s54, s4, s7
    buffer_load_dwordx4 v2, s[20:23], s54 offen sc1 lds
    buffer_load_dwordx4 v2, s[20:23], s54 offen offset:1024 sc1 lds
    s_add_u32 m0, s52, 147456
    s_add_u32 s54, s5, s7
    buffer_load_dwordx4 v2, s[20:23], s54 offen sc1 lds
    buffer_load_dwordx4 v2, s[20:23], s54 offen offset:1024 sc1 lds
    s_add_u32 m0, s52, 155648
    s_add_u32 s54, s6, s7
    buffer_load_dwordx4 v2, s[20:23], s54 offen sc1 lds
    buffer_load_dwordx4 v2, s[20:23], s54 offen offset:1024 sc1 lds
    v_lshlrev_b32 v6, 2, v3
    v_sub_u32 v6, v4, v6
    v_mov_b32 v7, 0xf149f2ca
    s_cmp_ge_u32 s27, 8
    s_cselect_b32 s55, 0, 0xf149f2ca
    v_mov_b32 v8, s55
    v_cmp_le_i32 vcc, 0, v6
    s_nop 1
    v_cndmask_b32_e64 v240, v7, 0, vcc
    v_cndmask_b32 v112, v8, v7, vcc
    v_cmp_le_i32 vcc, 1, v6
    s_nop 1
    v_cndmask_b32_e64 v241, v7, 0, vcc
    v_cndmask_b32 v113, v8, v7, vcc
    v_cmp_le_i32 vcc, 2, v6
    s_nop 1
    v_cndmask_b32_e64 v242, v7, 0, vcc
    v_cndmask_b32 v114, v8, v7, vcc
    v_cmp_le_i32 vcc, 3, v6
    s_nop 1
    v_cndmask_b32_e64 v243, v7, 0, vcc
    v_cndmask_b32 v115, v8, v7, vcc
    v_cmp_le_i32 vcc, 8, v6
    s_nop 1
    v_cndmask_b32_e64 v244, v7, 0, vcc
    v_cndmask_b32 v116, v8, v7, vcc
    v_cmp_le_i32 vcc, 9, v6
    s_nop 1
    v_cndmask_b32_e64 v245, v7, 0, vcc
    v_cndmask_b32 v117, v8, v7, vcc
    v_cmp_le_i32 vcc, 10, v6
    s_nop 1
    v_cndmask_b32_e64 v246, v7, 0, vcc
    v_cndmask_b32 v118, v8, v7, vcc
    v_cmp_le_i32 vcc, 11, v6
    s_nop 1
    v_cndmask_b32_e64 v247, v7, 0, vcc
    v_cndmask_b32 v119, v8, v7, vcc
    v_cmp_le_i32 vcc, 16, v6
    s_nop 1
    v_cndmask_b32_e64 v248, v7, 0, vcc
    v_cndmask_b32 v120, v8, v7, vcc
    v_cmp_le_i32 vcc, 17, v6
    s_nop 1
    v_cndmask_b32_e64 v249, v7, 0, vcc
    v_cndmask_b32 v121, v8, v7, vcc
    v_cmp_le_i32 vcc, 18, v6
    s_nop 1
    v_cndmask_b32_e64 v250, v7, 0, vcc
    v_cndmask_b32 v122, v8, v7, vcc
    v_cmp_le_i32 vcc, 19, v6
    s_nop 1
    v_cndmask_b32_e64 v251, v7, 0, vcc
    v_cndmask_b32 v123, v8, v7, vcc
    v_cmp_le_i32 vcc, 24, v6
    s_nop 1
    v_cndmask_b32_e64 v252, v7, 0, vcc
    v_cndmask_b32 v124, v8, v7, vcc
    v_cmp_le_i32 vcc, 25, v6
    s_nop 1
    v_cndmask_b32_e64 v253, v7, 0, vcc
    v_cndmask_b32 v125, v8, v7, vcc
    v_cmp_le_i32 vcc, 26, v6
    s_nop 1
    v_cndmask_b32_e64 v254, v7, 0, vcc
    v_cndmask_b32 v126, v8, v7, vcc
    v_cmp_le_i32 vcc, 27, v6
    s_nop 1
    v_cndmask_b32_e64 v255, v7, 0, vcc
    v_cndmask_b32 v127, v8, v7, vcc
    s_cmp_ge_u32 s27, 7
    s_cselect_b32 s54, 0, 0xf149f2ca
    s_mov_b32 s55, s54
    v_mov_b64 v[128:129], s[54:55]
    v_mov_b64 v[130:131], s[54:55]
    v_mov_b64 v[132:133], s[54:55]
    v_mov_b64 v[134:135], s[54:55]
    v_mov_b64 v[136:137], s[54:55]
    v_mov_b64 v[138:139], s[54:55]
    v_mov_b64 v[140:141], s[54:55]
    v_mov_b64 v[142:143], s[54:55]
    s_cmp_ge_u32 s27, 6
    s_cselect_b32 s54, 0, 0xf149f2ca
    s_mov_b32 s55, s54
    v_mov_b64 v[144:145], s[54:55]
    v_mov_b64 v[146:147], s[54:55]
    v_mov_b64 v[148:149], s[54:55]
    v_mov_b64 v[150:151], s[54:55]
    v_mov_b64 v[152:153], s[54:55]
    v_mov_b64 v[154:155], s[54:55]
    v_mov_b64 v[156:157], s[54:55]
    v_mov_b64 v[158:159], s[54:55]
    s_cmp_ge_u32 s27, 5
    s_cselect_b32 s54, 0, 0xf149f2ca
    s_mov_b32 s55, s54
    v_mov_b64 v[160:161], s[54:55]
    v_mov_b64 v[162:163], s[54:55]
    v_mov_b64 v[164:165], s[54:55]
    v_mov_b64 v[166:167], s[54:55]
    v_mov_b64 v[168:169], s[54:55]
    v_mov_b64 v[170:171], s[54:55]
    v_mov_b64 v[172:173], s[54:55]
    v_mov_b64 v[174:175], s[54:55]
    s_cmp_ge_u32 s27, 4
    s_cselect_b32 s54, 0, 0xf149f2ca
    s_mov_b32 s55, s54
    v_mov_b64 v[176:177], s[54:55]
    v_mov_b64 v[178:179], s[54:55]
    v_mov_b64 v[180:181], s[54:55]
    v_mov_b64 v[182:183], s[54:55]
    v_mov_b64 v[184:185], s[54:55]
    v_mov_b64 v[186:187], s[54:55]
    v_mov_b64 v[188:189], s[54:55]
    v_mov_b64 v[190:191], s[54:55]
    s_cmp_ge_u32 s27, 3
    s_cselect_b32 s54, 0, 0xf149f2ca
    s_mov_b32 s55, s54
    v_mov_b64 v[192:193], s[54:55]
    v_mov_b64 v[194:195], s[54:55]
    v_mov_b64 v[196:197], s[54:55]
    v_mov_b64 v[198:199], s[54:55]
    v_mov_b64 v[200:201], s[54:55]
    v_mov_b64 v[202:203], s[54:55]
    v_mov_b64 v[204:205], s[54:55]
    v_mov_b64 v[206:207], s[54:55]
    s_cmp_ge_u32 s27, 2
    s_cselect_b32 s54, 0, 0xf149f2ca
    s_mov_b32 s55, s54
    v_mov_b64 v[208:209], s[54:55]
    v_mov_b64 v[210:211], s[54:55]
    v_mov_b64 v[212:213], s[54:55]
    v_mov_b64 v[214:215], s[54:55]
    v_mov_b64 v[216:217], s[54:55]
    v_mov_b64 v[218:219], s[54:55]
    v_mov_b64 v[220:221], s[54:55]
    v_mov_b64 v[222:223], s[54:55]
    s_cmp_ge_u32 s27, 1
    s_cselect_b32 s54, 0, 0xf149f2ca
    s_mov_b32 s55, s54
    v_mov_b64 v[224:225], s[54:55]
    v_mov_b64 v[226:227], s[54:55]
    v_mov_b64 v[228:229], s[54:55]
    v_mov_b64 v[230:231], s[54:55]
    v_mov_b64 v[232:233], s[54:55]
    v_mov_b64 v[234:235], s[54:55]
    v_mov_b64 v[236:237], s[54:55]
    v_mov_b64 v[238:239], s[54:55]
    s_mov_b32 s54, 0x3f803f80
    s_mov_b32 s55, 0x3f803f80
    v_mov_b64 v[60:61], s[54:55]
    v_mov_b64 v[62:63], s[54:55]
    v_mov_b64 v[64:65], s[54:55]
    v_mov_b64 v[66:67], s[54:55]
    v_mov_b64 v[68:69], s[54:55]
    v_mov_b64 v[70:71], s[54:55]
    v_mov_b32 v72, 0x3f803f80
    v_mov_b32 v73, 0x3f80
    v_mov_b64 v[74:75], 0
    v_mov_b64 v[78:79], 0
    s_add_u32 m0, s8, 40960
    s_nop 0
    buffer_load_dwordx4 v20, s[16:19], s9 offen offset:0 lds
    buffer_load_dwordx4 v21, s[16:19], s9 offen offset:1024 lds
    buffer_load_dwordx4 v22, s[16:19], s9 offen offset:2048 lds
    buffer_load_dwordx4 v23, s[16:19], s9 offen offset:3072 lds
    s_add_u32 m0, s8, 45056
    s_nop 0
    buffer_load_dwordx4 v24, s[16:19], s9 offen offset:0 lds
    s_setprio 1
    s_waitcnt vmcnt(5)
mega_kernel_b_go:
    s_barrier
    ds_read_b128 v[96:99], v81
    ds_read_b128 v[100:103], v80 offset:8192
    ds_read_b128 v[36:39], v82 offset:0
    ds_read_b128 v[40:43], v83 offset:16384
    ds_read_b128 v[44:47], v82 offset:512
    ds_read_b128 v[48:51], v83 offset:16896
    s_waitcnt lgkmcnt(4)
    v_cndmask_b32_e64 v100, 0, v100, s[28:29]
    v_cndmask_b32_e64 v101, 0, v101, s[28:29]
    v_cndmask_b32_e64 v102, 0, v102, s[56:57]
    v_cndmask_b32_e64 v103, 0, v103, s[56:57]
    s_lshr_b32 s8, s24, 2
    s_mul_i32 s9, s8, 3072
    s_add_u32 s9, s9, s39
    s_mul_i32 s8, s8, 49152
    s_add_u32 s8, s8, s99
    s_add_u32 s43, s9, 139264
    s_add_u32 s99, s99, 196608
    s_cmp_ge_u32 s99, s38
    s_cselect_b32 s52, 1966080, 0
    s_sub_u32 s99, s99, s52
    s_lshl_b32 s52, s25, 3
    s_add_u32 s52, s52, s26
    s_lshl_b32 s52, s52, 7
    s_add_u32 s42, s52, 22419456
    s_waitcnt lgkmcnt(2)
    v_mfma_f32_32x32x16_bf16 v[112:127], v[36:39], v[96:99], v[112:127]
    ds_read_b128 v[52:55], v82 offset:1024
    ds_read_b128 v[56:59], v83 offset:17408
    v_mfma_f32_32x32x16_bf16 v[112:127], v[40:43], v[100:103], v[112:127]
    buffer_load_dwordx4 v[20:23], v32, s[32:35], s8 offen offset:0
    s_waitcnt lgkmcnt(2)
    v_mfma_f32_32x32x16_bf16 v[128:143], v[44:47], v[96:99], v[128:143]
    ds_read_b128 v[36:39], v82 offset:1536
    ds_read_b128 v[40:43], v83 offset:17920
    v_mfma_f32_32x32x16_bf16 v[128:143], v[48:51], v[100:103], v[128:143]
    buffer_load_dwordx4 v[24:27], v33, s[32:35], s8 offen offset:1024
    s_waitcnt lgkmcnt(2)
    v_mfma_f32_32x32x16_bf16 v[144:159], v[52:55], v[96:99], v[144:159]
    ds_read_b128 v[44:47], v82 offset:2048
    ds_read_b128 v[48:51], v83 offset:18432
    s_nop 0
    v_max_f32 v80, v112, v113
    v_max_f32 v81, v114, v115
    v_max3_f32 v80, v116, v117, v80
    v_max3_f32 v81, v118, v119, v81
    v_mfma_f32_32x32x16_bf16 v[144:159], v[56:59], v[100:103], v[144:159]
    v_max3_f32 v80, v120, v121, v80
    v_max3_f32 v81, v122, v123, v81
    v_max3_f32 v80, v124, v125, v80
    v_max3_f32 v81, v126, v127, v81
    buffer_load_dwordx4 v[28:31], v34, s[32:35], s8 offen offset:2048
    s_waitcnt lgkmcnt(2)
    v_mfma_f32_32x32x16_bf16 v[160:175], v[36:39], v[96:99], v[160:175]
    ds_read_b128 v[52:55], v82 offset:2560
    ds_read_b128 v[56:59], v83 offset:18944
    v_max3_f32 v80, v128, v129, v80
    v_max3_f32 v81, v130, v131, v81
    v_max3_f32 v80, v132, v133, v80
    v_mfma_f32_32x32x16_bf16 v[160:175], v[40:43], v[100:103], v[160:175]
    v_max3_f32 v81, v134, v135, v81
    v_max3_f32 v80, v136, v137, v80
    v_max3_f32 v81, v138, v139, v81
    v_max3_f32 v80, v140, v141, v80
    v_max3_f32 v81, v142, v143, v81
    s_waitcnt lgkmcnt(2)
    v_mfma_f32_32x32x16_bf16 v[176:191], v[44:47], v[96:99], v[176:191]
    ds_read_b128 v[36:39], v82 offset:3072
    ds_read_b128 v[40:43], v83 offset:19456
    v_max3_f32 v80, v144, v145, v80
    v_max3_f32 v81, v146, v147, v81
    v_max3_f32 v80, v148, v149, v80
    v_mfma_f32_32x32x16_bf16 v[176:191], v[48:51], v[100:103], v[176:191]
    v_max3_f32 v81, v150, v151, v81
    v_max3_f32 v80, v152, v153, v80
    v_max3_f32 v81, v154, v155, v81
    v_max3_f32 v80, v156, v157, v80
    v_max3_f32 v81, v158, v159, v81
    s_waitcnt lgkmcnt(2)
    v_mfma_f32_32x32x16_bf16 v[192:207], v[52:55], v[96:99], v[192:207]
    ds_read_b128 v[44:47], v82 offset:3584
    ds_read_b128 v[48:51], v83 offset:19968
    v_max3_f32 v80, v160, v161, v80
    v_max3_f32 v81, v162, v163, v81
    v_max3_f32 v80, v164, v165, v80
    v_mfma_f32_32x32x16_bf16 v[192:207], v[56:59], v[100:103], v[192:207]
    v_max3_f32 v81, v166, v167, v81
    v_max3_f32 v80, v168, v169, v80
    v_max3_f32 v81, v170, v171, v81
    v_max3_f32 v80, v172, v173, v80
    v_max3_f32 v81, v174, v175, v81
    s_waitcnt lgkmcnt(2)
    v_mfma_f32_32x32x16_bf16 v[208:223], v[36:39], v[96:99], v[208:223]
    ds_read_b128 v[52:55], v82 offset:4096
    ds_read_b128 v[56:59], v83 offset:20480
    v_max3_f32 v80, v176, v177, v80
    v_max3_f32 v81, v178, v179, v81
    v_max3_f32 v80, v180, v181, v80
    v_mfma_f32_32x32x16_bf16 v[208:223], v[40:43], v[100:103], v[208:223]
    v_max3_f32 v81, v182, v183, v81
    v_max3_f32 v80, v184, v185, v80
    v_max3_f32 v81, v186, v187, v81
    v_max3_f32 v80, v188, v189, v80
    v_max3_f32 v81, v190, v191, v81
    s_waitcnt lgkmcnt(2)
    v_mfma_f32_32x32x16_bf16 v[224:239], v[44:47], v[96:99], v[224:239]
    v_max3_f32 v80, v192, v193, v80
    v_max3_f32 v81, v194, v195, v81
    v_max3_f32 v80, v196, v197, v80
    v_max3_f32 v81, v198, v199, v81
    v_mfma_f32_32x32x16_bf16 v[224:239], v[48:51], v[100:103], v[224:239]
    v_max3_f32 v80, v200, v201, v80
    v_max3_f32 v81, v202, v203, v81
    v_max3_f32 v80, v204, v205, v80
    v_max3_f32 v81, v206, v207, v81
    s_waitcnt lgkmcnt(0)
    v_mfma_f32_32x32x16_bf16 v[240:255], v[52:55], v[96:99], v[240:255]
    v_max3_f32 v80, v208, v209, v80
    v_max3_f32 v81, v210, v211, v81
    v_max3_f32 v80, v212, v213, v80
    v_max3_f32 v81, v214, v215, v81
    v_mfma_f32_32x32x16_bf16 v[240:255], v[56:59], v[100:103], v[240:255]
    v_max3_f32 v80, v216, v217, v80
    v_max3_f32 v81, v218, v219, v81
    v_max3_f32 v80, v220, v221, v80
    v_max3_f32 v81, v222, v223, v81
    v_max3_f32 v80, v224, v225, v80
    v_max3_f32 v81, v226, v227, v81
    v_max3_f32 v80, v228, v229, v80
    v_max3_f32 v81, v230, v231, v81
    v_max3_f32 v80, v232, v233, v80
    v_max3_f32 v81, v234, v235, v81
    v_max3_f32 v80, v236, v237, v80
    v_max3_f32 v81, v238, v239, v81
    v_max3_f32 v80, v240, v241, v80
    v_max3_f32 v81, v242, v243, v81
    v_max3_f32 v80, v244, v245, v80
    v_max3_f32 v81, v246, v247, v81
    v_max3_f32 v80, v248, v249, v80
    v_max3_f32 v81, v250, v251, v81
    v_max3_f32 v80, v252, v253, v80
    v_max3_f32 v81, v254, v255, v81
    s_waitcnt vmcnt(3)
    s_barrier
    s_mov_b64 exec, s[58:59]
    ds_read_b128 v[60:63], v93 offset:0
    s_mov_b64 exec, -1
    s_mov_b64 exec, s[58:59]
    ds_read_b128 v[64:67], v93 offset:640
    s_mov_b64 exec, -1
    v_max_f32 v80, v80, v81
    v_mov_b32 v81, v80
    s_nop 1
    v_permlane32_swap_b32 v81, v80
    v_max_f32 v80, v80, v81
    v_cvt_pk_bf16_f32 v5, v80, v80
    v_lshlrev_b32 v5, 16, v5
    v_sub_f32 v5, v80, v5
    v_cvt_pk_bf16_f32 v6, v5, v5
    v_cvt_pk_bf16_f32 v76, -v80, -v5
    v_lshlrev_b32 v6, 16, v6
    v_sub_f32 v5, v5, v6
    v_cvt_pk_bf16_f32 v77, -v5, 0
    v_cmp_gt_u32 vcc, 32, v1
    s_nop 1
    v_cndmask_b32 v76, 0, v76, vcc
    v_cndmask_b32 v77, 0, v77, vcc
    s_nop 1
    v_mfma_f32_32x32x16_bf16 v[112:127], v[72:75], v[76:79], v[112:127]
    v_mfma_f32_32x32x16_bf16 v[128:143], v[72:75], v[76:79], v[128:143]
    s_nop 10
    v_exp_f32 v112, v112
    v_exp_f32 v113, v113
    v_exp_f32 v114, v114
    v_exp_f32 v115, v115
    v_exp_f32 v116, v116
    v_exp_f32 v117, v117
    v_exp_f32 v118, v118
    v_exp_f32 v119, v119
    v_cvt_pk_bf16_f32 v112, v112, v113
    v_cvt_pk_bf16_f32 v113, v114, v115
    v_cvt_pk_bf16_f32 v114, v116, v117
    v_cvt_pk_bf16_f32 v115, v118, v119
    v_exp_f32 v120, v120
    v_exp_f32 v121, v121
    v_exp_f32 v122, v122
    s_waitcnt lgkmcnt(1)
    v_mfma_f32_32x32x16_bf16 v[96:111], v[60:63], v[112:115], 0
    s_mov_b64 exec, s[58:59]
    ds_read_b128 v[68:71], v93 offset:1280
    s_mov_b64 exec, -1
    v_exp_f32 v123, v123
    v_exp_f32 v124, v124
    v_exp_f32 v125, v125
    v_exp_f32 v126, v126
    v_mfma_f32_32x32x16_bf16 v[144:159], v[72:75], v[76:79], v[144:159]
    s_add_u32 m0, s48, 0
    s_nop 0
    buffer_load_dwordx4 v88, s[16:19], s0 offen offset:0 lds
    v_exp_f32 v127, v127
    s_and_b32 s28, s24, 3
    v_cvt_pk_bf16_f32 v120, v120, v121
    s_lshr_b32 s29, s24, 2
    v_cvt_pk_bf16_f32 v121, v122, v123
    s_lshl_b32 s52, s25, 2
    v_cvt_pk_bf16_f32 v122, v124, v125
    s_add_u32 s27, s52, s28
    v_cvt_pk_bf16_f32 v123, v126, v127
    v_exp_f32 v128, v128
    v_exp_f32 v129, v129
    v_exp_f32 v130, v130
    s_waitcnt lgkmcnt(1)
    v_mfma_f32_32x32x16_bf16 v[96:111], v[64:67], v[120:123], v[96:111]
    s_mov_b64 exec, s[58:59]
    ds_read_b128 v[60:63], v93 offset:1920
    s_mov_b64 exec, -1
    v_exp_f32 v131, v131
    v_exp_f32 v132, v132
    v_exp_f32 v133, v133
    v_exp_f32 v134, v134
    s_add_u32 m0, s48, 0
    s_nop 0
    buffer_load_dwordx4 v89, s[16:19], s0 offen offset:1024 lds
    v_exp_f32 v135, v135
    s_bfe_u32 s55, s2, 0x10007
    v_cvt_pk_bf16_f32 v128, v128, v129
    s_xor_b32 s55, s55, s29
    v_cvt_pk_bf16_f32 v129, v130, v131
    s_mul_i32 s52, s27, 20480
    v_cvt_pk_bf16_f32 v130, v132, v133
    s_add_u32 s52, s52, 7864320
    v_cvt_pk_bf16_f32 v131, v134, v135
    v_exp_f32 v136, v136
    v_exp_f32 v137, v137
    v_exp_f32 v138, v138
    s_waitcnt lgkmcnt(1)
    v_mfma_f32_32x32x16_bf16 v[96:111], v[68:71], v[128:131], v[96:111]
    s_mov_b64 exec, s[58:59]
    ds_read_b128 v[64:67], v93 offset:2560
    s_mov_b64 exec, -1
    v_exp_f32 v139, v139
    v_exp_f32 v140, v140
    v_exp_f32 v141, v141
    v_exp_f32 v142, v142
    v_mfma_f32_32x32x16_bf16 v[160:175], v[72:75], v[76:79], v[160:175]
    s_add_u32 m0, s48, 0
    s_nop 0
    buffer_load_dwordx4 v90, s[16:19], s0 offen offset:2048 lds
    v_exp_f32 v143, v143
    s_lshl_b32 s54, s55, 13
    v_cvt_pk_bf16_f32 v136, v136, v137
    s_add_u32 s54, s54, s52
    v_cvt_pk_bf16_f32 v137, v138, v139
    s_add_u32 s53, s26, 0
    v_cvt_pk_bf16_f32 v138, v140, v141
    s_and_b32 s53, s53, 7
    v_cvt_pk_bf16_f32 v139, v142, v143
    v_exp_f32 v144, v144
    v_exp_f32 v145, v145
    v_exp_f32 v146, v146
    s_waitcnt lgkmcnt(1)
    v_mfma_f32_32x32x16_bf16 v[96:111], v[60:63], v[136:139], v[96:111]
    s_mov_b64 exec, s[58:59]
    ds_read_b128 v[68:71], v93 offset:3200
    s_mov_b64 exec, -1
    v_exp_f32 v147, v147
    v_exp_f32 v148, v148
    v_exp_f32 v149, v149
    v_exp_f32 v150, v150
    s_add_u32 m0, s48, 0
    s_nop 0
    buffer_load_dwordx4 v91, s[16:19], s0 offen offset:3072 lds
    v_exp_f32 v151, v151
    s_lshl_b32 s53, s53, 10
    v_cvt_pk_bf16_f32 v144, v144, v145
    s_add_u32 s4, s53, s54
    v_cvt_pk_bf16_f32 v145, v146, v147
    s_add_u32 s53, s26, 1
    v_cvt_pk_bf16_f32 v146, v148, v149
    s_and_b32 s53, s53, 7
    v_cvt_pk_bf16_f32 v147, v150, v151
    v_exp_f32 v152, v152
    v_exp_f32 v153, v153
    v_exp_f32 v154, v154
    s_waitcnt lgkmcnt(1)
    v_mfma_f32_32x32x16_bf16 v[96:111], v[64:67], v[144:147], v[96:111]
    s_mov_b64 exec, s[58:59]
    ds_read_b128 v[60:63], v93 offset:3840
    s_mov_b64 exec, -1
    v_exp_f32 v155, v155
    v_exp_f32 v156, v156
    v_exp_f32 v157, v157
    v_exp_f32 v158, v158
    v_mfma_f32_32x32x16_bf16 v[176:191], v[72:75], v[76:79], v[176:191]
    s_add_u32 m0, s48, 4096
    s_nop 0
    buffer_load_dwordx4 v92, s[16:19], s0 offen offset:0 lds
    v_exp_f32 v159, v159
    s_lshl_b32 s53, s53, 10
    v_cvt_pk_bf16_f32 v152, v152, v153
    s_add_u32 s5, s53, s54
    v_cvt_pk_bf16_f32 v153, v154, v155
    s_add_u32 s53, s26, 2
    v_cvt_pk_bf16_f32 v154, v156, v157
    s_and_b32 s53, s53, 7
    v_cvt_pk_bf16_f32 v155, v158, v159
    v_exp_f32 v160, v160
    v_exp_f32 v161, v161
    v_exp_f32 v162, v162
    s_waitcnt lgkmcnt(1)
    v_mfma_f32_32x32x16_bf16 v[96:111], v[68:71], v[152:155], v[96:111]
    s_mov_b64 exec, s[58:59]
    ds_read_b128 v[64:67], v93 offset:4480
    s_mov_b64 exec, -1
    v_exp_f32 v163, v163
    v_exp_f32 v164, v164
    v_exp_f32 v165, v165
    v_exp_f32 v166, v166
    s_add_u32 m0, s48, 51200
    s_nop 0
    buffer_load_dwordx4 v88, s[16:19], s1 offen offset:0 lds
    v_exp_f32 v167, v167
    s_lshl_b32 s53, s53, 10
    v_cvt_pk_bf16_f32 v160, v160, v161
    s_add_u32 s6, s53, s54
    v_cvt_pk_bf16_f32 v161, v162, v163
    s_add_u32 s53, s26, 3
    v_cvt_pk_bf16_f32 v162, v164, v165
    s_and_b32 s53, s53, 7
    v_cvt_pk_bf16_f32 v163, v166, v167
    v_exp_f32 v168, v168
    v_exp_f32 v169, v169
    v_exp_f32 v170, v170
    s_waitcnt lgkmcnt(1)
    v_mfma_f32_32x32x16_bf16 v[96:111], v[60:63], v[160:163], v[96:111]
    s_mov_b64 exec, s[58:59]
    ds_read_b128 v[68:71], v93 offset:5120
    s_mov_b64 exec, -1
    v_exp_f32 v171, v171
    v_exp_f32 v172, v172
    v_exp_f32 v173, v173
    v_exp_f32 v174, v174
    v_mfma_f32_32x32x16_bf16 v[192:207], v[72:75], v[76:79], v[192:207]
    s_add_u32 m0, s48, 51200
    s_nop 0
    buffer_load_dwordx4 v89, s[16:19], s1 offen offset:1024 lds
    v_exp_f32 v175, v175
    s_lshl_b32 s53, s53, 10
    v_cvt_pk_bf16_f32 v168, v168, v169
    s_add_u32 s7, s53, s54
    v_cvt_pk_bf16_f32 v169, v170, v171
    s_add_u32 s53, s26, 4
    v_cvt_pk_bf16_f32 v170, v172, v173
    s_and_b32 s53, s53, 7
    v_cvt_pk_bf16_f32 v171, v174, v175
    v_exp_f32 v176, v176
    v_exp_f32 v177, v177
    v_exp_f32 v178, v178
    s_waitcnt lgkmcnt(1)
    v_mfma_f32_32x32x16_bf16 v[96:111], v[64:67], v[168:171], v[96:111]
    s_mov_b64 exec, s[58:59]
    ds_read_b128 v[60:63], v93 offset:5760
    s_mov_b64 exec, -1
    v_exp_f32 v179, v179
    v_exp_f32 v180, v180
    v_exp_f32 v181, v181
    v_exp_f32 v182, v182
    s_add_u32 m0, s48, 51200
    s_nop 0
    buffer_load_dwordx4 v90, s[16:19], s1 offen offset:2048 lds
    v_exp_f32 v183, v183
    s_lshl_b32 s53, s53, 10
    v_cvt_pk_bf16_f32 v176, v176, v177
    s_add_u32 s8, s53, s54
    v_cvt_pk_bf16_f32 v177, v178, v179
    s_add_u32 s53, s26, 5
    v_cvt_pk_bf16_f32 v178, v180, v181
    s_and_b32 s53, s53, 7
    v_cvt_pk_bf16_f32 v179, v182, v183
    v_exp_f32 v184, v184
    v_exp_f32 v185, v185
    v_exp_f32 v186, v186
    s_waitcnt lgkmcnt(1)
    v_mfma_f32_32x32x16_bf16 v[96:111], v[68:71], v[176:179], v[96:111]
    s_mov_b64 exec, s[58:59]
    ds_read_b128 v[64:67], v93 offset:6400
    s_mov_b64 exec, -1
    v_exp_f32 v187, v187
    v_exp_f32 v188, v188
    v_exp_f32 v189, v189
    v_exp_f32 v190, v190
    v_mfma_f32_32x32x16_bf16 v[208:223], v[72:75], v[76:79], v[208:223]
    s_add_u32 m0, s48, 51200
    s_nop 0
    buffer_load_dwordx4 v91, s[16:19], s1 offen offset:3072 lds
    buffer_load_dword v84, v85, s[20:23], s42 offen sc1
    v_exp_f32 v191, v191
    s_lshl_b32 s53, s53, 10
    v_cvt_pk_bf16_f32 v184, v184, v185
    s_add_u32 s9, s53, s54
    v_cvt_pk_bf16_f32 v185, v186, v187
    s_add_u32 s53, s26, 6
    v_cvt_pk_bf16_f32 v186, v188, v189
    s_and_b32 s53, s53, 7
    v_cvt_pk_bf16_f32 v187, v190, v191
    v_exp_f32 v192, v192
    v_exp_f32 v193, v193
    v_exp_f32 v194, v194
    s_waitcnt lgkmcnt(1)
    v_mfma_f32_32x32x16_bf16 v[96:111], v[60:63], v[184:187], v[96:111]
    s_mov_b64 exec, s[58:59]
    ds_read_b128 v[68:71], v93 offset:7040
    s_mov_b64 exec, -1
    v_exp_f32 v195, v195
    v_exp_f32 v196, v196
    v_exp_f32 v197, v197
    v_exp_f32 v198, v198
    s_add_u32 m0, s48, 55296
    s_nop 0
    buffer_load_dwordx4 v92, s[16:19], s1 offen offset:0 lds
    v_exp_f32 v199, v199
    s_lshl_b32 s53, s53, 10
    v_cvt_pk_bf16_f32 v192, v192, v193
    s_add_u32 s10, s53, s54
    v_cvt_pk_bf16_f32 v193, v194, v195
    s_add_u32 s53, s26, 7
    v_cvt_pk_bf16_f32 v194, v196, v197
    s_and_b32 s53, s53, 7
    v_cvt_pk_bf16_f32 v195, v198, v199
    v_exp_f32 v200, v200
    v_exp_f32 v201, v201
    v_exp_f32 v202, v202
    s_waitcnt lgkmcnt(1)
    v_mfma_f32_32x32x16_bf16 v[96:111], v[64:67], v[192:195], v[96:111]
    s_mov_b64 exec, s[58:59]
    ds_read_b128 v[60:63], v93 offset:7680
    s_mov_b64 exec, -1
    v_exp_f32 v203, v203
    v_exp_f32 v204, v204
    v_exp_f32 v205, v205
    v_exp_f32 v206, v206
    v_mfma_f32_32x32x16_bf16 v[224:239], v[72:75], v[76:79], v[224:239]
    v_exp_f32 v207, v207
    s_lshl_b32 s53, s53, 10
    v_cvt_pk_bf16_f32 v200, v200, v201
    s_add_u32 s11, s53, s54
    v_cvt_pk_bf16_f32 v201, v202, v203
    s_lshl_b32 s53, s55, 11
    v_cvt_pk_bf16_f32 v202, v204, v205
    s_add_u32 s56, s52, s53
    v_cvt_pk_bf16_f32 v203, v206, v207
    v_exp_f32 v208, v208
    v_exp_f32 v209, v209
    v_exp_f32 v210, v210
    s_waitcnt lgkmcnt(1)
    v_mfma_f32_32x32x16_bf16 v[96:111], v[68:71], v[200:203], v[96:111]
    s_mov_b64 exec, s[58:59]
    ds_read_b128 v[64:67], v93 offset:8320
    s_mov_b64 exec, -1
    v_exp_f32 v211, v211
    v_exp_f32 v212, v212
    v_exp_f32 v213, v213
    v_exp_f32 v214, v214
    v_exp_f32 v215, v215
    s_add_u32 s56, s56, 16384
    v_cvt_pk_bf16_f32 v208, v208, v209
    v_cvt_pk_bf16_f32 v209, v210, v211
    v_cvt_pk_bf16_f32 v210, v212, v213
    v_cvt_pk_bf16_f32 v211, v214, v215
    v_exp_f32 v216, v216
    v_exp_f32 v217, v217
    v_exp_f32 v218, v218
    s_waitcnt lgkmcnt(1)
    v_mfma_f32_32x32x16_bf16 v[96:111], v[60:63], v[208:211], v[96:111]
    s_mov_b64 exec, s[58:59]
    ds_read_b128 v[68:71], v93 offset:8960
    s_mov_b64 exec, -1
    v_exp_f32 v219, v219
    v_exp_f32 v220, v220
    v_exp_f32 v221, v221
    v_exp_f32 v222, v222
    v_mfma_f32_32x32x16_bf16 v[240:255], v[72:75], v[76:79], v[240:255]
    v_exp_f32 v223, v223
    v_cvt_pk_bf16_f32 v216, v216, v217
    v_cvt_pk_bf16_f32 v217, v218, v219
    v_cvt_pk_bf16_f32 v218, v220, v221
    v_cvt_pk_bf16_f32 v219, v222, v223
    v_exp_f32 v224, v224
    v_exp_f32 v225, v225
    v_exp_f32 v226, v226
    s_waitcnt lgkmcnt(1)
    v_mfma_f32_32x32x16_bf16 v[96:111], v[64:67], v[216:219], v[96:111]
    s_mov_b64 exec, s[58:59]
    ds_read_b128 v[60:63], v93 offset:9600
    s_mov_b64 exec, -1
    v_exp_f32 v227, v227
    v_exp_f32 v228, v228
    v_exp_f32 v229, v229
    v_exp_f32 v230, v230
    v_exp_f32 v231, v231
    v_cvt_pk_bf16_f32 v224, v224, v225
    v_cvt_pk_bf16_f32 v225, v226, v227
    v_cvt_pk_bf16_f32 v226, v228, v229
    v_cvt_pk_bf16_f32 v227, v230, v231
    v_exp_f32 v232, v232
    v_exp_f32 v233, v233
    v_exp_f32 v234, v234
    s_waitcnt lgkmcnt(1)
    v_mfma_f32_32x32x16_bf16 v[96:111], v[68:71], v[224:227], v[96:111]
    s_mov_b64 exec, s[58:59]
    ds_read_b128 v[64:67], v93 offset:10240
    s_mov_b64 exec, -1
    v_exp_f32 v235, v235
    v_exp_f32 v236, v236
    v_exp_f32 v237, v237
    v_exp_f32 v238, v238
    v_exp_f32 v239, v239
    v_cvt_pk_bf16_f32 v232, v232, v233
    v_cvt_pk_bf16_f32 v233, v234, v235
    v_cvt_pk_bf16_f32 v234, v236, v237
    v_cvt_pk_bf16_f32 v235, v238, v239
    v_exp_f32 v240, v240
    v_exp_f32 v241, v241
    v_exp_f32 v242, v242
    s_waitcnt lgkmcnt(1)
    v_mfma_f32_32x32x16_bf16 v[96:111], v[60:63], v[232:235], v[96:111]
    s_mov_b64 exec, s[58:59]
    ds_read_b128 v[68:71], v93 offset:10880
    s_mov_b64 exec, -1
    v_exp_f32 v243, v243
    v_exp_f32 v244, v244
    v_exp_f32 v245, v245
    v_exp_f32 v246, v246
    v_exp_f32 v247, v247
    v_cvt_pk_bf16_f32 v240, v240, v241
    v_cvt_pk_bf16_f32 v241, v242, v243
    v_cvt_pk_bf16_f32 v242, v244, v245
    v_cvt_pk_bf16_f32 v243, v246, v247
    v_exp_f32 v248, v248
    v_exp_f32 v249, v249
    v_exp_f32 v250, v250
    s_waitcnt lgkmcnt(1)
    v_mfma_f32_32x32x16_bf16 v[96:111], v[64:67], v[240:243], v[96:111]
    v_exp_f32 v251, v251
    v_exp_f32 v252, v252
    v_exp_f32 v253, v253
    v_exp_f32 v254, v254
    v_exp_f32 v255, v255
    v_cvt_pk_bf16_f32 v248, v248, v249
    v_cvt_pk_bf16_f32 v249, v250, v251
    v_cvt_pk_bf16_f32 v250, v252, v253
    v_cvt_pk_bf16_f32 v251, v254, v255
    s_waitcnt lgkmcnt(0)
    s_nop 0
    v_mfma_f32_32x32x16_bf16 v[96:111], v[68:71], v[248:251], v[96:111]
    v_and_b32 v6, 15, v1
    v_lshlrev_b32 v35, 9, v3
    v_bfe_u32 v5, v1, 4, 1
    v_lshl_add_u32 v35, v5, 7, v35
    s_nop 7
    v_rcp_f32 v7, v108
    s_nop 0
    v_mul_f32 v96, v96, v7
    v_mul_f32 v97, v97, v7
    v_mul_f32 v98, v98, v7
    v_mul_f32 v99, v99, v7
    v_mul_f32 v100, v100, v7
    v_mul_f32 v101, v101, v7
    v_mul_f32 v102, v102, v7
    v_mul_f32 v103, v103, v7
    v_mul_f32 v104, v104, v7
    v_mul_f32 v105, v105, v7
    v_mul_f32 v106, v106, v7
    v_mul_f32 v107, v107, v7
    v_cvt_pk_bf16_f32 v96, v96, v97
    v_cvt_pk_bf16_f32 v97, v98, v99
    v_cvt_pk_bf16_f32 v98, v100, v101
    v_cvt_pk_bf16_f32 v99, v102, v103
    v_cvt_pk_bf16_f32 v100, v104, v105
    v_cvt_pk_bf16_f32 v101, v106, v107
    v_min_u32 v96, -2, v96
    v_min_u32 v100, -2, v100
    buffer_store_dwordx4 v[96:99], v94, s[20:23], s50 offen sc1
    s_mov_b32 exec_hi, 0
    buffer_store_dwordx2 v[100:101], v95, s[20:23], s51 offen sc1
    s_mov_b64 exec, -1
    v_lshl_add_u32 v35, v6, 3, v35
    s_waitcnt vmcnt(2)
    s_mov_b32 exec_lo, -1
    s_mov_b32 exec_hi, -1
    s_mov_b32 s61, 0
    v_cmp_ne_u32 vcc, s3, v84
    s_nop 1
    s_cbranch_vccz mega_kernel_pd3
mega_kernel_pl3:
    buffer_load_dword v84, v85, s[20:23], s42 offen sc1
    s_waitcnt vmcnt(0)
    v_cmp_ne_u32 vcc, s3, v84
    s_add_u32 s61, s61, 1
    s_cbranch_vccz mega_kernel_pd3
    s_cmp_lt_u32 s61, 40000
    s_cbranch_scc1 mega_kernel_pl3
mega_kernel_pd3:
    s_mov_b64 exec, -1
    s_setprio 0
    s_barrier
    s_cmp_lg_u32 s29, 0
    s_cbranch_scc1 mega_kernel_c_e1
    buffer_load_dwordx4 v[56:59], v2, s[20:23], s4 offen sc1
    buffer_load_dwordx4 v[60:63], v2, s[20:23], s5 offen sc1
    buffer_load_dwordx4 v[64:67], v2, s[20:23], s6 offen sc1
    buffer_load_dwordx4 v[68:71], v2, s[20:23], s7 offen sc1
    buffer_load_dwordx4 v[72:75], v2, s[20:23], s8 offen sc1
    buffer_load_dwordx4 v[76:79], v2, s[20:23], s9 offen sc1
    buffer_load_dwordx4 v[80:83], v2, s[20:23], s10 offen sc1
    buffer_load_dwordx4 v[84:87], v2, s[20:23], s11 offen sc1
    buffer_load_dwordx2 v[88:89], v35, s[20:23], s56 offen offset:0 sc1
    buffer_load_dwordx2 v[90:91], v35, s[20:23], s56 offen offset:256 sc1
    buffer_load_dwordx2 v[92:93], v35, s[20:23], s56 offen offset:1024 sc1
    buffer_load_dwordx2 v[94:95], v35, s[20:23], s56 offen offset:1280 sc1
mega_kernel_c_e1:
    v_add_u32 v6, s43, v2
    ds_write_b128 v6, v[20:23] offset:0
    ds_write_b128 v6, v[24:27] offset:1024
    ds_write_b128 v6, v[28:31] offset:2048
    s_and_b32 s52, s2, 7
    s_lshr_b32 s53, s2, 3
    s_lshr_b32 s54, s53, 3
    s_lshl_b32 s25, s52, 2
    s_add_u32 s25, s25, s54
    s_and_b32 s26, s53, 7
    s_and_b32 s28, s24, 3
    s_lshr_b32 s29, s24, 2
    v_bfe_u32 v5, v1, 2, 3
    v_lshl_add_u32 v5, v3, 4, v5
    v_mul_u32_u24 v5, 160, v5
    v_and_b32 v6, 3, v1
    v_lshl_add_u32 v5, v6, 3, v5
    s_mul_i32 s53, s29, 51200
    v_add_u32 v20, s53, v5
    v_add_u32 v21, 0, v20
    ds_read_b64_tr_b16 v[96:97], v20 offset:0
    ds_read_b64_tr_b16 v[98:99], v20 offset:1280
    ds_read_b64_tr_b16 v[100:101], v20 offset:32
    ds_read_b64_tr_b16 v[102:103], v20 offset:1312
    ds_read_b64_tr_b16 v[104:105], v20 offset:64
    ds_read_b64_tr_b16 v[106:107], v20 offset:1344
    ds_read_b64_tr_b16 v[108:109], v20 offset:96
    ds_read_b64_tr_b16 v[110:111], v20 offset:1376
    ds_read_b64_tr_b16 v[112:113], v20 offset:128
    ds_read_b64_tr_b16 v[114:115], v20 offset:1408
    ds_read_b64_tr_b16 v[116:117], v20 offset:5120
    ds_read_b64_tr_b16 v[118:119], v20 offset:6400
    ds_read_b64_tr_b16 v[120:121], v20 offset:5152
    ds_read_b64_tr_b16 v[122:123], v20 offset:6432
    ds_read_b64_tr_b16 v[124:125], v20 offset:5184
    ds_read_b64_tr_b16 v[126:127], v20 offset:6464
    ds_read_b64_tr_b16 v[128:129], v20 offset:5216
    ds_read_b64_tr_b16 v[130:131], v20 offset:6496
    ds_read_b64_tr_b16 v[132:133], v20 offset:5248
    ds_read_b64_tr_b16 v[134:135], v20 offset:6528
    ds_read_b64_tr_b16 v[136:137], v20 offset:10240
    ds_read_b64_tr_b16 v[138:139], v20 offset:11520
    ds_read_b64_tr_b16 v[140:141], v20 offset:10272
    ds_read_b64_tr_b16 v[142:143], v20 offset:11552
    ds_read_b64_tr_b16 v[144:145], v20 offset:10304
    ds_read_b64_tr_b16 v[146:147], v20 offset:11584
    ds_read_b64_tr_b16 v[148:149], v20 offset:10336
    ds_read_b64_tr_b16 v[150:151], v20 offset:11616
    ds_read_b64_tr_b16 v[152:153], v20 offset:10368
    ds_read_b64_tr_b16 v[154:155], v20 offset:11648
    s_cmp_eq_u32 s29, 0
    s_cbranch_scc1 mega_kernel_c_l1
    buffer_load_dwordx4 v[56:59], v2, s[20:23], s4 offen sc1
    buffer_load_dwordx4 v[60:63], v2, s[20:23], s5 offen sc1
    buffer_load_dwordx4 v[64:67], v2, s[20:23], s6 offen sc1
    buffer_load_dwordx4 v[68:71], v2, s[20:23], s7 offen sc1
    buffer_load_dwordx4 v[72:75], v2, s[20:23], s8 offen sc1
    buffer_load_dwordx4 v[76:79], v2, s[20:23], s9 offen sc1
    buffer_load_dwordx4 v[80:83], v2, s[20:23], s10 offen sc1
    buffer_load_dwordx4 v[84:87], v2, s[20:23], s11 offen sc1
    buffer_load_dwordx2 v[88:89], v35, s[20:23], s56 offen offset:0 sc1
    buffer_load_dwordx2 v[90:91], v35, s[20:23], s56 offen offset:256 sc1
    buffer_load_dwordx2 v[92:93], v35, s[20:23], s56 offen offset:1024 sc1
    buffer_load_dwordx2 v[94:95], v35, s[20:23], s56 offen offset:1280 sc1
mega_kernel_c_l1:
    ds_read_b64_tr_b16 v[156:157], v20 offset:15360
    ds_read_b64_tr_b16 v[158:159], v20 offset:16640
    ds_read_b64_tr_b16 v[160:161], v20 offset:15392
    ds_read_b64_tr_b16 v[162:163], v20 offset:16672
    ds_read_b64_tr_b16 v[164:165], v20 offset:15424
    ds_read_b64_tr_b16 v[166:167], v20 offset:16704
    ds_read_b64_tr_b16 v[168:169], v20 offset:15456
    ds_read_b64_tr_b16 v[170:171], v20 offset:16736
    ds_read_b64_tr_b16 v[172:173], v20 offset:15488
    ds_read_b64_tr_b16 v[174:175], v20 offset:16768
    ds_read_b64_tr_b16 v[176:177], v20 offset:20480
    ds_read_b64_tr_b16 v[178:179], v20 offset:21760
    ds_read_b64_tr_b16 v[180:181], v20 offset:20512
    ds_read_b64_tr_b16 v[182:183], v20 offset:21792
    ds_read_b64_tr_b16 v[184:185], v20 offset:20544
    ds_read_b64_tr_b16 v[186:187], v20 offset:21824
    ds_read_b64_tr_b16 v[188:189], v20 offset:20576
    ds_read_b64_tr_b16 v[190:191], v20 offset:21856
    ds_read_b64_tr_b16 v[192:193], v20 offset:20608
    ds_read_b64_tr_b16 v[194:195], v20 offset:21888
    ds_read_b64_tr_b16 v[196:197], v20 offset:25600
    ds_read_b64_tr_b16 v[198:199], v20 offset:26880
    ds_read_b64_tr_b16 v[200:201], v20 offset:25632
    ds_read_b64_tr_b16 v[202:203], v20 offset:26912
    ds_read_b64_tr_b16 v[204:205], v20 offset:25664
    ds_read_b64_tr_b16 v[206:207], v20 offset:26944
    ds_read_b64_tr_b16 v[208:209], v20 offset:25696
    ds_read_b64_tr_b16 v[210:211], v20 offset:26976
    ds_read_b64_tr_b16 v[212:213], v20 offset:25728
    ds_read_b64_tr_b16 v[214:215], v20 offset:27008
    v_lshrrev_b32 v6, 4, v1
    v_and_b32 v31, 15, v1
    s_lshl_b32 s52, s25, 2
    s_add_u32 s27, s52, s28
    s_mul_i32 s52, s27, 20480
    s_mul_i32 s53, s26, 160
    s_add_u32 s30, s52, s53
    v_mul_u32_u24 v22, 1280, v31
    v_lshl_add_u32 v23, v6, 3, v22
    v_lshl_add_u32 v22, v3, 4, v22
    v_bfe_u32 v5, v1, 4, 1
    v_lshl_add_u32 v22, v5, 5, v22
    s_mul_i32 s52, s28, 5120
    s_add_u32 s52, s52, 106496
    v_add_u32 v24, s52, v2
    s_lshr_b32 s52, s27, 1
    s_mul_i32 s52, s52, 40960
    s_mul_i32 s53, s26, 5120
    s_add_u32 s52, s52, s53
    s_and_b32 s53, s28, 1
    s_lshl_b32 s53, s53, 8
    s_add_u32 s52, s52, s53
    s_add_u32 s31, s52, 10485760
    v_bfe_u32 v5, v1, 4, 1
    v_lshlrev_b32 v6, 9, v3
    v_lshl_add_u32 v6, v31, 4, v6
    v_lshl_add_u32 v25, v5, 10, v6
    v_add_u32 v26, 4096, v6
    s_lshl_b32 s52, s27, 3
    s_add_u32 s52, s52, s26
    s_lshl_b32 s52, s52, 8
    s_add_u32 s57, s52, 21364736
    v_lshlrev_b32 v27, 4, v31
    s_mov_b32 s59, 0x3f803f80
    v_lshlrev_b32 v36, 16, v10
    v_and_b32 v37, 0xffff0000, v10
    v_lshlrev_b32 v38, 16, v11
    v_and_b32 v39, 0xffff0000, v11
    v_lshlrev_b32 v40, 16, v12
    v_and_b32 v41, 0xffff0000, v12
    v_lshlrev_b32 v42, 16, v13
    v_and_b32 v43, 0xffff0000, v13
    v_lshlrev_b32 v44, 16, v14
    v_and_b32 v45, 0xffff0000, v14
    v_lshlrev_b32 v46, 16, v15
    v_and_b32 v47, 0xffff0000, v15
    v_lshlrev_b32 v48, 16, v16
    v_and_b32 v49, 0xffff0000, v16
    v_lshlrev_b32 v50, 16, v17
    v_and_b32 v51, 0xffff0000, v17
    v_lshlrev_b32 v52, 16, v18
    v_and_b32 v53, 0xffff0000, v18
    v_lshlrev_b32 v54, 16, v19
    v_and_b32 v55, 0xffff0000, v19
    s_mov_b32 s61, 0
    s_waitcnt lgkmcnt(0)
    s_lshl_b32 s52, s29, 2
    s_add_u32 s52, s52, 102400
    v_mov_b32 v7, s52
    v_mov_b32 v8, 1
    s_mov_b64 exec, 1
    ds_add_u32 v7, v8
    s_mov_b64 exec, -1
    s_waitcnt vmcnt(11)
mega_kernel_c_c0:
    v_cmp_eq_u32 vcc, -1, v56
    s_nop 1
    s_cbranch_vccnz mega_kernel_c_s0
    v_mfma_f32_16x16x32_bf16 v[36:39], v[96:99], v[56:59], v[36:39]
    ds_read_b64_tr_b16 v[216:217], v20 offset:30720
    ds_read_b64_tr_b16 v[218:219], v20 offset:32000
    v_mfma_f32_16x16x32_bf16 v[40:43], v[100:103], v[56:59], v[40:43]
    ds_read_b64_tr_b16 v[220:221], v20 offset:30752
    ds_read_b64_tr_b16 v[222:223], v20 offset:32032
    v_mfma_f32_16x16x32_bf16 v[44:47], v[104:107], v[56:59], v[44:47]
    ds_read_b64_tr_b16 v[224:225], v20 offset:30784
    ds_read_b64_tr_b16 v[226:227], v20 offset:32064
    s_waitcnt vmcnt(10)
mega_kernel_c_c1:
    v_cmp_eq_u32 vcc, -1, v60
    s_nop 1
    s_cbranch_vccnz mega_kernel_c_s1
    v_mfma_f32_16x16x32_bf16 v[48:51], v[108:111], v[56:59], v[48:51]
    ds_read_b64_tr_b16 v[228:229], v20 offset:30816
    ds_read_b64_tr_b16 v[230:231], v20 offset:32096
    v_mfma_f32_16x16x32_bf16 v[52:55], v[112:115], v[56:59], v[52:55]
    ds_read_b64_tr_b16 v[232:233], v20 offset:30848
    ds_read_b64_tr_b16 v[234:235], v20 offset:32128
    v_mfma_f32_16x16x32_bf16 v[36:39], v[116:119], v[60:63], v[36:39]
    ds_read_b64_tr_b16 v[236:237], v20 offset:35840
    ds_read_b64_tr_b16 v[238:239], v20 offset:37120
    v_mfma_f32_16x16x32_bf16 v[40:43], v[120:123], v[60:63], v[40:43]
    ds_read_b64_tr_b16 v[240:241], v20 offset:35872
    ds_read_b64_tr_b16 v[242:243], v20 offset:37152
    v_mfma_f32_16x16x32_bf16 v[44:47], v[124:127], v[60:63], v[44:47]
    ds_read_b64_tr_b16 v[244:245], v20 offset:35904
    ds_read_b64_tr_b16 v[246:247], v20 offset:37184
    s_waitcnt vmcnt(9)
mega_kernel_c_c2:
    v_cmp_eq_u32 vcc, -1, v64
    s_nop 1
    s_cbranch_vccnz mega_kernel_c_s2
    v_mfma_f32_16x16x32_bf16 v[48:51], v[128:131], v[60:63], v[48:51]
    ds_read_b64_tr_b16 v[248:249], v20 offset:35936
    ds_read_b64_tr_b16 v[250:251], v20 offset:37216
    v_mfma_f32_16x16x32_bf16 v[52:55], v[132:135], v[60:63], v[52:55]
    ds_read_b64_tr_b16 v[252:253], v20 offset:35968
    ds_read_b64_tr_b16 v[254:255], v20 offset:37248
    v_mfma_f32_16x16x32_bf16 v[36:39], v[136:139], v[64:67], v[36:39]
    ds_read_b64_tr_b16 v[96:97], v20 offset:40960
    ds_read_b64_tr_b16 v[98:99], v20 offset:42240
    v_mfma_f32_16x16x32_bf16 v[40:43], v[140:143], v[64:67], v[40:43]
    ds_read_b64_tr_b16 v[100:101], v20 offset:40992
    ds_read_b64_tr_b16 v[102:103], v20 offset:42272
    v_mfma_f32_16x16x32_bf16 v[44:47], v[144:147], v[64:67], v[44:47]
    ds_read_b64_tr_b16 v[104:105], v20 offset:41024
    ds_read_b64_tr_b16 v[106:107], v20 offset:42304
    s_waitcnt vmcnt(8)
mega_kernel_c_c3:
    v_cmp_eq_u32 vcc, -1, v68
    s_nop 1
    s_cbranch_vccnz mega_kernel_c_s3
    v_mfma_f32_16x16x32_bf16 v[48:51], v[148:151], v[64:67], v[48:51]
    ds_read_b64_tr_b16 v[108:109], v20 offset:41056
    ds_read_b64_tr_b16 v[110:111], v20 offset:42336
    v_mfma_f32_16x16x32_bf16 v[52:55], v[152:155], v[64:67], v[52:55]
    ds_read_b64_tr_b16 v[112:113], v20 offset:41088
    ds_read_b64_tr_b16 v[114:115], v20 offset:42368
    v_mfma_f32_16x16x32_bf16 v[36:39], v[156:159], v[68:71], v[36:39]
    ds_read_b64_tr_b16 v[116:117], v20 offset:46080
    ds_read_b64_tr_b16 v[118:119], v20 offset:47360
    v_mfma_f32_16x16x32_bf16 v[40:43], v[160:163], v[68:71], v[40:43]
    ds_read_b64_tr_b16 v[120:121], v20 offset:46112
    ds_read_b64_tr_b16 v[122:123], v20 offset:47392
    v_mfma_f32_16x16x32_bf16 v[44:47], v[164:167], v[68:71], v[44:47]
    ds_read_b64_tr_b16 v[124:125], v20 offset:46144
    ds_read_b64_tr_b16 v[126:127], v20 offset:47424
    s_waitcnt vmcnt(7)
mega_kernel_c_c4:
    v_cmp_eq_u32 vcc, -1, v72
    s_nop 1
    s_cbranch_vccnz mega_kernel_c_s4
    v_mfma_f32_16x16x32_bf16 v[48:51], v[168:171], v[68:71], v[48:51]
    ds_read_b64_tr_b16 v[128:129], v20 offset:46176
    ds_read_b64_tr_b16 v[130:131], v20 offset:47456
    v_mfma_f32_16x16x32_bf16 v[52:55], v[172:175], v[68:71], v[52:55]
    ds_read_b64_tr_b16 v[132:133], v20 offset:46208
    ds_read_b64_tr_b16 v[134:135], v20 offset:47488
    v_mfma_f32_16x16x32_bf16 v[36:39], v[176:179], v[72:75], v[36:39]
    v_mfma_f32_16x16x32_bf16 v[40:43], v[180:183], v[72:75], v[40:43]
    v_mfma_f32_16x16x32_bf16 v[44:47], v[184:187], v[72:75], v[44:47]
    s_waitcnt vmcnt(6)
mega_kernel_c_c5:
    v_cmp_eq_u32 vcc, -1, v76
    s_nop 1
    s_cbranch_vccnz mega_kernel_c_s5
    v_mfma_f32_16x16x32_bf16 v[48:51], v[188:191], v[72:75], v[48:51]
    v_mfma_f32_16x16x32_bf16 v[52:55], v[192:195], v[72:75], v[52:55]
    v_mfma_f32_16x16x32_bf16 v[36:39], v[196:199], v[76:79], v[36:39]
    v_mfma_f32_16x16x32_bf16 v[40:43], v[200:203], v[76:79], v[40:43]
    v_mfma_f32_16x16x32_bf16 v[44:47], v[204:207], v[76:79], v[44:47]
    s_waitcnt vmcnt(5)
mega_kernel_c_c6:
    v_cmp_eq_u32 vcc, -1, v80
    s_nop 1
    s_cbranch_vccnz mega_kernel_c_s6
    v_mfma_f32_16x16x32_bf16 v[48:51], v[208:211], v[76:79], v[48:51]
    v_mfma_f32_16x16x32_bf16 v[52:55], v[212:215], v[76:79], v[52:55]
    s_waitcnt lgkmcnt(0)
    v_mfma_f32_16x16x32_bf16 v[36:39], v[216:219], v[80:83], v[36:39]
    v_mfma_f32_16x16x32_bf16 v[40:43], v[220:223], v[80:83], v[40:43]
    v_mfma_f32_16x16x32_bf16 v[44:47], v[224:227], v[80:83], v[44:47]
    s_waitcnt vmcnt(4)
mega_kernel_c_c7:
    v_cmp_eq_u32 vcc, -1, v84
    s_nop 1
    s_cbranch_vccnz mega_kernel_c_s7
    v_mfma_f32_16x16x32_bf16 v[48:51], v[228:231], v[80:83], v[48:51]
    v_mfma_f32_16x16x32_bf16 v[52:55], v[232:235], v[80:83], v[52:55]
    s_waitcnt lgkmcnt(0)
    v_mfma_f32_16x16x32_bf16 v[36:39], v[236:239], v[84:87], v[36:39]
    v_mfma_f32_16x16x32_bf16 v[40:43], v[240:243], v[84:87], v[40:43]
    v_mfma_f32_16x16x32_bf16 v[44:47], v[244:247], v[84:87], v[44:47]
    s_waitcnt vmcnt(2)
mega_kernel_c_c8:
    v_max_u32 v5, v88, v90
    v_cmp_eq_u32 vcc, -1, v5
    s_nop 1
    s_cbranch_vccnz mega_kernel_c_s8
    v_mfma_f32_16x16x32_bf16 v[48:51], v[248:251], v[84:87], v[48:51]
    v_mfma_f32_16x16x32_bf16 v[52:55], v[252:255], v[84:87], v[52:55]
    s_waitcnt lgkmcnt(0)
    v_mfma_f32_16x16x32_bf16 v[36:39], v[96:99], v[88:91], v[36:39]
    v_mfma_f32_16x16x32_bf16 v[40:43], v[100:103], v[88:91], v[40:43]
    v_mfma_f32_16x16x32_bf16 v[44:47], v[104:107], v[88:91], v[44:47]
    s_waitcnt vmcnt(0)
mega_kernel_c_c9:
    v_max_u32 v5, v92, v94
    v_cmp_eq_u32 vcc, -1, v5
    s_nop 1
    s_cbranch_vccnz mega_kernel_c_s9
    v_mfma_f32_16x16x32_bf16 v[48:51], v[108:111], v[88:91], v[48:51]
    v_mfma_f32_16x16x32_bf16 v[52:55], v[112:115], v[88:91], v[52:55]
    s_waitcnt lgkmcnt(0)
    s_cmp_eq_u32 s29, 0
    s_cbranch_scc1 mega_kernel_c_nf
    s_barrier
    s_setprio 3
    ds_read_b128 v[136:139], v24 offset:0
    ds_read_b128 v[140:143], v24 offset:1024
    ds_read_b128 v[144:147], v24 offset:2048
    ds_read_b128 v[148:151], v24 offset:3072
    ds_read_b128 v[152:155], v24 offset:4096
mega_kernel_c_nf:
    v_mfma_f32_16x16x32_bf16 v[36:39], v[116:119], v[92:95], v[36:39]
    v_mfma_f32_16x16x32_bf16 v[40:43], v[120:123], v[92:95], v[40:43]
    v_mfma_f32_16x16x32_bf16 v[44:47], v[124:127], v[92:95], v[44:47]
    v_mfma_f32_16x16x32_bf16 v[48:51], v[128:131], v[92:95], v[48:51]
    v_mfma_f32_16x16x32_bf16 v[52:55], v[132:135], v[92:95], v[52:55]
    s_cmp_lg_u32 s29, 0
    s_cbranch_scc1 mega_kernel_c_k1
    v_and_b32 v5, 3, v1
    s_mov_b32 s52, 102400
    v_lshl_add_u32 v7, v5, 2, s52
    ds_read_b32 v8, v7
    v_lshlrev_b32 v5, 3, v5
    s_mov_b32 s52, 0x4
    v_bfe_u32 v5, s52, v5, 8
    s_mov_b32 s61, 0
mega_kernel_c_w:
    s_waitcnt lgkmcnt(0)
    v_cmp_gt_u32 vcc, v5, v8
    s_add_u32 s61, s61, 1
    s_cmp_gt_u32 s61, 40000
    s_cbranch_vccz mega_kernel_c_wx
    s_cbranch_scc1 mega_kernel_c_wx
    ds_read_b32 v8, v7
    s_branch mega_kernel_c_w
mega_kernel_c_wx:
    ds_write_b128 v24, v[36:39] offset:0
    ds_write_b128 v24, v[40:43] offset:1024
    ds_write_b128 v24, v[44:47] offset:2048
    ds_write_b128 v24, v[48:51] offset:3072
    ds_write_b128 v24, v[52:55] offset:4096
    s_add_u32 m0, s39, 0
    s_nop 0
    buffer_load_dwordx4 v32, s[32:35], s99 offen offset:0 lds
    buffer_load_dwordx4 v33, s[32:35], s99 offen offset:1024 lds
    buffer_load_dwordx4 v34, s[32:35], s99 offen offset:2048 lds
    s_add_u32 s49, s99, 49152
    s_add_u32 m0, s39, 3072
    s_nop 0
    buffer_load_dwordx4 v32, s[32:35], s49 offen offset:0 lds
    buffer_load_dwordx4 v33, s[32:35], s49 offen offset:1024 lds
    buffer_load_dwordx4 v34, s[32:35], s49 offen offset:2048 lds
    s_add_u32 s99, s99, 196608
    s_cmp_ge_u32 s99, s38
    s_cselect_b32 s52, 1966080, 0
    s_sub_u32 s99, s99, s52
    s_waitcnt lgkmcnt(0)
    s_barrier
    s_branch mega_kernel_c_k0
mega_kernel_c_k1:
    s_waitcnt lgkmcnt(4)
    s_nop 0
    v_pk_add_f32 v[36:37], v[36:37], v[136:137]
    v_pk_add_f32 v[38:39], v[38:39], v[138:139]
    v_cvt_pk_bf16_f32 v10, v36, v37
    v_cvt_pk_bf16_f32 v11, v38, v39
    s_waitcnt lgkmcnt(3)
    v_pk_add_f32 v[40:41], v[40:41], v[140:141]
    v_pk_add_f32 v[42:43], v[42:43], v[142:143]
    v_cvt_pk_bf16_f32 v12, v40, v41
    v_cvt_pk_bf16_f32 v13, v42, v43
    s_waitcnt lgkmcnt(2)
    v_pk_add_f32 v[44:45], v[44:45], v[144:145]
    v_pk_add_f32 v[46:47], v[46:47], v[146:147]
    v_cvt_pk_bf16_f32 v14, v44, v45
    v_cvt_pk_bf16_f32 v15, v46, v47
    s_waitcnt lgkmcnt(1)
    v_pk_add_f32 v[48:49], v[48:49], v[148:149]
    v_pk_add_f32 v[50:51], v[50:51], v[150:151]
    v_cvt_pk_bf16_f32 v16, v48, v49
    v_cvt_pk_bf16_f32 v17, v50, v51
    s_waitcnt lgkmcnt(0)
    v_pk_add_f32 v[52:53], v[52:53], v[152:153]
    v_pk_add_f32 v[54:55], v[54:55], v[154:155]
    v_cvt_pk_bf16_f32 v18, v52, v53
    v_cvt_pk_bf16_f32 v19, v54, v55
    v_mov_b64 v[56:57], v[18:19]
    v_mov_b64 v[58:59], v[18:19]
    v_mov_b64 v[60:61], 0
    v_mov_b64 v[62:63], 0
    v_permlane16_swap_b32 v10, v12
    v_permlane16_swap_b32 v11, v13
    v_permlane16_swap_b32 v14, v16
    v_permlane16_swap_b32 v15, v17
    v_permlane16_swap_b32 v56, v58
    v_permlane16_swap_b32 v57, v59
    v_min_u32 v10, -2, v10
    v_min_u32 v14, -2, v14
    v_min_u32 v56, -2, v56
    buffer_store_dwordx4 v[10:13], v25, s[20:23], s31 offen sc1
    buffer_store_dwordx4 v[14:17], v25, s[20:23], s31 offen offset:2048 sc1
    s_mov_b32 exec_lo, 0xffff
    s_mov_b32 exec_hi, 0xffff
    buffer_store_dwordx4 v[56:59], v26, s[20:23], s31 offen sc1
    s_mov_b64 exec, -1
    v_dot2c_f32_bf16 v60, s59, v10
    v_dot2c_f32_bf16 v61, v10, v10
    v_dot2c_f32_bf16 v62, s59, v11
    v_dot2c_f32_bf16 v63, v11, v11
    v_dot2c_f32_bf16 v60, s59, v12
    v_dot2c_f32_bf16 v61, v12, v12
    v_dot2c_f32_bf16 v62, s59, v13
    v_dot2c_f32_bf16 v63, v13, v13
    v_dot2c_f32_bf16 v60, s59, v14
    v_dot2c_f32_bf16 v61, v14, v14
    v_dot2c_f32_bf16 v62, s59, v15
    v_dot2c_f32_bf16 v63, v15, v15
    v_dot2c_f32_bf16 v60, s59, v16
    v_dot2c_f32_bf16 v61, v16, v16
    v_dot2c_f32_bf16 v62, s59, v17
    v_dot2c_f32_bf16 v63, v17, v17
    v_dot2c_f32_bf16 v60, s59, v18
    v_dot2c_f32_bf16 v61, v18, v18
    v_dot2c_f32_bf16 v62, s59, v19
    v_dot2c_f32_bf16 v63, v19, v19
    s_nop 2
    v_pk_add_f32 v[60:61], v[60:61], v[62:63]
    v_mov_b64 v[62:63], v[60:61]
    s_nop 1
    v_permlane16_swap_b32 v62, v60
    v_permlane16_swap_b32 v63, v61
    v_pk_add_f32 v[60:61], v[60:61], v[62:63]
    v_mov_b64 v[62:63], v[60:61]
    s_nop 1
    v_permlane32_swap_b32 v62, v60
    v_permlane32_swap_b32 v63, v61
    v_pk_add_f32 v[60:61], v[60:61], v[62:63]
    v_mov_b32 v62, s3
    s_waitcnt vmcnt(0)
    s_mov_b64 exec, 0xffff
    buffer_store_dwordx4 v[60:63], v27, s[20:23], s57 offen sc1
    s_mov_b64 exec, -1
    s_branch mega_kernel_c_pub
mega_kernel_c_s0:
    s_call_b64 s[50:51], mega_kernel_c_r
    s_branch mega_kernel_c_c0
mega_kernel_c_s1:
    s_call_b64 s[50:51], mega_kernel_c_r
    s_branch mega_kernel_c_c1
mega_kernel_c_s2:
    s_call_b64 s[50:51], mega_kernel_c_r
    s_branch mega_kernel_c_c2
mega_kernel_c_s3:
    s_call_b64 s[50:51], mega_kernel_c_r
    s_branch mega_kernel_c_c3
mega_kernel_c_s4:
    s_call_b64 s[50:51], mega_kernel_c_r
    s_branch mega_kernel_c_c4
mega_kernel_c_s5:
    s_call_b64 s[50:51], mega_kernel_c_r
    s_branch mega_kernel_c_c5
mega_kernel_c_s6:
    s_call_b64 s[50:51], mega_kernel_c_r
    s_branch mega_kernel_c_c6
mega_kernel_c_s7:
    s_call_b64 s[50:51], mega_kernel_c_r
    s_branch mega_kernel_c_c7
mega_kernel_c_s8:
    s_call_b64 s[50:51], mega_kernel_c_r
    s_branch mega_kernel_c_c8
mega_kernel_c_s9:
    s_call_b64 s[50:51], mega_kernel_c_r
    s_branch mega_kernel_c_c9
mega_kernel_c_r:
    s_waitcnt vmcnt(0)
    v_cmp_eq_u32 s[40:41], -1, v56
    v_cmp_eq_u32 s[44:45], -1, v60
    v_cmp_eq_u32 s[52:53], -1, v64
    v_cmp_eq_u32 s[54:55], -1, v68
    s_mov_b64 exec, s[40:41]
    buffer_load_dwordx4 v[56:59], v2, s[20:23], s4 offen sc1
    s_mov_b64 exec, s[44:45]
    buffer_load_dwordx4 v[60:63], v2, s[20:23], s5 offen sc1
    s_mov_b64 exec, s[52:53]
    buffer_load_dwordx4 v[64:67], v2, s[20:23], s6 offen sc1
    s_mov_b64 exec, s[54:55]
    buffer_load_dwordx4 v[68:71], v2, s[20:23], s7 offen sc1
    s_mov_b64 exec, -1
    v_cmp_eq_u32 s[40:41], -1, v72
    v_cmp_eq_u32 s[44:45], -1, v76
    v_cmp_eq_u32 s[52:53], -1, v80
    v_cmp_eq_u32 s[54:55], -1, v84
    s_mov_b64 exec, s[40:41]
    buffer_load_dwordx4 v[72:75], v2, s[20:23], s8 offen sc1
    s_mov_b64 exec, s[44:45]
    buffer_load_dwordx4 v[76:79], v2, s[20:23], s9 offen sc1
    s_mov_b64 exec, s[52:53]
    buffer_load_dwordx4 v[80:83], v2, s[20:23], s10 offen sc1
    s_mov_b64 exec, s[54:55]
    buffer_load_dwordx4 v[84:87], v2, s[20:23], s11 offen sc1
    s_mov_b64 exec, -1
    v_cmp_eq_u32 s[40:41], -1, v88
    v_cmp_eq_u32 s[44:45], -1, v90
    v_cmp_eq_u32 s[52:53], -1, v92
    v_cmp_eq_u32 s[54:55], -1, v94
    s_mov_b64 exec, s[40:41]
    buffer_load_dwordx2 v[88:89], v35, s[20:23], s56 offen offset:0 sc1
    s_mov_b64 exec, s[44:45]
    buffer_load_dwordx2 v[90:91], v35, s[20:23], s56 offen offset:256 sc1
    s_mov_b64 exec, s[52:53]
    buffer_load_dwordx2 v[92:93], v35, s[20:23], s56 offen offset:1024 sc1
    s_mov_b64 exec, s[54:55]
    buffer_load_dwordx2 v[94:95], v35, s[20:23], s56 offen offset:1280 sc1
    s_mov_b64 exec, -1
    s_add_u32 s61, s61, 1
    s_cmp_lt_u32 s61, 40000
    s_waitcnt vmcnt(0)
    s_cbranch_scc1 mega_kernel_c_x
    v_min_u32 v56, -2, v56
    v_min_u32 v60, -2, v60
    v_min_u32 v64, -2, v64
    v_min_u32 v68, -2, v68
    v_min_u32 v72, -2, v72
    v_min_u32 v76, -2, v76
    v_min_u32 v80, -2, v80
    v_min_u32 v84, -2, v84
    v_min_u32 v88, -2, v88
    v_min_u32 v90, -2, v90
    v_min_u32 v92, -2, v92
    v_min_u32 v94, -2, v94
mega_kernel_c_x:
    s_setpc_b64 s[50:51]
mega_kernel_c_k0:
    s_add_u32 m0, s39, 57344
    s_nop 0
    buffer_load_dwordx4 v32, s[32:35], s99 offen offset:0 lds
    buffer_load_dwordx4 v33, s[32:35], s99 offen offset:1024 lds
    buffer_load_dwordx4 v34, s[32:35], s99 offen offset:2048 lds
    s_add_u32 s49, s99, 49152
    s_add_u32 m0, s39, 60416
    s_nop 0
    buffer_load_dwordx4 v32, s[32:35], s49 offen offset:0 lds
    buffer_load_dwordx4 v33, s[32:35], s49 offen offset:1024 lds
    buffer_load_dwordx4 v34, s[32:35], s49 offen offset:2048 lds
    s_add_u32 s99, s99, 196608
    s_cmp_ge_u32 s99, s38
    s_cselect_b32 s52, 1966080, 0
    s_sub_u32 s99, s99, s52
    s_branch mega_kernel_d_cmp
mega_kernel_c_pub:
    s_barrier
mega_kernel_c_end:
    s_cmp_lt_u32 s24, 4
    s_cbranch_scc1 mega_kernel_d_cmp
    s_sub_u32 s31, s24, 4
    s_add_u32 s99, s99, 196608
    s_cmp_ge_u32 s99, s38
    s_cselect_b32 s52, 1966080, 0
    s_sub_u32 s99, s99, s52
    s_add_u32 s99, s99, 196608
    s_cmp_ge_u32 s99, s38
    s_cselect_b32 s52, 1966080, 0
    s_sub_u32 s99, s99, s52
    s_add_u32 s99, s99, 196608
    s_cmp_ge_u32 s99, s38
    s_cselect_b32 s52, 1966080, 0
    s_sub_u32 s99, s99, s52
    s_lshl_b32 s52, s96, 2
    s_add_u32 s52, s52, s31
    s_mul_i32 s52, s52, 40960
    s_add_u32 s52, s52, 10485760
    s_add_u32 s57, s52, 40960
    s_lshl_b32 s53, s98, 12
    s_add_u32 s56, s52, s53
    s_lshl_b32 s55, s31, 12
    s_mul_i32 s58, s26, 245760
    s_add_u32 s58, s58, 19398656
    v_add_u32 v35, 4096, v2
    v_lshrrev_b32 v5, 4, v1
    v_and_b32 v6, 15, v1
    v_lshlrev_b32 v6, 4, v6
    v_lshl_add_u32 v36, v5, 10, v6
    v_lshlrev_b32 v37, 3, v1
    s_lshl_b32 s52, s96, 2
    s_add_u32 s52, s52, s31
    s_lshl_b32 s52, s52, 12
    s_add_u32 s4, s52, 21364736
    s_min_u32 s9, s31, 2
    s_lshl_b32 s9, s9, 9
    s_mul_i32 s52, s97, 15360
    s_add_u32 s52, s52, s9
    s_add_u32 s5, s52, 21626880
    s_add_u32 s6, s5, 4608
    s_add_u32 s7, s5, 9216
    s_add_u32 s8, s5, 13824
    v_add_u32 v38, s55, v2
    v_add_u32 v39, 122880, v38
    s_mov_b32 s10, s56
    s_nop 15
    s_nop 15
    s_nop 15
    s_nop 15
    s_add_u32 m0, s55, 122880
    s_nop 0
    buffer_load_dwordx4 v2, s[20:23], s56 offen offset:0 sc1 lds
    buffer_load_dwordx4 v2, s[20:23], s56 offen offset:1024 sc1 lds
    buffer_load_dwordx4 v2, s[20:23], s56 offen offset:2048 sc1 lds
    buffer_load_dwordx4 v2, s[20:23], s56 offen offset:3072 sc1 lds
    s_add_u32 s56, s56, 4096
    s_cmp_ge_u32 s56, s57
    s_cselect_b32 s52, 40960, 0
    s_sub_u32 s56, s56, s52
    s_add_u32 m0, s55, 24576
    s_nop 0
    buffer_load_dwordx4 v2, s[20:23], s56 offen offset:0 sc1 lds
    buffer_load_dwordx4 v2, s[20:23], s56 offen offset:1024 sc1 lds
    buffer_load_dwordx4 v2, s[20:23], s56 offen offset:2048 sc1 lds
    buffer_load_dwordx4 v2, s[20:23], s56 offen offset:3072 sc1 lds
    s_add_u32 s56, s56, 4096
    s_cmp_ge_u32 s56, s57
    s_cselect_b32 s52, 40960, 0
    s_sub_u32 s56, s56, s52
    s_add_u32 m0, s55, 40960
    s_nop 0
    buffer_load_dwordx4 v2, s[20:23], s56 offen offset:0 sc1 lds
    buffer_load_dwordx4 v2, s[20:23], s56 offen offset:1024 sc1 lds
    buffer_load_dwordx4 v2, s[20:23], s56 offen offset:2048 sc1 lds
    buffer_load_dwordx4 v2, s[20:23], s56 offen offset:3072 sc1 lds
    s_add_u32 s56, s56, 4096
    s_cmp_ge_u32 s56, s57
    s_cselect_b32 s52, 40960, 0
    s_sub_u32 s56, s56, s52
    s_setprio 0
    s_waitcnt vmcnt(8)
    s_mov_b32 s61, 0
mega_kernel_d_v0:
    ds_read2st64_b32 v[76:77], v39 offset0:0 offset1:4
    ds_read2st64_b32 v[78:79], v39 offset0:8 offset1:12
    s_add_u32 s61, s61, 1
    s_waitcnt lgkmcnt(0)
    v_max_u32 v76, v76, v77
    v_max3_u32 v76, v76, v78, v79
    v_cmp_eq_u32 vcc, -1, v76
    s_cmp_gt_u32 s61, 40000
    s_cbranch_vccz mega_kernel_d_w0
    s_cbranch_scc1 mega_kernel_d_w0
    s_mov_b32 s11, m0
    s_add_u32 m0, s55, 122880
    s_nop 0
    buffer_load_dwordx4 v2, s[20:23], s10 offen offset:0 sc1 lds
    buffer_load_dwordx4 v2, s[20:23], s10 offen offset:1024 sc1 lds
    buffer_load_dwordx4 v2, s[20:23], s10 offen offset:2048 sc1 lds
    buffer_load_dwordx4 v2, s[20:23], s10 offen offset:3072 sc1 lds
    s_mov_b32 m0, s11
    s_waitcnt vmcnt(0)
    s_branch mega_kernel_d_v0
mega_kernel_d_w0:
    s_add_u32 s10, s10, 4096
    s_cmp_ge_u32 s10, s57
    s_cselect_b32 s52, 40960, 0
    s_sub_u32 s10, s10, s52
    s_barrier
    buffer_load_dwordx3 v[40:42], v36, s[20:23], s4 offen offset:0 sc1
    buffer_load_dwordx3 v[44:46], v36, s[20:23], s4 offen offset:256 sc1
    buffer_load_dwordx3 v[48:50], v36, s[20:23], s4 offen offset:512 sc1
    buffer_load_dwordx3 v[52:54], v36, s[20:23], s4 offen offset:768 sc1
    s_waitcnt vmcnt(4)
    s_mov_b32 s61, 0
mega_kernel_d_v1:
    ds_read2st64_b32 v[76:77], v38 offset0:96 offset1:100
    ds_read2st64_b32 v[78:79], v38 offset0:104 offset1:108
    ds_read2st64_b32 v[80:81], v38 offset0:160 offset1:164
    ds_read2st64_b32 v[82:83], v38 offset0:168 offset1:172
    s_add_u32 s61, s61, 1
    s_waitcnt lgkmcnt(0)
    v_max_u32 v76, v76, v77
    v_max3_u32 v76, v76, v78, v79
    v_max3_u32 v80, v80, v81, v82
    v_max3_u32 v76, v76, v80, v83
    v_cmp_eq_u32 vcc, -1, v76
    s_cmp_gt_u32 s61, 40000
    s_cbranch_vccz mega_kernel_d_w1
    s_cbranch_scc1 mega_kernel_d_w1
    s_mov_b32 s11, m0
    s_add_u32 m0, s55, 24576
    s_nop 0
    buffer_load_dwordx4 v2, s[20:23], s10 offen offset:0 sc1 lds
    buffer_load_dwordx4 v2, s[20:23], s10 offen offset:1024 sc1 lds
    buffer_load_dwordx4 v2, s[20:23], s10 offen offset:2048 sc1 lds
    buffer_load_dwordx4 v2, s[20:23], s10 offen offset:3072 sc1 lds
    s_add_u32 s53, s10, 4096
    s_cmp_ge_u32 s53, s57
    s_cselect_b32 s52, 40960, 0
    s_sub_u32 s53, s53, s52
    s_add_u32 m0, s55, 40960
    s_nop 0
    buffer_load_dwordx4 v2, s[20:23], s53 offen offset:0 sc1 lds
    buffer_load_dwordx4 v2, s[20:23], s53 offen offset:1024 sc1 lds
    buffer_load_dwordx4 v2, s[20:23], s53 offen offset:2048 sc1 lds
    buffer_load_dwordx4 v2, s[20:23], s53 offen offset:3072 sc1 lds
    s_mov_b32 m0, s11
    s_waitcnt vmcnt(0)
    s_branch mega_kernel_d_v1
mega_kernel_d_w1:
    s_barrier
    s_add_u32 m0, s39, 139264
    s_nop 0
    buffer_load_dwordx4 v32, s[32:35], s99 offen offset:0 lds
    buffer_load_dwordx4 v33, s[32:35], s99 offen offset:1024 lds
    buffer_load_dwordx4 v34, s[32:35], s99 offen offset:2048 lds
    s_add_u32 s49, s99, 49152
    s_add_u32 m0, s39, 142336
    s_nop 0
    buffer_load_dwordx4 v32, s[32:35], s49 offen offset:0 lds
    buffer_load_dwordx4 v33, s[32:35], s49 offen offset:1024 lds
    buffer_load_dwordx4 v34, s[32:35], s49 offen offset:2048 lds
    s_add_u32 s99, s99, 196608
    s_cmp_ge_u32 s99, s38
    s_cselect_b32 s52, 1966080, 0
    s_sub_u32 s99, s99, s52
    s_waitcnt vmcnt(6)
    s_mov_b32 s61, 0
mega_kernel_d_hchk:
    v_xor_b32 v5, s3, v42
    v_xor_b32 v6, s3, v46
    v_xor_b32 v7, s3, v50
    v_or3_b32 v5, v5, v6, v7
    v_xor_b32 v6, s3, v54
    v_or_b32 v5, v5, v6
    v_cmp_ne_u32 vcc, 0, v5
    s_add_u32 s61, s61, 1
    s_cbranch_vccz mega_kernel_d_hok
    s_cmp_gt_u32 s61, 40000
    s_cbranch_scc1 mega_kernel_d_hok
    buffer_load_dwordx3 v[40:42], v36, s[20:23], s4 offen offset:0 sc1
    buffer_load_dwordx3 v[44:46], v36, s[20:23], s4 offen offset:256 sc1
    buffer_load_dwordx3 v[48:50], v36, s[20:23], s4 offen offset:512 sc1
    buffer_load_dwordx3 v[52:54], v36, s[20:23], s4 offen offset:768 sc1
    s_waitcnt vmcnt(0)
    s_branch mega_kernel_d_hchk
mega_kernel_d_hok:
    s_add_u32 m0, s55, 106496
    s_nop 0
    buffer_load_dwordx4 v2, s[20:23], s56 offen offset:0 sc1 lds
    buffer_load_dwordx4 v2, s[20:23], s56 offen offset:1024 sc1 lds
    buffer_load_dwordx4 v2, s[20:23], s56 offen offset:2048 sc1 lds
    buffer_load_dwordx4 v2, s[20:23], s56 offen offset:3072 sc1 lds
    s_add_u32 s56, s56, 4096
    s_cmp_ge_u32 s56, s57
    s_cselect_b32 s52, 40960, 0
    s_sub_u32 s56, s56, s52
    s_add_u32 m0, s55, 122880
    s_nop 0
    buffer_load_dwordx4 v2, s[20:23], s56 offen offset:0 sc1 lds
    buffer_load_dwordx4 v2, s[20:23], s56 offen offset:1024 sc1 lds
    s_nop 0
    s_barrier
    buffer_load_dwordx4 v2, s[20:23], s56 offen offset:2048 sc1 lds
    buffer_load_dwordx4 v2, s[20:23], s56 offen offset:3072 sc1 lds
    s_add_u32 s56, s56, 4096
    s_cmp_ge_u32 s56, s57
    s_cselect_b32 s52, 40960, 0
    s_sub_u32 s56, s56, s52
    s_add_u32 m0, s39, 0
    s_nop 0
    buffer_load_dwordx4 v32, s[32:35], s99 offen offset:0 lds
    buffer_load_dwordx4 v33, s[32:35], s99 offen offset:1024 lds
    buffer_load_dwordx4 v34, s[32:35], s99 offen offset:2048 lds
    s_add_u32 s49, s99, 49152
    s_add_u32 m0, s39, 3072
    s_nop 0
    buffer_load_dwordx4 v32, s[32:35], s49 offen offset:0 lds
    buffer_load_dwordx4 v33, s[32:35], s49 offen offset:1024 lds
    buffer_load_dwordx4 v34, s[32:35], s49 offen offset:2048 lds
    s_add_u32 s99, s99, 196608
    s_cmp_ge_u32 s99, s38
    s_cselect_b32 s52, 1966080, 0
    s_sub_u32 s99, s99, s52
    s_add_u32 m0, s55, 24576
    s_nop 0
    buffer_load_dwordx4 v2, s[20:23], s56 offen offset:0 sc1 lds
    buffer_load_dwordx4 v2, s[20:23], s56 offen offset:1024 sc1 lds
    buffer_load_dwordx4 v2, s[20:23], s56 offen offset:2048 sc1 lds
    s_waitcnt vmcnt(13)
    s_barrier
    buffer_load_dwordx4 v2, s[20:23], s56 offen offset:3072 sc1 lds
    s_add_u32 s56, s56, 4096
    s_cmp_ge_u32 s56, s57
    s_cselect_b32 s52, 40960, 0
    s_sub_u32 s56, s56, s52
    s_add_u32 m0, s39, 57344
    s_nop 0
    buffer_load_dwordx4 v32, s[32:35], s99 offen offset:0 lds
    buffer_load_dwordx4 v33, s[32:35], s99 offen offset:1024 lds
    buffer_load_dwordx4 v34, s[32:35], s99 offen offset:2048 lds
    s_add_u32 s49, s99, 49152
    s_add_u32 m0, s39, 60416
    s_nop 0
    buffer_load_dwordx4 v32, s[32:35], s49 offen offset:0 lds
    buffer_load_dwordx4 v33, s[32:35], s49 offen offset:1024 lds
    buffer_load_dwordx4 v34, s[32:35], s49 offen offset:2048 lds
    s_add_u32 s99, s99, 196608
    s_cmp_ge_u32 s99, s38
    s_cselect_b32 s52, 1966080, 0
    s_sub_u32 s99, s99, s52
    s_add_u32 m0, s55, 40960
    s_nop 0
    buffer_load_dwordx4 v2, s[20:23], s56 offen offset:0 sc1 lds
    v_pk_add_f32 v[40:41], v[40:41], v[44:45]
    v_pk_add_f32 v[40:41], v[40:41], v[48:49]
    v_pk_add_f32 v[40:41], v[40:41], v[52:53]
    v_mov_b32 v7, v40
    s_nop 1
    v_permlane16_swap_b32 v7, v40
    v_add_f32 v40, v7, v40
    v_mov_b32 v8, v41
    s_nop 1
    v_permlane16_swap_b32 v8, v41
    v_add_f32 v41, v8, v41
    v_mul_f32 v40, 0x3acccccd, v40
    v_mul_f32 v41, 0x3acccccd, v41
    v_fma_f32 v5, -v40, v40, v41
    v_max_f32 v5, 0, v5
    v_cvt_pk_bf16_f32 v6, v40, v5
    v_lshlrev_b32 v44, 16, v6
    v_and_b32 v5, 0xffff0000, v6
    v_add_f32 v5, 0x3727c5ac, v5
    v_cvt_pk_bf16_f32 v5, v5, v5
    v_lshlrev_b32 v5, 16, v5
    v_sqrt_f32 v5, v5
    s_nop 0
    v_cvt_pk_bf16_f32 v5, v5, v5
    v_lshlrev_b32 v5, 16, v5
    v_mov_b32 v47, v5
    v_rcp_f32 v46, v5
    v_xor_b32 v44, 0x80000000, v44
    v_mul_f32 v46, 0xbfb8aa3b, v46
    v_mul_f32 v47, v47, v47
    v_and_b32 v5, 15, v1
    v_lshl_add_u32 v5, v3, 4, v5
    s_lshl_b32 s52, s31, 8
    s_add_u32 s52, s52, 46080
    v_lshl_add_u32 v48, v5, 3, s52
    s_lshr_b32 s52, s9, 1
    s_add_u32 s52, s52, 48128
    v_lshl_add_u32 v49, v1, 2, s52
    s_waitcnt vmcnt(17)
    s_barrier
    buffer_load_dwordx2 v[56:57], v37, s[20:23], s5 offen offset:0 sc1
    buffer_load_dwordx2 v[58:59], v37, s[20:23], s5 offen offset:1536 sc1
    buffer_load_dwordx2 v[60:61], v37, s[20:23], s5 offen offset:3072 sc1
    buffer_load_dwordx2 v[62:63], v37, s[20:23], s6 offen offset:0 sc1
    buffer_load_dwordx2 v[64:65], v37, s[20:23], s6 offen offset:1536 sc1
    buffer_load_dwordx2 v[66:67], v37, s[20:23], s6 offen offset:3072 sc1
    buffer_load_dwordx2 v[68:69], v37, s[20:23], s7 offen offset:0 sc1
    buffer_load_dwordx2 v[70:71], v37, s[20:23], s7 offen offset:1536 sc1
    buffer_load_dwordx2 v[72:73], v37, s[20:23], s7 offen offset:3072 sc1
    buffer_load_dwordx2 v[74:75], v37, s[20:23], s8 offen offset:0 sc1
    buffer_load_dwordx4 v2, s[20:23], s56 offen offset:1024 sc1 lds
    buffer_load_dwordx4 v2, s[20:23], s56 offen offset:2048 sc1 lds
    buffer_load_dwordx4 v2, s[20:23], s56 offen offset:3072 sc1 lds
    s_add_u32 s56, s56, 4096
    s_cmp_ge_u32 s56, s57
    s_cselect_b32 s52, 40960, 0
    s_sub_u32 s56, s56, s52
    s_add_u32 m0, s39, 81920
    s_nop 0
    buffer_load_dwordx4 v32, s[32:35], s99 offen offset:0 lds
    buffer_load_dwordx4 v33, s[32:35], s99 offen offset:1024 lds
    buffer_load_dwordx4 v34, s[32:35], s99 offen offset:2048 lds
    s_waitcnt vmcnt(23)
    s_barrier
    s_add_u32 s49, s99, 49152
    s_add_u32 m0, s39, 84992
    s_nop 0
    buffer_load_dwordx4 v32, s[32:35], s49 offen offset:0 lds
    buffer_load_dwordx4 v33, s[32:35], s49 offen offset:1024 lds
    buffer_load_dwordx4 v34, s[32:35], s49 offen offset:2048 lds
    s_add_u32 s99, s99, 196608
    s_cmp_ge_u32 s99, s38
    s_cselect_b32 s52, 1966080, 0
    s_sub_u32 s99, s99, s52
    s_add_u32 m0, s55, 106496
    s_nop 0
    buffer_load_dwordx4 v2, s[20:23], s56 offen offset:0 sc1 lds
    buffer_load_dwordx4 v2, s[20:23], s56 offen offset:1024 sc1 lds
    buffer_load_dwordx4 v2, s[20:23], s56 offen offset:2048 sc1 lds
    buffer_load_dwordx4 v2, s[20:23], s56 offen offset:3072 sc1 lds
    s_add_u32 s56, s56, 4096
    s_cmp_ge_u32 s56, s57
    s_cselect_b32 s52, 40960, 0
    s_sub_u32 s56, s56, s52
    s_add_u32 m0, s39, 139264
    s_nop 0
    buffer_load_dwordx4 v32, s[32:35], s99 offen offset:0 lds
    buffer_load_dwordx4 v33, s[32:35], s99 offen offset:1024 lds
    buffer_load_dwordx4 v34, s[32:35], s99 offen offset:2048 lds
    s_add_u32 s49, s99, 49152
    s_add_u32 m0, s39, 142336
    s_nop 0
    buffer_load_dwordx4 v32, s[32:35], s49 offen offset:0 lds
    s_waitcnt vmcnt(14)
    s_barrier
    buffer_load_dwordx4 v33, s[32:35], s49 offen offset:1024 lds
    buffer_load_dwordx4 v34, s[32:35], s49 offen offset:2048 lds
    s_add_u32 s99, s99, 196608
    s_cmp_ge_u32 s99, s38
    s_cselect_b32 s52, 1966080, 0
    s_sub_u32 s99, s99, s52
    s_add_u32 m0, s55, 122880
    s_nop 0
    buffer_load_dwordx4 v2, s[20:23], s56 offen offset:0 sc1 lds
    buffer_load_dwordx4 v2, s[20:23], s56 offen offset:1024 sc1 lds
    buffer_load_dwordx4 v2, s[20:23], s56 offen offset:2048 sc1 lds
    buffer_load_dwordx4 v2, s[20:23], s56 offen offset:3072 sc1 lds
    s_add_u32 s56, s56, 4096
    s_cmp_ge_u32 s56, s57
    s_cselect_b32 s52, 40960, 0
    s_sub_u32 s56, s56, s52
    s_add_u32 m0, s39, 0
    s_nop 0
    buffer_load_dwordx4 v32, s[32:35], s99 offen offset:0 lds
    buffer_load_dwordx4 v33, s[32:35], s99 offen offset:1024 lds
    s_nop 0
    s_mov_b32 s61, 0
mega_kernel_d_chk:
    v_xor_b32 v5, s3, v57
    v_xor_b32 v6, s3, v59
    v_or_b32 v5, v5, v6
    v_xor_b32 v6, s3, v61
    v_xor_b32 v7, s3, v63
    v_or3_b32 v5, v5, v6, v7
    v_xor_b32 v6, s3, v65
    v_xor_b32 v7, s3, v67
    v_or3_b32 v5, v5, v6, v7
    v_xor_b32 v6, s3, v69
    v_xor_b32 v7, s3, v71
    v_or3_b32 v5, v5, v6, v7
    v_xor_b32 v6, s3, v73
    v_xor_b32 v7, s3, v75
    v_or3_b32 v5, v5, v6, v7
    v_cmp_ne_u32 vcc, 0, v5
    s_add_u32 s61, s61, 1
    s_cbranch_vccz mega_kernel_d_ok
    s_cmp_gt_u32 s61, 40000
    s_cbranch_scc1 mega_kernel_d_ok
    buffer_load_dwordx2 v[56:57], v37, s[20:23], s5 offen offset:0 sc1
    buffer_load_dwordx2 v[58:59], v37, s[20:23], s5 offen offset:1536 sc1
    buffer_load_dwordx2 v[60:61], v37, s[20:23], s5 offen offset:3072 sc1
    buffer_load_dwordx2 v[62:63], v37, s[20:23], s6 offen offset:0 sc1
    buffer_load_dwordx2 v[64:65], v37, s[20:23], s6 offen offset:1536 sc1
    buffer_load_dwordx2 v[66:67], v37, s[20:23], s6 offen offset:3072 sc1
    buffer_load_dwordx2 v[68:69], v37, s[20:23], s7 offen offset:0 sc1
    buffer_load_dwordx2 v[70:71], v37, s[20:23], s7 offen offset:1536 sc1
    buffer_load_dwordx2 v[72:73], v37, s[20:23], s7 offen offset:3072 sc1
    buffer_load_dwordx2 v[74:75], v37, s[20:23], s8 offen offset:0 sc1
    s_waitcnt vmcnt(0)
    s_branch mega_kernel_d_chk
mega_kernel_d_ok:
    v_add_f32 v56, v56, v58
    v_add_f32 v56, v56, v60
    v_add_f32 v56, v56, v62
    v_add_f32 v56, v56, v64
    v_add_f32 v56, v56, v66
    v_add_f32 v56, v56, v68
    v_add_f32 v56, v56, v70
    v_add_f32 v56, v56, v72
    v_add_f32 v56, v56, v74
    s_waitcnt vmcnt(12)
    s_barrier
    ds_write_b32 v48, v44
    ds_write_b64 v48, v[46:47] offset:1024
    ds_write_b32 v49, v56
    buffer_load_dwordx4 v34, s[32:35], s99 offen offset:2048 lds
    s_add_u32 s49, s99, 49152
    s_add_u32 m0, s39, 3072
    s_nop 0
    buffer_load_dwordx4 v32, s[32:35], s49 offen offset:0 lds
    buffer_load_dwordx4 v33, s[32:35], s49 offen offset:1024 lds
    buffer_load_dwordx4 v34, s[32:35], s49 offen offset:2048 lds
    s_add_u32 s99, s99, 196608
    s_cmp_ge_u32 s99, s38
    s_cselect_b32 s52, 1966080, 0
    s_sub_u32 s99, s99, s52
    s_add_u32 m0, s55, 24576
    s_nop 0
    buffer_load_dwordx4 v2, s[20:23], s56 offen offset:0 sc1 lds
    buffer_load_dwordx4 v2, s[20:23], s56 offen offset:1024 sc1 lds
    buffer_load_dwordx4 v2, s[20:23], s56 offen offset:2048 sc1 lds
    buffer_load_dwordx4 v2, s[20:23], s56 offen offset:3072 sc1 lds
    s_add_u32 s56, s56, 4096
    s_cmp_ge_u32 s56, s57
    s_cselect_b32 s52, 40960, 0
    s_sub_u32 s56, s56, s52
    s_lshl_b32 s53, s31, 1
    s_add_u32 s53, s53, 0
    s_add_u32 s54, s53, 32
    s_mul_i32 s54, s54, 5120
    s_add_u32 s54, s54, s58
    s_mul_i32 s53, s53, 5120
    s_add_u32 m0, s53, 40960
    s_nop 0
    buffer_load_dwordx4 v2, s[20:23], s54 offen offset:0 sc1 lds
    buffer_load_dwordx4 v2, s[20:23], s54 offen offset:1024 sc1 lds
    buffer_load_dwordx4 v2, s[20:23], s54 offen offset:2048 sc1 lds
    buffer_load_dwordx4 v2, s[20:23], s54 offen offset:3072 sc1 lds
    s_add_u32 m0, s53, 45056
    s_nop 0
    buffer_load_dwordx4 v35, s[20:23], s54 offen sc1 lds
    s_waitcnt lgkmcnt(0)
    s_waitcnt vmcnt(15)
    s_barrier
    s_lshl_b32 s53, s31, 1
    s_add_u32 s53, s53, 0
    s_add_u32 s54, s53, 24
    s_mul_i32 s54, s54, 5120
    s_add_u32 s54, s54, s58
    s_mul_i32 s53, s53, 5120
    s_add_u32 m0, s53, 81920
    s_nop 0
    buffer_load_dwordx4 v2, s[20:23], s54 offen offset:0 sc1 lds
    buffer_load_dwordx4 v2, s[20:23], s54 offen offset:1024 sc1 lds
    buffer_load_dwordx4 v2, s[20:23], s54 offen offset:2048 sc1 lds
    buffer_load_dwordx4 v2, s[20:23], s54 offen offset:3072 sc1 lds
    s_add_u32 m0, s53, 86016
    s_nop 0
    buffer_load_dwordx4 v35, s[20:23], s54 offen sc1 lds
    s_lshl_b32 s53, s31, 1
    s_add_u32 s53, s53, 1
    s_add_u32 s54, s53, 24
    s_mul_i32 s54, s54, 5120
    s_add_u32 s54, s54, s58
    s_mul_i32 s53, s53, 5120
    s_add_u32 m0, s53, 81920
    s_nop 0
    buffer_load_dwordx4 v2, s[20:23], s54 offen offset:0 sc1 lds
    buffer_load_dwordx4 v2, s[20:23], s54 offen offset:1024 sc1 lds
    buffer_load_dwordx4 v2, s[20:23], s54 offen offset:2048 sc1 lds
    buffer_load_dwordx4 v2, s[20:23], s54 offen offset:3072 sc1 lds
    s_add_u32 m0, s53, 86016
    s_nop 0
    buffer_load_dwordx4 v35, s[20:23], s54 offen sc1 lds
    s_waitcnt vmcnt(15)
    s_barrier
    s_lshl_b32 s53, s31, 1
    s_add_u32 s53, s53, 0
    s_add_u32 s54, s53, 0
    s_mul_i32 s54, s54, 5120
    s_add_u32 s54, s54, s58
    s_mul_i32 s53, s53, 5120
    s_add_u32 m0, s53, 122880
    s_nop 0
    buffer_load_dwordx4 v2, s[20:23], s54 offen offset:0 sc1 lds
    buffer_load_dwordx4 v2, s[20:23], s54 offen offset:1024 sc1 lds
    buffer_load_dwordx4 v2, s[20:23], s54 offen offset:2048 sc1 lds
    buffer_load_dwordx4 v2, s[20:23], s54 offen offset:3072 sc1 lds
    s_add_u32 m0, s53, 126976
    s_nop 0
    buffer_load_dwordx4 v35, s[20:23], s54 offen sc1 lds
    s_lshl_b32 s53, s31, 1
    s_add_u32 s53, s53, 1
    s_add_u32 s54, s53, 0
    s_mul_i32 s54, s54, 5120
    s_add_u32 s54, s54, s58
    s_mul_i32 s53, s53, 5120
    s_add_u32 m0, s53, 122880
    s_nop 0
    buffer_load_dwordx4 v2, s[20:23], s54 offen offset:0 sc1 lds
    buffer_load_dwordx4 v2, s[20:23], s54 offen offset:1024 sc1 lds
    buffer_load_dwordx4 v2, s[20:23], s54 offen offset:2048 sc1 lds
    buffer_load_dwordx4 v2, s[20:23], s54 offen offset:3072 sc1 lds
    s_add_u32 m0, s53, 126976
    s_nop 0
    buffer_load_dwordx4 v35, s[20:23], s54 offen sc1 lds
    s_lshl_b32 s53, s31, 1
    s_add_u32 s53, s53, 1
    s_add_u32 s54, s53, 32
    s_mul_i32 s54, s54, 5120
    s_add_u32 s54, s54, s58
    s_mul_i32 s53, s53, 5120
    s_add_u32 m0, s53, 40960
    s_nop 0
    buffer_load_dwordx4 v2, s[20:23], s54 offen offset:0 sc1 lds
    buffer_load_dwordx4 v2, s[20:23], s54 offen offset:1024 sc1 lds
    buffer_load_dwordx4 v2, s[20:23], s54 offen offset:2048 sc1 lds
    buffer_load_dwordx4 v2, s[20:23], s54 offen offset:3072 sc1 lds
    s_add_u32 m0, s53, 45056
    s_nop 0
    buffer_load_dwordx4 v35, s[20:23], s54 offen sc1 lds
    s_waitcnt vmcnt(15)
    v_add_u32 v21, 81920, v2
    s_barrier
    s_lshl_b32 s53, s31, 1
    s_add_u32 s53, s53, 0
    s_add_u32 s54, s53, 8
    s_mul_i32 s54, s54, 5120
    s_add_u32 s54, s54, s58
    s_mul_i32 s53, s53, 5120
    s_add_u32 m0, s53, 0
    s_nop 0
    buffer_load_dwordx4 v2, s[20:23], s54 offen offset:0 sc1 lds
    buffer_load_dwordx4 v2, s[20:23], s54 offen offset:1024 sc1 lds
    buffer_load_dwordx4 v2, s[20:23], s54 offen offset:2048 sc1 lds
    buffer_load_dwordx4 v2, s[20:23], s54 offen offset:3072 sc1 lds
    s_add_u32 m0, s53, 4096
    s_nop 0
    buffer_load_dwordx4 v35, s[20:23], s54 offen sc1 lds
    s_lshl_b32 s53, s31, 1
    s_add_u32 s53, s53, 1
    s_add_u32 s54, s53, 8
    s_mul_i32 s54, s54, 5120
    s_add_u32 s54, s54, s58
    s_mul_i32 s53, s53, 5120
    s_add_u32 m0, s53, 0
    s_nop 0
    buffer_load_dwordx4 v2, s[20:23], s54 offen offset:0 sc1 lds
    buffer_load_dwordx4 v2, s[20:23], s54 offen offset:1024 sc1 lds
    buffer_load_dwordx4 v2, s[20:23], s54 offen offset:2048 sc1 lds
    buffer_load_dwordx4 v2, s[20:23], s54 offen offset:3072 sc1 lds
    s_add_u32 m0, s53, 4096
    s_nop 0
    buffer_load_dwordx4 v35, s[20:23], s54 offen sc1 lds
    ds_read_b128 v[96:99], v21 offset:0
    ds_read_b128 v[100:103], v21 offset:1024
    ds_read_b128 v[104:107], v21 offset:2048
    ds_read_b128 v[108:111], v21 offset:3072
    ds_read_b128 v[112:115], v21 offset:4096
    ds_read_b128 v[116:119], v21 offset:5120
    ds_read_b128 v[120:123], v21 offset:6144
    ds_read_b128 v[124:127], v21 offset:7168
    ds_read_b128 v[128:131], v21 offset:8192
    ds_read_b128 v[132:135], v21 offset:9216
    ds_read_b128 v[136:139], v21 offset:10240
    ds_read_b128 v[140:143], v21 offset:11264
    ds_read_b128 v[144:147], v21 offset:12288
    ds_read_b128 v[148:151], v21 offset:13312
    ds_read_b128 v[152:155], v21 offset:14336
    ds_read_b128 v[156:159], v21 offset:15360
    ds_read_b128 v[160:163], v21 offset:16384
    ds_read_b128 v[164:167], v21 offset:17408
    ds_read_b128 v[168:171], v21 offset:18432
    ds_read_b128 v[172:175], v21 offset:19456
    ds_read_b128 v[176:179], v21 offset:20480
    ds_read_b128 v[180:183], v21 offset:21504
    ds_read_b128 v[184:187], v21 offset:22528
    ds_read_b128 v[188:191], v21 offset:23552
    ds_read_b128 v[192:195], v21 offset:24576
    ds_read_b128 v[196:199], v21 offset:25600
    ds_read_b128 v[200:203], v21 offset:26624
    ds_read_b128 v[204:207], v21 offset:27648
    ds_read_b128 v[208:211], v21 offset:28672
    ds_read_b128 v[212:215], v21 offset:29696
    ds_read_b128 v[216:219], v21 offset:30720
    ds_read_b128 v[220:223], v21 offset:31744
    ds_read_b128 v[224:227], v21 offset:32768
    ds_read_b128 v[228:231], v21 offset:33792
    ds_read_b128 v[232:235], v21 offset:34816
    ds_read_b128 v[236:239], v21 offset:35840
    ds_read_b128 v[240:243], v21 offset:36864
    ds_read_b128 v[244:247], v21 offset:37888
    ds_read_b128 v[248:251], v21 offset:38912
    ds_read_b128 v[252:255], v21 offset:39936
    s_waitcnt lgkmcnt(0)
    s_waitcnt vmcnt(15)
    s_barrier
    s_branch mega_kernel_d_done
mega_kernel_d_cmp:
    s_lshr_b32 s28, s24, 1
    s_and_b32 s29, s24, 1
    s_lshl_b32 s52, s28, 13
    v_lshrrev_b32 v7, 4, v1
    v_and_b32 v8, 15, v1
    v_lshl_add_u32 v20, v7, 9, s52
    v_lshl_add_u32 v20, v8, 4, v20
    v_add_u32 v21, 81920, v20
    v_bfe_u32 v5, v1, 2, 2
    v_lshl_add_u32 v5, v7, 3, v5
    v_mul_u32_u24 v5, 192, v5
    v_and_b32 v6, 1, v1
    v_lshl_add_u32 v5, v6, 4, v5
    v_and_b32 v6, 2, v1
    v_lshl_add_u32 v5, v6, 2, v5
    v_and_b32 v6, 1, v7
    s_mul_i32 s52, s29, 3
    v_xor_b32 v9, s52, v6
    v_lshl_add_u32 v22, v9, 5, v5
    v_add_u32 v25, 57344, v22
    v_add_u32 v28, 139264, v22
    s_add_u32 s52, s52, 1
    v_xor_b32 v9, s52, v6
    v_lshl_add_u32 v23, v9, 5, v5
    v_add_u32 v26, 57344, v23
    v_add_u32 v29, 139264, v23
    s_add_u32 s52, s52, 1
    v_xor_b32 v9, s52, v6
    v_lshl_add_u32 v24, v9, 5, v5
    v_add_u32 v27, 57344, v24
    v_add_u32 v30, 139264, v24
    s_add_u32 s52, s52, 1
    ds_read_b64_tr_b16 v[56:57], v28 offset:0
    ds_read_b64_tr_b16 v[58:59], v28 offset:768
    ds_read_b64_tr_b16 v[60:61], v28 offset:12288
    ds_read_b64_tr_b16 v[62:63], v28 offset:13056
    ds_read_b64_tr_b16 v[64:65], v29 offset:0
    ds_read_b64_tr_b16 v[66:67], v29 offset:768
    ds_read_b64_tr_b16 v[68:69], v29 offset:12288
    ds_read_b64_tr_b16 v[70:71], v29 offset:13056
    ds_read_b64_tr_b16 v[72:73], v30 offset:0
    ds_read_b64_tr_b16 v[74:75], v30 offset:768
    ds_read_b64_tr_b16 v[76:77], v30 offset:12288
    ds_read_b64_tr_b16 v[78:79], v30 offset:13056
    ds_read_b64_tr_b16 v[96:97], v28 offset:6144
    ds_read_b64_tr_b16 v[98:99], v28 offset:6912
    ds_read_b64_tr_b16 v[100:101], v28 offset:18432
    ds_read_b64_tr_b16 v[102:103], v28 offset:19200
    ds_read_b64_tr_b16 v[104:105], v29 offset:6144
    ds_read_b64_tr_b16 v[106:107], v29 offset:6912
    ds_read_b64_tr_b16 v[108:109], v29 offset:18432
    ds_read_b64_tr_b16 v[110:111], v29 offset:19200
    ds_read_b64_tr_b16 v[112:113], v30 offset:6144
    ds_read_b64_tr_b16 v[114:115], v30 offset:6912
    ds_read_b64_tr_b16 v[116:117], v30 offset:18432
    ds_read_b64_tr_b16 v[118:119], v30 offset:19200
    v_lshrrev_b32 v5, 4, v4
    v_mul_u32_u24 v5, 49152, v5
    v_lshl_add_u32 v5, v8, 4, v5
    v_lshl_add_u32 v31, v3, 8, v5
    s_lshl_b32 s52, s96, 1
    s_add_u32 s52, s52, s28
    s_mul_i32 s52, s52, 196608
    s_lshl_b32 s53, s97, 1
    s_add_u32 s53, s53, s29
    s_mul_i32 s54, s53, 1536
    s_add_u32 s52, s52, s54
    s_add_u32 s4, s52, 13107200
    s_add_u32 s5, s4, 98304
    s_lshl_b32 s52, s28, 9
    s_add_u32 s52, s52, 46080
    v_lshl_add_u32 v8, v8, 3, s52
    s_mul_i32 s52, s29, 384
    s_add_u32 s52, s52, 48128
    v_lshl_add_u32 v7, v7, 4, s52
    s_cmp_lt_u32 s24, 2
    s_cbranch_scc1 mega_kernel_d_ncs
    v_mov_b32 v36, 0x3f803f80
    v_mov_b32 v37, 0x3f803f80
    v_mov_b32 v38, 0x3f803f80
    v_mov_b32 v39, 0x3f803f80
    s_mul_i32 s52, s97, 15360
    s_mul_i32 s53, s98, 1536
    s_add_u32 s52, s52, s53
    s_mul_i32 s53, s29, 768
    s_add_u32 s52, s52, s53
    s_add_u32 s52, s52, 21626880
    v_lshlrev_b32 v5, 3, v4
    v_cmp_gt_u32 vcc, 16, v1
    s_waitcnt lgkmcnt(0)
    v_mfma_f32_16x16x32_bf16 v[160:163], v[36:39], v[56:59], 0
    v_mfma_f32_16x16x32_bf16 v[164:167], v[36:39], v[60:63], 0
    v_mfma_f32_16x16x32_bf16 v[168:171], v[36:39], v[64:67], 0
    v_mfma_f32_16x16x32_bf16 v[172:175], v[36:39], v[68:71], 0
    v_mfma_f32_16x16x32_bf16 v[176:179], v[36:39], v[72:75], 0
    v_mfma_f32_16x16x32_bf16 v[180:183], v[36:39], v[76:79], 0
    v_mfma_f32_16x16x32_bf16 v[160:163], v[36:39], v[96:99], v[160:163]
    v_mfma_f32_16x16x32_bf16 v[164:167], v[36:39], v[100:103], v[164:167]
    v_mfma_f32_16x16x32_bf16 v[168:171], v[36:39], v[104:107], v[168:171]
    v_mfma_f32_16x16x32_bf16 v[172:175], v[36:39], v[108:111], v[172:175]
    v_mfma_f32_16x16x32_bf16 v[176:179], v[36:39], v[112:115], v[176:179]
    v_mfma_f32_16x16x32_bf16 v[180:183], v[36:39], v[116:119], v[180:183]
    s_mov_b32 exec_hi, 0
    s_nop 2
    v_cndmask_b32 v160, v164, v160, vcc
    v_mov_b32 v161, s3
    buffer_store_dwordx2 v[160:161], v5, s[20:23], s52 offen offset:0 sc1
    v_cndmask_b32 v168, v172, v168, vcc
    v_mov_b32 v169, s3
    buffer_store_dwordx2 v[168:169], v5, s[20:23], s52 offen offset:256 sc1
    v_cndmask_b32 v176, v180, v176, vcc
    v_mov_b32 v177, s3
    buffer_store_dwordx2 v[176:177], v5, s[20:23], s52 offen offset:512 sc1
    s_mov_b64 exec, -1
mega_kernel_d_ncs:
    s_barrier
    s_add_u32 m0, s39, 81920
    s_nop 0
    buffer_load_dwordx4 v32, s[32:35], s99 offen offset:0 lds
    buffer_load_dwordx4 v33, s[32:35], s99 offen offset:1024 lds
    buffer_load_dwordx4 v34, s[32:35], s99 offen offset:2048 lds
    s_add_u32 s49, s99, 49152
    s_add_u32 m0, s39, 84992
    s_nop 0
    buffer_load_dwordx4 v32, s[32:35], s49 offen offset:0 lds
    buffer_load_dwordx4 v33, s[32:35], s49 offen offset:1024 lds
    buffer_load_dwordx4 v34, s[32:35], s49 offen offset:2048 lds
    s_add_u32 s99, s99, 196608
    s_cmp_ge_u32 s99, s38
    s_cselect_b32 s52, 1966080, 0
    s_sub_u32 s99, s99, s52
    s_barrier
    ds_read_b128 v[40:43], v21 offset:40960
    ds_read_b128 v[44:47], v21 offset:41216
    ds_read_b128 v[48:51], v21 offset:45056
    ds_read_b128 v[52:55], v21 offset:45312
    s_waitcnt lgkmcnt(0)
    v_mfma_f32_16x16x32_bf16 v[160:163], v[56:59], v[40:43], 0
    ds_read_b128 v[80:83], v21 offset:43008
    v_mfma_f32_16x16x32_bf16 v[164:167], v[56:59], v[44:47], 0
    v_mfma_f32_16x16x32_bf16 v[172:175], v[60:63], v[44:47], 0
    v_mfma_f32_16x16x32_bf16 v[168:171], v[60:63], v[40:43], 0
    v_mfma_f32_16x16x32_bf16 v[176:179], v[64:67], v[40:43], 0
    ds_read_b128 v[84:87], v21 offset:43264
    v_mfma_f32_16x16x32_bf16 v[180:183], v[64:67], v[44:47], 0
    v_mfma_f32_16x16x32_bf16 v[188:191], v[68:71], v[44:47], 0
    v_mfma_f32_16x16x32_bf16 v[184:187], v[68:71], v[40:43], 0
    v_mfma_f32_16x16x32_bf16 v[192:195], v[72:75], v[40:43], 0
    ds_read_b128 v[88:91], v21 offset:47104
    v_mfma_f32_16x16x32_bf16 v[196:199], v[72:75], v[44:47], 0
    v_mfma_f32_16x16x32_bf16 v[204:207], v[76:79], v[44:47], 0
    v_mfma_f32_16x16x32_bf16 v[200:203], v[76:79], v[40:43], 0
    v_mfma_f32_16x16x32_bf16 v[248:251], v[76:79], v[48:51], 0
    ds_read_b128 v[92:95], v21 offset:47360
    v_mfma_f32_16x16x32_bf16 v[252:255], v[76:79], v[52:55], 0
    v_mfma_f32_16x16x32_bf16 v[244:247], v[72:75], v[52:55], 0
    v_mfma_f32_16x16x32_bf16 v[240:243], v[72:75], v[48:51], 0
    v_mfma_f32_16x16x32_bf16 v[224:227], v[64:67], v[48:51], 0
    v_mfma_f32_16x16x32_bf16 v[228:231], v[64:67], v[52:55], 0
    v_mfma_f32_16x16x32_bf16 v[236:239], v[68:71], v[52:55], 0
    v_mfma_f32_16x16x32_bf16 v[232:235], v[68:71], v[48:51], 0
    v_mfma_f32_16x16x32_bf16 v[208:211], v[56:59], v[48:51], 0
    v_mfma_f32_16x16x32_bf16 v[212:215], v[56:59], v[52:55], 0
    v_mfma_f32_16x16x32_bf16 v[220:223], v[60:63], v[52:55], 0
    v_mfma_f32_16x16x32_bf16 v[216:219], v[60:63], v[48:51], 0
    s_waitcnt lgkmcnt(0)
    s_waitcnt vmcnt(12)
    s_barrier
    v_mfma_f32_16x16x32_bf16 v[160:163], v[96:99], v[80:83], v[160:163]
    ds_read_b128 v[40:43], v20 offset:24576
    v_mfma_f32_16x16x32_bf16 v[164:167], v[96:99], v[84:87], v[164:167]
    ds_read_b64_tr_b16 v[56:57], v22 offset:0
    v_mfma_f32_16x16x32_bf16 v[172:175], v[100:103], v[84:87], v[172:175]
    ds_read_b64_tr_b16 v[58:59], v22 offset:768
    v_mfma_f32_16x16x32_bf16 v[168:171], v[100:103], v[80:83], v[168:171]
    ds_read_b128 v[44:47], v20 offset:24832
    v_mfma_f32_16x16x32_bf16 v[176:179], v[104:107], v[80:83], v[176:179]
    ds_read_b64_tr_b16 v[60:61], v22 offset:12288
    v_mfma_f32_16x16x32_bf16 v[180:183], v[104:107], v[84:87], v[180:183]
    ds_read_b64_tr_b16 v[62:63], v22 offset:13056
    v_mfma_f32_16x16x32_bf16 v[188:191], v[108:111], v[84:87], v[188:191]
    ds_read_b64_tr_b16 v[64:65], v23 offset:0
    v_mfma_f32_16x16x32_bf16 v[184:187], v[108:111], v[80:83], v[184:187]
    ds_read_b64_tr_b16 v[66:67], v23 offset:768
    v_mfma_f32_16x16x32_bf16 v[192:195], v[112:115], v[80:83], v[192:195]
    ds_read_b64_tr_b16 v[68:69], v23 offset:12288
    v_mfma_f32_16x16x32_bf16 v[196:199], v[112:115], v[84:87], v[196:199]
    ds_read_b64_tr_b16 v[70:71], v23 offset:13056
    v_mfma_f32_16x16x32_bf16 v[204:207], v[116:119], v[84:87], v[204:207]
    ds_read_b64_tr_b16 v[72:73], v24 offset:0
    v_mfma_f32_16x16x32_bf16 v[200:203], v[116:119], v[80:83], v[200:203]
    ds_read_b64_tr_b16 v[74:75], v24 offset:768
    v_mfma_f32_16x16x32_bf16 v[248:251], v[116:119], v[88:91], v[248:251]
    ds_read_b64_tr_b16 v[76:77], v24 offset:12288
    v_mfma_f32_16x16x32_bf16 v[252:255], v[116:119], v[92:95], v[252:255]
    ds_read_b64_tr_b16 v[78:79], v24 offset:13056
    v_mfma_f32_16x16x32_bf16 v[244:247], v[112:115], v[92:95], v[244:247]
    ds_read_b128 v[48:51], v20 offset:28672
    v_mfma_f32_16x16x32_bf16 v[240:243], v[112:115], v[88:91], v[240:243]
    ds_read_b128 v[52:55], v20 offset:28928
    v_mfma_f32_16x16x32_bf16 v[224:227], v[104:107], v[88:91], v[224:227]
    v_mfma_f32_16x16x32_bf16 v[228:231], v[104:107], v[92:95], v[228:231]
    v_mfma_f32_16x16x32_bf16 v[236:239], v[108:111], v[92:95], v[236:239]
    v_mfma_f32_16x16x32_bf16 v[232:235], v[108:111], v[88:91], v[232:235]
    v_mfma_f32_16x16x32_bf16 v[208:211], v[96:99], v[88:91], v[208:211]
    v_mfma_f32_16x16x32_bf16 v[212:215], v[96:99], v[92:95], v[212:215]
    v_mfma_f32_16x16x32_bf16 v[220:223], v[100:103], v[92:95], v[220:223]
    v_mfma_f32_16x16x32_bf16 v[216:219], v[100:103], v[88:91], v[216:219]
    s_waitcnt lgkmcnt(0)
    v_mfma_f32_16x16x32_bf16 v[160:163], v[56:59], v[40:43], v[160:163]
    ds_read_b128 v[80:83], v20 offset:26624
    v_mfma_f32_16x16x32_bf16 v[164:167], v[56:59], v[44:47], v[164:167]
    ds_read_b64_tr_b16 v[96:97], v22 offset:6144
    v_mfma_f32_16x16x32_bf16 v[172:175], v[60:63], v[44:47], v[172:175]
    ds_read_b64_tr_b16 v[98:99], v22 offset:6912
    v_mfma_f32_16x16x32_bf16 v[168:171], v[60:63], v[40:43], v[168:171]
    ds_read_b128 v[84:87], v20 offset:26880
    v_mfma_f32_16x16x32_bf16 v[176:179], v[64:67], v[40:43], v[176:179]
    ds_read_b64_tr_b16 v[100:101], v22 offset:18432
    v_mfma_f32_16x16x32_bf16 v[180:183], v[64:67], v[44:47], v[180:183]
    ds_read_b64_tr_b16 v[102:103], v22 offset:19200
    v_mfma_f32_16x16x32_bf16 v[188:191], v[68:71], v[44:47], v[188:191]
    ds_read_b64_tr_b16 v[104:105], v23 offset:6144
    v_mfma_f32_16x16x32_bf16 v[184:187], v[68:71], v[40:43], v[184:187]
    ds_read_b64_tr_b16 v[106:107], v23 offset:6912
    v_mfma_f32_16x16x32_bf16 v[192:195], v[72:75], v[40:43], v[192:195]
    ds_read_b64_tr_b16 v[108:109], v23 offset:18432
    v_mfma_f32_16x16x32_bf16 v[196:199], v[72:75], v[44:47], v[196:199]
    ds_read_b64_tr_b16 v[110:111], v23 offset:19200
    v_mfma_f32_16x16x32_bf16 v[204:207], v[76:79], v[44:47], v[204:207]
    ds_read_b64_tr_b16 v[112:113], v24 offset:6144
    v_mfma_f32_16x16x32_bf16 v[200:203], v[76:79], v[40:43], v[200:203]
    ds_read_b64_tr_b16 v[114:115], v24 offset:6912
    v_mfma_f32_16x16x32_bf16 v[248:251], v[76:79], v[48:51], v[248:251]
    ds_read_b64_tr_b16 v[116:117], v24 offset:18432
    v_mfma_f32_16x16x32_bf16 v[252:255], v[76:79], v[52:55], v[252:255]
    ds_read_b64_tr_b16 v[118:119], v24 offset:19200
    v_mfma_f32_16x16x32_bf16 v[244:247], v[72:75], v[52:55], v[244:247]
    ds_read_b128 v[88:91], v20 offset:30720
    v_mfma_f32_16x16x32_bf16 v[240:243], v[72:75], v[48:51], v[240:243]
    ds_read_b128 v[92:95], v20 offset:30976
    v_mfma_f32_16x16x32_bf16 v[224:227], v[64:67], v[48:51], v[224:227]
    v_mfma_f32_16x16x32_bf16 v[228:231], v[64:67], v[52:55], v[228:231]
    v_mfma_f32_16x16x32_bf16 v[236:239], v[68:71], v[52:55], v[236:239]
    v_mfma_f32_16x16x32_bf16 v[232:235], v[68:71], v[48:51], v[232:235]
    v_mfma_f32_16x16x32_bf16 v[208:211], v[56:59], v[48:51], v[208:211]
    v_mfma_f32_16x16x32_bf16 v[212:215], v[56:59], v[52:55], v[212:215]
    v_mfma_f32_16x16x32_bf16 v[220:223], v[60:63], v[52:55], v[220:223]
    v_mfma_f32_16x16x32_bf16 v[216:219], v[60:63], v[48:51], v[216:219]
    s_waitcnt lgkmcnt(0)
    s_waitcnt vmcnt(6)
    s_barrier
    v_mfma_f32_16x16x32_bf16 v[160:163], v[96:99], v[80:83], v[160:163]
    ds_read_b128 v[40:43], v20 offset:40960
    v_mfma_f32_16x16x32_bf16 v[164:167], v[96:99], v[84:87], v[164:167]
    ds_read_b64_tr_b16 v[56:57], v25 offset:0
    v_mfma_f32_16x16x32_bf16 v[172:175], v[100:103], v[84:87], v[172:175]
    ds_read_b64_tr_b16 v[58:59], v25 offset:768
    v_mfma_f32_16x16x32_bf16 v[168:171], v[100:103], v[80:83], v[168:171]
    ds_read_b128 v[44:47], v20 offset:41216
    v_mfma_f32_16x16x32_bf16 v[176:179], v[104:107], v[80:83], v[176:179]
    ds_read_b64_tr_b16 v[60:61], v25 offset:12288
    v_mfma_f32_16x16x32_bf16 v[180:183], v[104:107], v[84:87], v[180:183]
    ds_read_b64_tr_b16 v[62:63], v25 offset:13056
    v_mfma_f32_16x16x32_bf16 v[188:191], v[108:111], v[84:87], v[188:191]
    ds_read_b64_tr_b16 v[64:65], v26 offset:0
    v_mfma_f32_16x16x32_bf16 v[184:187], v[108:111], v[80:83], v[184:187]
    ds_read_b64_tr_b16 v[66:67], v26 offset:768
    v_mfma_f32_16x16x32_bf16 v[192:195], v[112:115], v[80:83], v[192:195]
    ds_read_b64_tr_b16 v[68:69], v26 offset:12288
    v_mfma_f32_16x16x32_bf16 v[196:199], v[112:115], v[84:87], v[196:199]
    ds_read_b64_tr_b16 v[70:71], v26 offset:13056
    v_mfma_f32_16x16x32_bf16 v[204:207], v[116:119], v[84:87], v[204:207]
    ds_read_b64_tr_b16 v[72:73], v27 offset:0
    v_mfma_f32_16x16x32_bf16 v[200:203], v[116:119], v[80:83], v[200:203]
    ds_read_b64_tr_b16 v[74:75], v27 offset:768
    v_mfma_f32_16x16x32_bf16 v[248:251], v[116:119], v[88:91], v[248:251]
    ds_read_b64_tr_b16 v[76:77], v27 offset:12288
    v_mfma_f32_16x16x32_bf16 v[252:255], v[116:119], v[92:95], v[252:255]
    ds_read_b64_tr_b16 v[78:79], v27 offset:13056
    v_mfma_f32_16x16x32_bf16 v[244:247], v[112:115], v[92:95], v[244:247]
    ds_read_b128 v[48:51], v20 offset:45056
    v_mfma_f32_16x16x32_bf16 v[240:243], v[112:115], v[88:91], v[240:243]
    ds_read_b128 v[52:55], v20 offset:45312
    v_mfma_f32_16x16x32_bf16 v[224:227], v[104:107], v[88:91], v[224:227]
    v_mfma_f32_16x16x32_bf16 v[228:231], v[104:107], v[92:95], v[228:231]
    v_mfma_f32_16x16x32_bf16 v[236:239], v[108:111], v[92:95], v[236:239]
    v_mfma_f32_16x16x32_bf16 v[232:235], v[108:111], v[88:91], v[232:235]
    v_mfma_f32_16x16x32_bf16 v[208:211], v[96:99], v[88:91], v[208:211]
    v_mfma_f32_16x16x32_bf16 v[212:215], v[96:99], v[92:95], v[212:215]
    v_mfma_f32_16x16x32_bf16 v[220:223], v[100:103], v[92:95], v[220:223]
    v_mfma_f32_16x16x32_bf16 v[216:219], v[100:103], v[88:91], v[216:219]
    s_waitcnt lgkmcnt(0)
    v_mfma_f32_16x16x32_bf16 v[160:163], v[56:59], v[40:43], v[160:163]
    ds_read_b128 v[80:83], v20 offset:43008
    v_mfma_f32_16x16x32_bf16 v[164:167], v[56:59], v[44:47], v[164:167]
    ds_read_b64_tr_b16 v[96:97], v25 offset:6144
    v_mfma_f32_16x16x32_bf16 v[172:175], v[60:63], v[44:47], v[172:175]
    ds_read_b64_tr_b16 v[98:99], v25 offset:6912
    v_mfma_f32_16x16x32_bf16 v[168:171], v[60:63], v[40:43], v[168:171]
    ds_read_b128 v[84:87], v20 offset:43264
    v_mfma_f32_16x16x32_bf16 v[176:179], v[64:67], v[40:43], v[176:179]
    ds_read_b64_tr_b16 v[100:101], v25 offset:18432
    v_mfma_f32_16x16x32_bf16 v[180:183], v[64:67], v[44:47], v[180:183]
    ds_read_b64_tr_b16 v[102:103], v25 offset:19200
    v_mfma_f32_16x16x32_bf16 v[188:191], v[68:71], v[44:47], v[188:191]
    ds_read_b64_tr_b16 v[104:105], v26 offset:6144
    v_mfma_f32_16x16x32_bf16 v[184:187], v[68:71], v[40:43], v[184:187]
    ds_read_b64_tr_b16 v[106:107], v26 offset:6912
    v_mfma_f32_16x16x32_bf16 v[192:195], v[72:75], v[40:43], v[192:195]
    ds_read_b64_tr_b16 v[108:109], v26 offset:18432
    v_mfma_f32_16x16x32_bf16 v[196:199], v[72:75], v[44:47], v[196:199]
    ds_read_b64_tr_b16 v[110:111], v26 offset:19200
    v_mfma_f32_16x16x32_bf16 v[204:207], v[76:79], v[44:47], v[204:207]
    ds_read_b64_tr_b16 v[112:113], v27 offset:6144
    v_mfma_f32_16x16x32_bf16 v[200:203], v[76:79], v[40:43], v[200:203]
    ds_read_b64_tr_b16 v[114:115], v27 offset:6912
    v_mfma_f32_16x16x32_bf16 v[248:251], v[76:79], v[48:51], v[248:251]
    ds_read_b64_tr_b16 v[116:117], v27 offset:18432
    v_mfma_f32_16x16x32_bf16 v[252:255], v[76:79], v[52:55], v[252:255]
    ds_read_b64_tr_b16 v[118:119], v27 offset:19200
    v_mfma_f32_16x16x32_bf16 v[244:247], v[72:75], v[52:55], v[244:247]
    ds_read_b128 v[88:91], v20 offset:47104
    v_mfma_f32_16x16x32_bf16 v[240:243], v[72:75], v[48:51], v[240:243]
    ds_read_b128 v[92:95], v20 offset:47360
    v_mfma_f32_16x16x32_bf16 v[224:227], v[64:67], v[48:51], v[224:227]
    v_mfma_f32_16x16x32_bf16 v[228:231], v[64:67], v[52:55], v[228:231]
    v_mfma_f32_16x16x32_bf16 v[236:239], v[68:71], v[52:55], v[236:239]
    v_mfma_f32_16x16x32_bf16 v[232:235], v[68:71], v[48:51], v[232:235]
    v_mfma_f32_16x16x32_bf16 v[208:211], v[56:59], v[48:51], v[208:211]
    v_mfma_f32_16x16x32_bf16 v[212:215], v[56:59], v[52:55], v[212:215]
    v_mfma_f32_16x16x32_bf16 v[220:223], v[60:63], v[52:55], v[220:223]
    v_mfma_f32_16x16x32_bf16 v[216:219], v[60:63], v[48:51], v[216:219]
    s_waitcnt lgkmcnt(0)
    s_waitcnt vmcnt(0)
    s_barrier
    v_mfma_f32_16x16x32_bf16 v[160:163], v[96:99], v[80:83], v[160:163]
    ds_read_b128 v[40:43], v21 offset:24576
    v_mfma_f32_16x16x32_bf16 v[164:167], v[96:99], v[84:87], v[164:167]
    ds_read_b64_tr_b16 v[56:57], v25 offset:24576
    v_mfma_f32_16x16x32_bf16 v[172:175], v[100:103], v[84:87], v[172:175]
    ds_read_b64_tr_b16 v[58:59], v25 offset:25344
    v_mfma_f32_16x16x32_bf16 v[168:171], v[100:103], v[80:83], v[168:171]
    ds_read_b128 v[44:47], v21 offset:24832
    v_mfma_f32_16x16x32_bf16 v[176:179], v[104:107], v[80:83], v[176:179]
    ds_read_b64_tr_b16 v[60:61], v25 offset:36864
    v_mfma_f32_16x16x32_bf16 v[180:183], v[104:107], v[84:87], v[180:183]
    ds_read_b64_tr_b16 v[62:63], v25 offset:37632
    v_mfma_f32_16x16x32_bf16 v[188:191], v[108:111], v[84:87], v[188:191]
    ds_read_b64_tr_b16 v[64:65], v26 offset:24576
    v_mfma_f32_16x16x32_bf16 v[184:187], v[108:111], v[80:83], v[184:187]
    ds_read_b64_tr_b16 v[66:67], v26 offset:25344
    v_mfma_f32_16x16x32_bf16 v[192:195], v[112:115], v[80:83], v[192:195]
    ds_read_b64_tr_b16 v[68:69], v26 offset:36864
    v_mfma_f32_16x16x32_bf16 v[196:199], v[112:115], v[84:87], v[196:199]
    ds_read_b64_tr_b16 v[70:71], v26 offset:37632
    v_mfma_f32_16x16x32_bf16 v[204:207], v[116:119], v[84:87], v[204:207]
    ds_read_b64_tr_b16 v[72:73], v27 offset:24576
    v_mfma_f32_16x16x32_bf16 v[200:203], v[116:119], v[80:83], v[200:203]
    ds_read_b64_tr_b16 v[74:75], v27 offset:25344
    v_mfma_f32_16x16x32_bf16 v[248:251], v[116:119], v[88:91], v[248:251]
    ds_read_b64_tr_b16 v[76:77], v27 offset:36864
    v_mfma_f32_16x16x32_bf16 v[252:255], v[116:119], v[92:95], v[252:255]
    ds_read_b64_tr_b16 v[78:79], v27 offset:37632
    v_mfma_f32_16x16x32_bf16 v[244:247], v[112:115], v[92:95], v[244:247]
    ds_read_b128 v[48:51], v21 offset:28672
    v_mfma_f32_16x16x32_bf16 v[240:243], v[112:115], v[88:91], v[240:243]
    ds_read_b128 v[52:55], v21 offset:28928
    v_mfma_f32_16x16x32_bf16 v[224:227], v[104:107], v[88:91], v[224:227]
    v_mfma_f32_16x16x32_bf16 v[228:231], v[104:107], v[92:95], v[228:231]
    v_mfma_f32_16x16x32_bf16 v[236:239], v[108:111], v[92:95], v[236:239]
    v_mfma_f32_16x16x32_bf16 v[232:235], v[108:111], v[88:91], v[232:235]
    v_mfma_f32_16x16x32_bf16 v[208:211], v[96:99], v[88:91], v[208:211]
    v_mfma_f32_16x16x32_bf16 v[212:215], v[96:99], v[92:95], v[212:215]
    v_mfma_f32_16x16x32_bf16 v[220:223], v[100:103], v[92:95], v[220:223]
    v_mfma_f32_16x16x32_bf16 v[216:219], v[100:103], v[88:91], v[216:219]
    s_waitcnt lgkmcnt(0)
    v_mfma_f32_16x16x32_bf16 v[160:163], v[56:59], v[40:43], v[160:163]
    ds_read_b128 v[80:83], v21 offset:26624
    v_mfma_f32_16x16x32_bf16 v[164:167], v[56:59], v[44:47], v[164:167]
    ds_read_b64_tr_b16 v[96:97], v25 offset:30720
    v_mfma_f32_16x16x32_bf16 v[172:175], v[60:63], v[44:47], v[172:175]
    ds_read_b64_tr_b16 v[98:99], v25 offset:31488
    v_mfma_f32_16x16x32_bf16 v[168:171], v[60:63], v[40:43], v[168:171]
    ds_read_b128 v[84:87], v21 offset:26880
    v_mfma_f32_16x16x32_bf16 v[176:179], v[64:67], v[40:43], v[176:179]
    ds_read_b64_tr_b16 v[100:101], v25 offset:43008
    v_mfma_f32_16x16x32_bf16 v[180:183], v[64:67], v[44:47], v[180:183]
    ds_read_b64_tr_b16 v[102:103], v25 offset:43776
    v_mfma_f32_16x16x32_bf16 v[188:191], v[68:71], v[44:47], v[188:191]
    ds_read_b64_tr_b16 v[104:105], v26 offset:30720
    v_mfma_f32_16x16x32_bf16 v[184:187], v[68:71], v[40:43], v[184:187]
    ds_read_b64_tr_b16 v[106:107], v26 offset:31488
    v_mfma_f32_16x16x32_bf16 v[192:195], v[72:75], v[40:43], v[192:195]
    ds_read_b64_tr_b16 v[108:109], v26 offset:43008
    v_mfma_f32_16x16x32_bf16 v[196:199], v[72:75], v[44:47], v[196:199]
    ds_read_b64_tr_b16 v[110:111], v26 offset:43776
    v_mfma_f32_16x16x32_bf16 v[204:207], v[76:79], v[44:47], v[204:207]
    ds_read_b64_tr_b16 v[112:113], v27 offset:30720
    v_mfma_f32_16x16x32_bf16 v[200:203], v[76:79], v[40:43], v[200:203]
    ds_read_b64_tr_b16 v[114:115], v27 offset:31488
    v_mfma_f32_16x16x32_bf16 v[248:251], v[76:79], v[48:51], v[248:251]
    ds_read_b64_tr_b16 v[116:117], v27 offset:43008
    v_mfma_f32_16x16x32_bf16 v[252:255], v[76:79], v[52:55], v[252:255]
    ds_read_b64_tr_b16 v[118:119], v27 offset:43776
    v_mfma_f32_16x16x32_bf16 v[244:247], v[72:75], v[52:55], v[244:247]
    ds_read_b128 v[88:91], v21 offset:30720
    v_mfma_f32_16x16x32_bf16 v[240:243], v[72:75], v[48:51], v[240:243]
    ds_read_b128 v[92:95], v21 offset:30976
    v_mfma_f32_16x16x32_bf16 v[224:227], v[64:67], v[48:51], v[224:227]
    v_mfma_f32_16x16x32_bf16 v[228:231], v[64:67], v[52:55], v[228:231]
    v_mfma_f32_16x16x32_bf16 v[236:239], v[68:71], v[52:55], v[236:239]
    v_mfma_f32_16x16x32_bf16 v[232:235], v[68:71], v[48:51], v[232:235]
    v_mfma_f32_16x16x32_bf16 v[208:211], v[56:59], v[48:51], v[208:211]
    v_mfma_f32_16x16x32_bf16 v[212:215], v[56:59], v[52:55], v[212:215]
    v_mfma_f32_16x16x32_bf16 v[220:223], v[60:63], v[52:55], v[220:223]
    v_mfma_f32_16x16x32_bf16 v[216:219], v[60:63], v[48:51], v[216:219]
    s_waitcnt lgkmcnt(0)
    s_barrier
    v_mfma_f32_16x16x32_bf16 v[160:163], v[96:99], v[80:83], v[160:163]
    ds_read_b128 v[40:43], v21 offset:40960
    v_mfma_f32_16x16x32_bf16 v[164:167], v[96:99], v[84:87], v[164:167]
    ds_read_b64_tr_b16 v[56:57], v28 offset:0
    v_mfma_f32_16x16x32_bf16 v[172:175], v[100:103], v[84:87], v[172:175]
    ds_read_b64_tr_b16 v[58:59], v28 offset:768
    v_mfma_f32_16x16x32_bf16 v[168:171], v[100:103], v[80:83], v[168:171]
    ds_read_b128 v[44:47], v21 offset:41216
    v_mfma_f32_16x16x32_bf16 v[176:179], v[104:107], v[80:83], v[176:179]
    ds_read_b64_tr_b16 v[60:61], v28 offset:12288
    v_mfma_f32_16x16x32_bf16 v[180:183], v[104:107], v[84:87], v[180:183]
    ds_read_b64_tr_b16 v[62:63], v28 offset:13056
    v_mfma_f32_16x16x32_bf16 v[188:191], v[108:111], v[84:87], v[188:191]
    ds_read_b64_tr_b16 v[64:65], v29 offset:0
    v_mfma_f32_16x16x32_bf16 v[184:187], v[108:111], v[80:83], v[184:187]
    ds_read_b64_tr_b16 v[66:67], v29 offset:768
    v_mfma_f32_16x16x32_bf16 v[192:195], v[112:115], v[80:83], v[192:195]
    ds_read_b64_tr_b16 v[68:69], v29 offset:12288
    v_mfma_f32_16x16x32_bf16 v[196:199], v[112:115], v[84:87], v[196:199]
    ds_read_b64_tr_b16 v[70:71], v29 offset:13056
    v_mfma_f32_16x16x32_bf16 v[204:207], v[116:119], v[84:87], v[204:207]
    ds_read_b64_tr_b16 v[72:73], v30 offset:0
    v_mfma_f32_16x16x32_bf16 v[200:203], v[116:119], v[80:83], v[200:203]
    ds_read_b64_tr_b16 v[74:75], v30 offset:768
    v_mfma_f32_16x16x32_bf16 v[248:251], v[116:119], v[88:91], v[248:251]
    ds_read_b64_tr_b16 v[76:77], v30 offset:12288
    v_mfma_f32_16x16x32_bf16 v[252:255], v[116:119], v[92:95], v[252:255]
    ds_read_b64_tr_b16 v[78:79], v30 offset:13056
    v_mfma_f32_16x16x32_bf16 v[244:247], v[112:115], v[92:95], v[244:247]
    ds_read_b128 v[48:51], v21 offset:45056
    v_mfma_f32_16x16x32_bf16 v[240:243], v[112:115], v[88:91], v[240:243]
    ds_read_b128 v[52:55], v21 offset:45312
    v_mfma_f32_16x16x32_bf16 v[224:227], v[104:107], v[88:91], v[224:227]
    v_mfma_f32_16x16x32_bf16 v[228:231], v[104:107], v[92:95], v[228:231]
    v_mfma_f32_16x16x32_bf16 v[236:239], v[108:111], v[92:95], v[236:239]
    v_mfma_f32_16x16x32_bf16 v[232:235], v[108:111], v[88:91], v[232:235]
    v_mfma_f32_16x16x32_bf16 v[208:211], v[96:99], v[88:91], v[208:211]
    v_mfma_f32_16x16x32_bf16 v[212:215], v[96:99], v[92:95], v[212:215]
    v_mfma_f32_16x16x32_bf16 v[220:223], v[100:103], v[92:95], v[220:223]
    v_mfma_f32_16x16x32_bf16 v[216:219], v[100:103], v[88:91], v[216:219]
    s_waitcnt lgkmcnt(0)
    v_mfma_f32_16x16x32_bf16 v[160:163], v[56:59], v[40:43], v[160:163]
    ds_read_b128 v[80:83], v21 offset:43008
    v_mfma_f32_16x16x32_bf16 v[164:167], v[56:59], v[44:47], v[164:167]
    ds_read_b64_tr_b16 v[96:97], v28 offset:6144
    v_mfma_f32_16x16x32_bf16 v[172:175], v[60:63], v[44:47], v[172:175]
    ds_read_b64_tr_b16 v[98:99], v28 offset:6912
    v_mfma_f32_16x16x32_bf16 v[168:171], v[60:63], v[40:43], v[168:171]
    ds_read_b128 v[84:87], v21 offset:43264
    v_mfma_f32_16x16x32_bf16 v[176:179], v[64:67], v[40:43], v[176:179]
    ds_read_b64_tr_b16 v[100:101], v28 offset:18432
    v_mfma_f32_16x16x32_bf16 v[180:183], v[64:67], v[44:47], v[180:183]
    ds_read_b64_tr_b16 v[102:103], v28 offset:19200
    v_mfma_f32_16x16x32_bf16 v[188:191], v[68:71], v[44:47], v[188:191]
    ds_read_b64_tr_b16 v[104:105], v29 offset:6144
    v_mfma_f32_16x16x32_bf16 v[184:187], v[68:71], v[40:43], v[184:187]
    ds_read_b64_tr_b16 v[106:107], v29 offset:6912
    v_mfma_f32_16x16x32_bf16 v[192:195], v[72:75], v[40:43], v[192:195]
    ds_read_b64_tr_b16 v[108:109], v29 offset:18432
    v_mfma_f32_16x16x32_bf16 v[196:199], v[72:75], v[44:47], v[196:199]
    ds_read_b64_tr_b16 v[110:111], v29 offset:19200
    v_mfma_f32_16x16x32_bf16 v[204:207], v[76:79], v[44:47], v[204:207]
    ds_read_b64_tr_b16 v[112:113], v30 offset:6144
    v_mfma_f32_16x16x32_bf16 v[200:203], v[76:79], v[40:43], v[200:203]
    ds_read_b64_tr_b16 v[114:115], v30 offset:6912
    v_mfma_f32_16x16x32_bf16 v[248:251], v[76:79], v[48:51], v[248:251]
    ds_read_b64_tr_b16 v[116:117], v30 offset:18432
    v_mfma_f32_16x16x32_bf16 v[252:255], v[76:79], v[52:55], v[252:255]
    ds_read_b64_tr_b16 v[118:119], v30 offset:19200
    v_mfma_f32_16x16x32_bf16 v[244:247], v[72:75], v[52:55], v[244:247]
    ds_read_b128 v[88:91], v21 offset:47104
    v_mfma_f32_16x16x32_bf16 v[240:243], v[72:75], v[48:51], v[240:243]
    ds_read_b128 v[92:95], v21 offset:47360
    v_mfma_f32_16x16x32_bf16 v[224:227], v[64:67], v[48:51], v[224:227]
    v_mfma_f32_16x16x32_bf16 v[228:231], v[64:67], v[52:55], v[228:231]
    v_mfma_f32_16x16x32_bf16 v[236:239], v[68:71], v[52:55], v[236:239]
    v_mfma_f32_16x16x32_bf16 v[232:235], v[68:71], v[48:51], v[232:235]
    v_mfma_f32_16x16x32_bf16 v[208:211], v[56:59], v[48:51], v[208:211]
    v_mfma_f32_16x16x32_bf16 v[212:215], v[56:59], v[52:55], v[212:215]
    v_mfma_f32_16x16x32_bf16 v[220:223], v[60:63], v[52:55], v[220:223]
    v_mfma_f32_16x16x32_bf16 v[216:219], v[60:63], v[48:51], v[216:219]
    s_waitcnt lgkmcnt(0)
    s_barrier
    v_mfma_f32_16x16x32_bf16 v[160:163], v[96:99], v[80:83], v[160:163]
    ds_read_b128 v[40:43], v20 offset:24576
    v_mfma_f32_16x16x32_bf16 v[164:167], v[96:99], v[84:87], v[164:167]
    ds_read_b64_tr_b16 v[56:57], v22 offset:0
    v_mfma_f32_16x16x32_bf16 v[172:175], v[100:103], v[84:87], v[172:175]
    ds_read_b64_tr_b16 v[58:59], v22 offset:768
    v_mfma_f32_16x16x32_bf16 v[168:171], v[100:103], v[80:83], v[168:171]
    ds_read_b128 v[44:47], v20 offset:24832
    v_mfma_f32_16x16x32_bf16 v[176:179], v[104:107], v[80:83], v[176:179]
    ds_read_b64_tr_b16 v[60:61], v22 offset:12288
    v_mfma_f32_16x16x32_bf16 v[180:183], v[104:107], v[84:87], v[180:183]
    ds_read_b64_tr_b16 v[62:63], v22 offset:13056
    v_mfma_f32_16x16x32_bf16 v[188:191], v[108:111], v[84:87], v[188:191]
    ds_read_b64_tr_b16 v[64:65], v23 offset:0
    v_mfma_f32_16x16x32_bf16 v[184:187], v[108:111], v[80:83], v[184:187]
    ds_read_b64_tr_b16 v[66:67], v23 offset:768
    v_mfma_f32_16x16x32_bf16 v[192:195], v[112:115], v[80:83], v[192:195]
    ds_read_b64_tr_b16 v[68:69], v23 offset:12288
    v_mfma_f32_16x16x32_bf16 v[196:199], v[112:115], v[84:87], v[196:199]
    ds_read_b64_tr_b16 v[70:71], v23 offset:13056
    v_mfma_f32_16x16x32_bf16 v[204:207], v[116:119], v[84:87], v[204:207]
    ds_read_b64_tr_b16 v[72:73], v24 offset:0
    v_mfma_f32_16x16x32_bf16 v[200:203], v[116:119], v[80:83], v[200:203]
    ds_read_b64_tr_b16 v[74:75], v24 offset:768
    v_mfma_f32_16x16x32_bf16 v[248:251], v[116:119], v[88:91], v[248:251]
    ds_read_b64_tr_b16 v[76:77], v24 offset:12288
    v_mfma_f32_16x16x32_bf16 v[252:255], v[116:119], v[92:95], v[252:255]
    ds_read_b64_tr_b16 v[78:79], v24 offset:13056
    v_mfma_f32_16x16x32_bf16 v[244:247], v[112:115], v[92:95], v[244:247]
    ds_read_b128 v[48:51], v20 offset:28672
    v_mfma_f32_16x16x32_bf16 v[240:243], v[112:115], v[88:91], v[240:243]
    ds_read_b128 v[52:55], v20 offset:28928
    v_mfma_f32_16x16x32_bf16 v[224:227], v[104:107], v[88:91], v[224:227]
    v_mfma_f32_16x16x32_bf16 v[228:231], v[104:107], v[92:95], v[228:231]
    v_mfma_f32_16x16x32_bf16 v[236:239], v[108:111], v[92:95], v[236:239]
    v_mfma_f32_16x16x32_bf16 v[232:235], v[108:111], v[88:91], v[232:235]
    v_mfma_f32_16x16x32_bf16 v[208:211], v[96:99], v[88:91], v[208:211]
    v_mfma_f32_16x16x32_bf16 v[212:215], v[96:99], v[92:95], v[212:215]
    v_mfma_f32_16x16x32_bf16 v[220:223], v[100:103], v[92:95], v[220:223]
    v_mfma_f32_16x16x32_bf16 v[216:219], v[100:103], v[88:91], v[216:219]
    s_waitcnt lgkmcnt(0)
    v_mfma_f32_16x16x32_bf16 v[160:163], v[56:59], v[40:43], v[160:163]
    ds_read_b128 v[80:83], v20 offset:26624
    v_mfma_f32_16x16x32_bf16 v[164:167], v[56:59], v[44:47], v[164:167]
    ds_read_b64_tr_b16 v[96:97], v22 offset:6144
    v_mfma_f32_16x16x32_bf16 v[172:175], v[60:63], v[44:47], v[172:175]
    ds_read_b64_tr_b16 v[98:99], v22 offset:6912
    v_mfma_f32_16x16x32_bf16 v[168:171], v[60:63], v[40:43], v[168:171]
    ds_read_b128 v[84:87], v20 offset:26880
    v_mfma_f32_16x16x32_bf16 v[176:179], v[64:67], v[40:43], v[176:179]
    ds_read_b64_tr_b16 v[100:101], v22 offset:18432
    v_mfma_f32_16x16x32_bf16 v[180:183], v[64:67], v[44:47], v[180:183]
    ds_read_b64_tr_b16 v[102:103], v22 offset:19200
    v_mfma_f32_16x16x32_bf16 v[188:191], v[68:71], v[44:47], v[188:191]
    ds_read_b64_tr_b16 v[104:105], v23 offset:6144
    v_mfma_f32_16x16x32_bf16 v[184:187], v[68:71], v[40:43], v[184:187]
    ds_read_b64_tr_b16 v[106:107], v23 offset:6912
    v_mfma_f32_16x16x32_bf16 v[192:195], v[72:75], v[40:43], v[192:195]
    ds_read_b64_tr_b16 v[108:109], v23 offset:18432
    v_mfma_f32_16x16x32_bf16 v[196:199], v[72:75], v[44:47], v[196:199]
    ds_read_b64_tr_b16 v[110:111], v23 offset:19200
    v_mfma_f32_16x16x32_bf16 v[204:207], v[76:79], v[44:47], v[204:207]
    ds_read_b64_tr_b16 v[112:113], v24 offset:6144
    v_mfma_f32_16x16x32_bf16 v[200:203], v[76:79], v[40:43], v[200:203]
    ds_read_b64_tr_b16 v[114:115], v24 offset:6912
    v_mfma_f32_16x16x32_bf16 v[248:251], v[76:79], v[48:51], v[248:251]
    ds_read_b64_tr_b16 v[116:117], v24 offset:18432
    v_mfma_f32_16x16x32_bf16 v[252:255], v[76:79], v[52:55], v[252:255]
    ds_read_b64_tr_b16 v[118:119], v24 offset:19200
    v_mfma_f32_16x16x32_bf16 v[244:247], v[72:75], v[52:55], v[244:247]
    ds_read_b128 v[88:91], v20 offset:30720
    v_mfma_f32_16x16x32_bf16 v[240:243], v[72:75], v[48:51], v[240:243]
    ds_read_b128 v[92:95], v20 offset:30976
    v_mfma_f32_16x16x32_bf16 v[224:227], v[64:67], v[48:51], v[224:227]
    v_mfma_f32_16x16x32_bf16 v[228:231], v[64:67], v[52:55], v[228:231]
    v_mfma_f32_16x16x32_bf16 v[236:239], v[68:71], v[52:55], v[236:239]
    v_mfma_f32_16x16x32_bf16 v[232:235], v[68:71], v[48:51], v[232:235]
    v_mfma_f32_16x16x32_bf16 v[208:211], v[56:59], v[48:51], v[208:211]
    v_mfma_f32_16x16x32_bf16 v[212:215], v[56:59], v[52:55], v[212:215]
    v_mfma_f32_16x16x32_bf16 v[220:223], v[60:63], v[52:55], v[220:223]
    v_mfma_f32_16x16x32_bf16 v[216:219], v[60:63], v[48:51], v[216:219]
    s_waitcnt lgkmcnt(0)
    s_barrier
    v_mfma_f32_16x16x32_bf16 v[160:163], v[96:99], v[80:83], v[160:163]
    ds_read_b128 v[40:43], v20 offset:40960
    v_mfma_f32_16x16x32_bf16 v[164:167], v[96:99], v[84:87], v[164:167]
    ds_read_b64_tr_b16 v[56:57], v25 offset:0
    v_mfma_f32_16x16x32_bf16 v[172:175], v[100:103], v[84:87], v[172:175]
    ds_read_b64_tr_b16 v[58:59], v25 offset:768
    v_mfma_f32_16x16x32_bf16 v[168:171], v[100:103], v[80:83], v[168:171]
    ds_read_b128 v[44:47], v20 offset:41216
    v_mfma_f32_16x16x32_bf16 v[176:179], v[104:107], v[80:83], v[176:179]
    ds_read_b64_tr_b16 v[60:61], v25 offset:12288
    v_mfma_f32_16x16x32_bf16 v[180:183], v[104:107], v[84:87], v[180:183]
    ds_read_b64_tr_b16 v[62:63], v25 offset:13056
    v_mfma_f32_16x16x32_bf16 v[188:191], v[108:111], v[84:87], v[188:191]
    ds_read_b64_tr_b16 v[64:65], v26 offset:0
    v_mfma_f32_16x16x32_bf16 v[184:187], v[108:111], v[80:83], v[184:187]
    ds_read_b64_tr_b16 v[66:67], v26 offset:768
    v_mfma_f32_16x16x32_bf16 v[192:195], v[112:115], v[80:83], v[192:195]
    ds_read_b64_tr_b16 v[68:69], v26 offset:12288
    v_mfma_f32_16x16x32_bf16 v[196:199], v[112:115], v[84:87], v[196:199]
    ds_read_b64_tr_b16 v[70:71], v26 offset:13056
    v_mfma_f32_16x16x32_bf16 v[204:207], v[116:119], v[84:87], v[204:207]
    ds_read_b64_tr_b16 v[72:73], v27 offset:0
    v_mfma_f32_16x16x32_bf16 v[200:203], v[116:119], v[80:83], v[200:203]
    ds_read_b64_tr_b16 v[74:75], v27 offset:768
    v_mfma_f32_16x16x32_bf16 v[248:251], v[116:119], v[88:91], v[248:251]
    ds_read_b64_tr_b16 v[76:77], v27 offset:12288
    v_mfma_f32_16x16x32_bf16 v[252:255], v[116:119], v[92:95], v[252:255]
    ds_read_b64_tr_b16 v[78:79], v27 offset:13056
    v_mfma_f32_16x16x32_bf16 v[244:247], v[112:115], v[92:95], v[244:247]
    ds_read_b128 v[48:51], v20 offset:45056
    v_mfma_f32_16x16x32_bf16 v[240:243], v[112:115], v[88:91], v[240:243]
    ds_read_b128 v[52:55], v20 offset:45312
    v_mfma_f32_16x16x32_bf16 v[224:227], v[104:107], v[88:91], v[224:227]
    v_mfma_f32_16x16x32_bf16 v[228:231], v[104:107], v[92:95], v[228:231]
    v_mfma_f32_16x16x32_bf16 v[236:239], v[108:111], v[92:95], v[236:239]
    v_mfma_f32_16x16x32_bf16 v[232:235], v[108:111], v[88:91], v[232:235]
    v_mfma_f32_16x16x32_bf16 v[208:211], v[96:99], v[88:91], v[208:211]
    v_mfma_f32_16x16x32_bf16 v[212:215], v[96:99], v[92:95], v[212:215]
    v_mfma_f32_16x16x32_bf16 v[220:223], v[100:103], v[92:95], v[220:223]
    v_mfma_f32_16x16x32_bf16 v[216:219], v[100:103], v[88:91], v[216:219]
    s_waitcnt lgkmcnt(0)
    v_mfma_f32_16x16x32_bf16 v[160:163], v[56:59], v[40:43], v[160:163]
    ds_read_b128 v[80:83], v20 offset:43008
    v_mfma_f32_16x16x32_bf16 v[164:167], v[56:59], v[44:47], v[164:167]
    ds_read_b64_tr_b16 v[96:97], v25 offset:6144
    v_mfma_f32_16x16x32_bf16 v[172:175], v[60:63], v[44:47], v[172:175]
    ds_read_b64_tr_b16 v[98:99], v25 offset:6912
    v_mfma_f32_16x16x32_bf16 v[168:171], v[60:63], v[40:43], v[168:171]
    ds_read_b128 v[84:87], v20 offset:43264
    v_mfma_f32_16x16x32_bf16 v[176:179], v[64:67], v[40:43], v[176:179]
    ds_read_b64_tr_b16 v[100:101], v25 offset:18432
    v_mfma_f32_16x16x32_bf16 v[180:183], v[64:67], v[44:47], v[180:183]
    ds_read_b64_tr_b16 v[102:103], v25 offset:19200
    v_mfma_f32_16x16x32_bf16 v[188:191], v[68:71], v[44:47], v[188:191]
    ds_read_b64_tr_b16 v[104:105], v26 offset:6144
    v_mfma_f32_16x16x32_bf16 v[184:187], v[68:71], v[40:43], v[184:187]
    ds_read_b64_tr_b16 v[106:107], v26 offset:6912
    v_mfma_f32_16x16x32_bf16 v[192:195], v[72:75], v[40:43], v[192:195]
    ds_read_b64_tr_b16 v[108:109], v26 offset:18432
    v_mfma_f32_16x16x32_bf16 v[196:199], v[72:75], v[44:47], v[196:199]
    ds_read_b64_tr_b16 v[110:111], v26 offset:19200
    v_mfma_f32_16x16x32_bf16 v[204:207], v[76:79], v[44:47], v[204:207]
    ds_read_b64_tr_b16 v[112:113], v27 offset:6144
    v_mfma_f32_16x16x32_bf16 v[200:203], v[76:79], v[40:43], v[200:203]
    ds_read_b64_tr_b16 v[114:115], v27 offset:6912
    v_mfma_f32_16x16x32_bf16 v[248:251], v[76:79], v[48:51], v[248:251]
    ds_read_b64_tr_b16 v[116:117], v27 offset:18432
    v_mfma_f32_16x16x32_bf16 v[252:255], v[76:79], v[52:55], v[252:255]
    ds_read_b64_tr_b16 v[118:119], v27 offset:19200
    v_mfma_f32_16x16x32_bf16 v[244:247], v[72:75], v[52:55], v[244:247]
    ds_read_b128 v[88:91], v20 offset:47104
    v_mfma_f32_16x16x32_bf16 v[240:243], v[72:75], v[48:51], v[240:243]
    ds_read_b128 v[92:95], v20 offset:47360
    v_mfma_f32_16x16x32_bf16 v[224:227], v[64:67], v[48:51], v[224:227]
    v_mfma_f32_16x16x32_bf16 v[228:231], v[64:67], v[52:55], v[228:231]
    v_mfma_f32_16x16x32_bf16 v[236:239], v[68:71], v[52:55], v[236:239]
    v_mfma_f32_16x16x32_bf16 v[232:235], v[68:71], v[48:51], v[232:235]
    v_mfma_f32_16x16x32_bf16 v[208:211], v[56:59], v[48:51], v[208:211]
    v_mfma_f32_16x16x32_bf16 v[212:215], v[56:59], v[52:55], v[212:215]
    v_mfma_f32_16x16x32_bf16 v[220:223], v[60:63], v[52:55], v[220:223]
    v_mfma_f32_16x16x32_bf16 v[216:219], v[60:63], v[48:51], v[216:219]
    s_waitcnt lgkmcnt(0)
    s_barrier
    v_mfma_f32_16x16x32_bf16 v[160:163], v[96:99], v[80:83], v[160:163]
    ds_read_b128 v[40:43], v21 offset:24576
    v_mfma_f32_16x16x32_bf16 v[164:167], v[96:99], v[84:87], v[164:167]
    ds_read_b64_tr_b16 v[56:57], v25 offset:24576
    v_mfma_f32_16x16x32_bf16 v[172:175], v[100:103], v[84:87], v[172:175]
    ds_read_b64_tr_b16 v[58:59], v25 offset:25344
    v_mfma_f32_16x16x32_bf16 v[168:171], v[100:103], v[80:83], v[168:171]
    ds_read_b128 v[44:47], v21 offset:24832
    v_mfma_f32_16x16x32_bf16 v[176:179], v[104:107], v[80:83], v[176:179]
    ds_read_b64_tr_b16 v[60:61], v25 offset:36864
    v_mfma_f32_16x16x32_bf16 v[180:183], v[104:107], v[84:87], v[180:183]
    ds_read_b64_tr_b16 v[62:63], v25 offset:37632
    v_mfma_f32_16x16x32_bf16 v[188:191], v[108:111], v[84:87], v[188:191]
    ds_read_b64_tr_b16 v[64:65], v26 offset:24576
    v_mfma_f32_16x16x32_bf16 v[184:187], v[108:111], v[80:83], v[184:187]
    ds_read_b64_tr_b16 v[66:67], v26 offset:25344
    v_mfma_f32_16x16x32_bf16 v[192:195], v[112:115], v[80:83], v[192:195]
    ds_read_b64_tr_b16 v[68:69], v26 offset:36864
    v_mfma_f32_16x16x32_bf16 v[196:199], v[112:115], v[84:87], v[196:199]
    ds_read_b64_tr_b16 v[70:71], v26 offset:37632
    v_mfma_f32_16x16x32_bf16 v[204:207], v[116:119], v[84:87], v[204:207]
    ds_read_b64_tr_b16 v[72:73], v27 offset:24576
    v_mfma_f32_16x16x32_bf16 v[200:203], v[116:119], v[80:83], v[200:203]
    ds_read_b64_tr_b16 v[74:75], v27 offset:25344
    v_mfma_f32_16x16x32_bf16 v[248:251], v[116:119], v[88:91], v[248:251]
    ds_read_b64_tr_b16 v[76:77], v27 offset:36864
    v_mfma_f32_16x16x32_bf16 v[252:255], v[116:119], v[92:95], v[252:255]
    ds_read_b64_tr_b16 v[78:79], v27 offset:37632
    v_mfma_f32_16x16x32_bf16 v[244:247], v[112:115], v[92:95], v[244:247]
    ds_read_b128 v[48:51], v21 offset:28672
    v_mfma_f32_16x16x32_bf16 v[240:243], v[112:115], v[88:91], v[240:243]
    ds_read_b128 v[52:55], v21 offset:28928
    v_mfma_f32_16x16x32_bf16 v[224:227], v[104:107], v[88:91], v[224:227]
    v_mfma_f32_16x16x32_bf16 v[228:231], v[104:107], v[92:95], v[228:231]
    v_mfma_f32_16x16x32_bf16 v[236:239], v[108:111], v[92:95], v[236:239]
    v_mfma_f32_16x16x32_bf16 v[232:235], v[108:111], v[88:91], v[232:235]
    v_mfma_f32_16x16x32_bf16 v[208:211], v[96:99], v[88:91], v[208:211]
    v_mfma_f32_16x16x32_bf16 v[212:215], v[96:99], v[92:95], v[212:215]
    v_mfma_f32_16x16x32_bf16 v[220:223], v[100:103], v[92:95], v[220:223]
    v_mfma_f32_16x16x32_bf16 v[216:219], v[100:103], v[88:91], v[216:219]
    s_waitcnt lgkmcnt(0)
    v_mfma_f32_16x16x32_bf16 v[160:163], v[56:59], v[40:43], v[160:163]
    ds_read_b128 v[80:83], v21 offset:26624
    v_mfma_f32_16x16x32_bf16 v[164:167], v[56:59], v[44:47], v[164:167]
    ds_read_b64_tr_b16 v[96:97], v25 offset:30720
    v_mfma_f32_16x16x32_bf16 v[172:175], v[60:63], v[44:47], v[172:175]
    ds_read_b64_tr_b16 v[98:99], v25 offset:31488
    v_mfma_f32_16x16x32_bf16 v[168:171], v[60:63], v[40:43], v[168:171]
    ds_read_b128 v[84:87], v21 offset:26880
    v_mfma_f32_16x16x32_bf16 v[176:179], v[64:67], v[40:43], v[176:179]
    ds_read_b64_tr_b16 v[100:101], v25 offset:43008
    v_mfma_f32_16x16x32_bf16 v[180:183], v[64:67], v[44:47], v[180:183]
    ds_read_b64_tr_b16 v[102:103], v25 offset:43776
    v_mfma_f32_16x16x32_bf16 v[188:191], v[68:71], v[44:47], v[188:191]
    ds_read_b64_tr_b16 v[104:105], v26 offset:30720
    v_mfma_f32_16x16x32_bf16 v[184:187], v[68:71], v[40:43], v[184:187]
    ds_read_b64_tr_b16 v[106:107], v26 offset:31488
    v_mfma_f32_16x16x32_bf16 v[192:195], v[72:75], v[40:43], v[192:195]
    ds_read_b64_tr_b16 v[108:109], v26 offset:43008
    v_mfma_f32_16x16x32_bf16 v[196:199], v[72:75], v[44:47], v[196:199]
    ds_read_b64_tr_b16 v[110:111], v26 offset:43776
    v_mfma_f32_16x16x32_bf16 v[204:207], v[76:79], v[44:47], v[204:207]
    ds_read_b64_tr_b16 v[112:113], v27 offset:30720
    v_mfma_f32_16x16x32_bf16 v[200:203], v[76:79], v[40:43], v[200:203]
    ds_read_b64_tr_b16 v[114:115], v27 offset:31488
    v_mfma_f32_16x16x32_bf16 v[248:251], v[76:79], v[48:51], v[248:251]
    ds_read_b64_tr_b16 v[116:117], v27 offset:43008
    v_mfma_f32_16x16x32_bf16 v[252:255], v[76:79], v[52:55], v[252:255]
    ds_read_b64_tr_b16 v[118:119], v27 offset:43776
    v_mfma_f32_16x16x32_bf16 v[244:247], v[72:75], v[52:55], v[244:247]
    ds_read_b128 v[88:91], v21 offset:30720
    v_mfma_f32_16x16x32_bf16 v[240:243], v[72:75], v[48:51], v[240:243]
    ds_read_b128 v[92:95], v21 offset:30976
    v_mfma_f32_16x16x32_bf16 v[224:227], v[64:67], v[48:51], v[224:227]
    v_mfma_f32_16x16x32_bf16 v[228:231], v[64:67], v[52:55], v[228:231]
    v_mfma_f32_16x16x32_bf16 v[236:239], v[68:71], v[52:55], v[236:239]
    v_mfma_f32_16x16x32_bf16 v[232:235], v[68:71], v[48:51], v[232:235]
    v_mfma_f32_16x16x32_bf16 v[208:211], v[56:59], v[48:51], v[208:211]
    v_mfma_f32_16x16x32_bf16 v[212:215], v[56:59], v[52:55], v[212:215]
    v_mfma_f32_16x16x32_bf16 v[220:223], v[60:63], v[52:55], v[220:223]
    v_mfma_f32_16x16x32_bf16 v[216:219], v[60:63], v[48:51], v[216:219]
    s_waitcnt lgkmcnt(0)
    s_barrier
    v_mfma_f32_16x16x32_bf16 v[160:163], v[96:99], v[80:83], v[160:163]
    ds_read_b128 v[40:43], v21 offset:40960
    ds_read_b64_tr_b16 v[56:57], v28 offset:0
    v_mfma_f32_16x16x32_bf16 v[164:167], v[96:99], v[84:87], v[164:167]
    ds_read_b64_tr_b16 v[58:59], v28 offset:768
    v_mfma_f32_16x16x32_bf16 v[172:175], v[100:103], v[84:87], v[172:175]
    ds_read_b128 v[44:47], v21 offset:41216
    v_mfma_f32_16x16x32_bf16 v[168:171], v[100:103], v[80:83], v[168:171]
    ds_read_b64_tr_b16 v[60:61], v28 offset:12288
    ds_read_b64_tr_b16 v[62:63], v28 offset:13056
    v_mfma_f32_16x16x32_bf16 v[176:179], v[104:107], v[80:83], v[176:179]
    ds_read_b64_tr_b16 v[64:65], v29 offset:0
    v_mfma_f32_16x16x32_bf16 v[180:183], v[104:107], v[84:87], v[180:183]
    ds_read_b64_tr_b16 v[66:67], v29 offset:768
    v_mfma_f32_16x16x32_bf16 v[188:191], v[108:111], v[84:87], v[188:191]
    ds_read_b64_tr_b16 v[68:69], v29 offset:12288
    ds_read_b64_tr_b16 v[70:71], v29 offset:13056
    v_mfma_f32_16x16x32_bf16 v[184:187], v[108:111], v[80:83], v[184:187]
    ds_read_b64_tr_b16 v[72:73], v30 offset:0
    v_mfma_f32_16x16x32_bf16 v[192:195], v[112:115], v[80:83], v[192:195]
    ds_read_b64_tr_b16 v[74:75], v30 offset:768
    v_mfma_f32_16x16x32_bf16 v[196:199], v[112:115], v[84:87], v[196:199]
    ds_read_b64_tr_b16 v[76:77], v30 offset:12288
    v_mfma_f32_16x16x32_bf16 v[204:207], v[116:119], v[84:87], v[204:207]
    ds_read_b64_tr_b16 v[78:79], v30 offset:13056
    ds_read_b128 v[48:51], v21 offset:45056
    v_mfma_f32_16x16x32_bf16 v[200:203], v[116:119], v[80:83], v[200:203]
    ds_read_b128 v[52:55], v21 offset:45312
    v_mfma_f32_16x16x32_bf16 v[248:251], v[116:119], v[88:91], v[248:251]
    ds_read_b128 v[120:123], v7 offset:0
    v_mfma_f32_16x16x32_bf16 v[252:255], v[116:119], v[92:95], v[252:255]
    ds_read_b128 v[124:127], v7 offset:64
    ds_read_b128 v[128:131], v7 offset:128
    v_mfma_f32_16x16x32_bf16 v[244:247], v[112:115], v[92:95], v[244:247]
    ds_read_b128 v[132:135], v7 offset:192
    v_mfma_f32_16x16x32_bf16 v[240:243], v[112:115], v[88:91], v[240:243]
    ds_read_b128 v[136:139], v7 offset:256
    v_mfma_f32_16x16x32_bf16 v[224:227], v[104:107], v[88:91], v[224:227]
    ds_read_b128 v[140:143], v7 offset:320
    ds_read_b32 v144, v8 offset:0
    v_mfma_f32_16x16x32_bf16 v[228:231], v[104:107], v[92:95], v[228:231]
    ds_read_b32 v145, v8 offset:128
    v_mfma_f32_16x16x32_bf16 v[236:239], v[108:111], v[92:95], v[236:239]
    ds_read_b32 v146, v8 offset:256
    v_mfma_f32_16x16x32_bf16 v[232:235], v[108:111], v[88:91], v[232:235]
    ds_read_b32 v147, v8 offset:384
    v_mfma_f32_16x16x32_bf16 v[208:211], v[96:99], v[88:91], v[208:211]
    v_mfma_f32_16x16x32_bf16 v[212:215], v[96:99], v[92:95], v[212:215]
    v_mfma_f32_16x16x32_bf16 v[220:223], v[100:103], v[92:95], v[220:223]
    v_mfma_f32_16x16x32_bf16 v[216:219], v[100:103], v[88:91], v[216:219]
    s_waitcnt lgkmcnt(0)
    v_mfma_f32_16x16x32_bf16 v[160:163], v[56:59], v[40:43], v[160:163]
    v_fmac_f32 v248, v146, v140
    ds_read_b128 v[80:83], v21 offset:43008
    ds_read_b64_tr_b16 v[96:97], v28 offset:6144
    v_mfma_f32_16x16x32_bf16 v[164:167], v[56:59], v[44:47], v[164:167]
    v_fmac_f32 v249, v146, v141
    ds_read_b64_tr_b16 v[98:99], v28 offset:6912
    v_mfma_f32_16x16x32_bf16 v[172:175], v[60:63], v[44:47], v[172:175]
    v_fmac_f32 v250, v146, v142
    v_fmac_f32 v251, v146, v143
    ds_read_b128 v[84:87], v21 offset:43264
    v_mfma_f32_16x16x32_bf16 v[168:171], v[60:63], v[40:43], v[168:171]
    v_fmac_f32 v240, v146, v136
    ds_read_b64_tr_b16 v[100:101], v28 offset:18432
    v_mfma_f32_16x16x32_bf16 v[176:179], v[64:67], v[40:43], v[176:179]
    v_fmac_f32 v241, v146, v137
    ds_read_b64_tr_b16 v[102:103], v28 offset:19200
    ds_read_b64_tr_b16 v[104:105], v29 offset:6144
    v_mfma_f32_16x16x32_bf16 v[180:183], v[64:67], v[44:47], v[180:183]
    v_fmac_f32 v242, v146, v138
    v_fmac_f32 v243, v146, v139
    ds_read_b64_tr_b16 v[106:107], v29 offset:6912
    v_mfma_f32_16x16x32_bf16 v[188:191], v[68:71], v[44:47], v[188:191]
    v_fmac_f32 v236, v147, v132
    ds_read_b64_tr_b16 v[108:109], v29 offset:18432
    v_mfma_f32_16x16x32_bf16 v[184:187], v[68:71], v[40:43], v[184:187]
    v_fmac_f32 v237, v147, v133
    ds_read_b64_tr_b16 v[110:111], v29 offset:19200
    v_mfma_f32_16x16x32_bf16 v[192:195], v[72:75], v[40:43], v[192:195]
    v_fmac_f32 v238, v147, v134
    v_fmac_f32 v239, v147, v135
    ds_read_b64_tr_b16 v[112:113], v30 offset:6144
    ds_read_b64_tr_b16 v[114:115], v30 offset:6912
    v_mfma_f32_16x16x32_bf16 v[196:199], v[72:75], v[44:47], v[196:199]
    v_fmac_f32 v212, v147, v120
    ds_read_b64_tr_b16 v[116:117], v30 offset:18432
    v_mfma_f32_16x16x32_bf16 v[204:207], v[76:79], v[44:47], v[204:207]
    v_fmac_f32 v213, v147, v121
    ds_read_b64_tr_b16 v[118:119], v30 offset:19200
    v_mfma_f32_16x16x32_bf16 v[200:203], v[76:79], v[40:43], v[200:203]
    v_fmac_f32 v214, v147, v122
    v_fmac_f32 v215, v147, v123
    ds_read_b128 v[88:91], v21 offset:47104
    v_mfma_f32_16x16x32_bf16 v[248:251], v[76:79], v[48:51], v[248:251]
    v_fmac_f32 v160, v144, v120
    ds_read_b128 v[92:95], v21 offset:47360
    ds_read_b64 v[32:33], v8 offset:1024
    v_mfma_f32_16x16x32_bf16 v[252:255], v[76:79], v[52:55], v[252:255]
    v_fmac_f32 v161, v144, v121
    ds_read_b64 v[34:35], v8 offset:1152
    v_mfma_f32_16x16x32_bf16 v[244:247], v[72:75], v[52:55], v[244:247]
    v_fmac_f32 v162, v144, v122
    v_fmac_f32 v163, v144, v123
    ds_read_b64 v[36:37], v8 offset:1280
    v_mfma_f32_16x16x32_bf16 v[240:243], v[72:75], v[48:51], v[240:243]
    v_fmac_f32 v168, v144, v124
    ds_read_b64 v[38:39], v8 offset:1408
    v_mfma_f32_16x16x32_bf16 v[224:227], v[64:67], v[48:51], v[224:227]
    v_fmac_f32 v169, v144, v125
    v_mfma_f32_16x16x32_bf16 v[228:231], v[64:67], v[52:55], v[228:231]
    v_fmac_f32 v170, v144, v126
    v_fmac_f32 v171, v144, v127
    v_fmac_f32 v188, v145, v132
    v_mfma_f32_16x16x32_bf16 v[236:239], v[68:71], v[52:55], v[236:239]
    v_fmac_f32 v189, v145, v133
    v_mfma_f32_16x16x32_bf16 v[232:235], v[68:71], v[48:51], v[232:235]
    v_fmac_f32 v190, v145, v134
    v_mfma_f32_16x16x32_bf16 v[208:211], v[56:59], v[48:51], v[208:211]
    v_fmac_f32 v191, v145, v135
    v_fmac_f32 v196, v145, v136
    v_mfma_f32_16x16x32_bf16 v[212:215], v[56:59], v[52:55], v[212:215]
    v_fmac_f32 v197, v145, v137
    v_mfma_f32_16x16x32_bf16 v[220:223], v[60:63], v[52:55], v[220:223]
    v_fmac_f32 v198, v145, v138
    v_mfma_f32_16x16x32_bf16 v[216:219], v[60:63], v[48:51], v[216:219]
    v_fmac_f32 v199, v145, v139
    s_waitcnt lgkmcnt(0)
    s_barrier
    v_mfma_f32_16x16x32_bf16 v[160:163], v[96:99], v[80:83], v[160:163]
    v_fmac_f32 v252, v147, v140
    ds_read_b128 v[40:43], v20 offset:24576
    v_mfma_f32_16x16x32_bf16 v[164:167], v[96:99], v[84:87], v[164:167]
    v_fmac_f32 v253, v147, v141
    ds_read_b64_tr_b16 v[56:57], v22 offset:0
    v_mfma_f32_16x16x32_bf16 v[172:175], v[100:103], v[84:87], v[172:175]
    v_fmac_f32 v254, v147, v142
    v_fmac_f32 v255, v147, v143
    ds_read_b64_tr_b16 v[58:59], v22 offset:768
    v_mfma_f32_16x16x32_bf16 v[168:171], v[100:103], v[80:83], v[168:171]
    v_fmac_f32 v224, v146, v128
    ds_read_b128 v[44:47], v20 offset:24832
    v_mfma_f32_16x16x32_bf16 v[176:179], v[104:107], v[80:83], v[176:179]
    v_fmac_f32 v225, v146, v129
    ds_read_b64_tr_b16 v[60:61], v22 offset:12288
    v_mfma_f32_16x16x32_bf16 v[180:183], v[104:107], v[84:87], v[180:183]
    v_fmac_f32 v226, v146, v130
    v_fmac_f32 v227, v146, v131
    ds_read_b64_tr_b16 v[62:63], v22 offset:13056
    v_mfma_f32_16x16x32_bf16 v[188:191], v[108:111], v[84:87], v[188:191]
    v_fmac_f32 v232, v146, v132
    ds_read_b64_tr_b16 v[64:65], v23 offset:0
    v_mfma_f32_16x16x32_bf16 v[184:187], v[108:111], v[80:83], v[184:187]
    v_fmac_f32 v233, v146, v133
    ds_read_b64_tr_b16 v[66:67], v23 offset:768
    v_mfma_f32_16x16x32_bf16 v[192:195], v[112:115], v[80:83], v[192:195]
    v_fmac_f32 v234, v146, v134
    v_fmac_f32 v235, v146, v135
    ds_read_b64_tr_b16 v[68:69], v23 offset:12288
    v_mfma_f32_16x16x32_bf16 v[196:199], v[112:115], v[84:87], v[196:199]
    v_fmac_f32 v220, v147, v124
    ds_read_b64_tr_b16 v[70:71], v23 offset:13056
    v_mfma_f32_16x16x32_bf16 v[204:207], v[116:119], v[84:87], v[204:207]
    v_fmac_f32 v221, v147, v125
    ds_read_b64_tr_b16 v[72:73], v24 offset:0
    v_mfma_f32_16x16x32_bf16 v[200:203], v[116:119], v[80:83], v[200:203]
    v_fmac_f32 v222, v147, v126
    v_fmac_f32 v223, v147, v127
    ds_read_b64_tr_b16 v[74:75], v24 offset:768
    v_mfma_f32_16x16x32_bf16 v[248:251], v[116:119], v[88:91], v[248:251]
    v_fmac_f32 v164, v145, v120
    ds_read_b64_tr_b16 v[76:77], v24 offset:12288
    v_mfma_f32_16x16x32_bf16 v[252:255], v[116:119], v[92:95], v[252:255]
    v_fmac_f32 v165, v145, v121
    ds_read_b64_tr_b16 v[78:79], v24 offset:13056
    v_mfma_f32_16x16x32_bf16 v[244:247], v[112:115], v[92:95], v[244:247]
    v_fmac_f32 v166, v145, v122
    v_fmac_f32 v167, v145, v123
    ds_read_b128 v[48:51], v20 offset:28672
    v_mfma_f32_16x16x32_bf16 v[240:243], v[112:115], v[88:91], v[240:243]
    v_fmac_f32 v176, v144, v128
    ds_read_b128 v[52:55], v20 offset:28928
    v_mfma_f32_16x16x32_bf16 v[224:227], v[104:107], v[88:91], v[224:227]
    v_fmac_f32 v177, v144, v129
    v_mfma_f32_16x16x32_bf16 v[228:231], v[104:107], v[92:95], v[228:231]
    v_fmac_f32 v178, v144, v130
    v_fmac_f32 v179, v144, v131
    v_fmac_f32 v184, v144, v132
    v_mfma_f32_16x16x32_bf16 v[236:239], v[108:111], v[92:95], v[236:239]
    v_fmac_f32 v185, v144, v133
    v_mfma_f32_16x16x32_bf16 v[232:235], v[108:111], v[88:91], v[232:235]
    v_fmac_f32 v186, v144, v134
    v_mfma_f32_16x16x32_bf16 v[208:211], v[96:99], v[88:91], v[208:211]
    v_fmac_f32 v187, v144, v135
    v_fmac_f32 v204, v145, v140
    v_mfma_f32_16x16x32_bf16 v[212:215], v[96:99], v[92:95], v[212:215]
    v_fmac_f32 v205, v145, v141
    v_mfma_f32_16x16x32_bf16 v[220:223], v[100:103], v[92:95], v[220:223]
    v_fmac_f32 v206, v145, v142
    v_mfma_f32_16x16x32_bf16 v[216:219], v[100:103], v[88:91], v[216:219]
    v_fmac_f32 v207, v145, v143
    s_waitcnt lgkmcnt(0)
    v_mfma_f32_16x16x32_bf16 v[160:163], v[56:59], v[40:43], v[160:163]
    v_fmac_f32 v244, v147, v136
    ds_read_b128 v[80:83], v20 offset:26624
    v_mfma_f32_16x16x32_bf16 v[164:167], v[56:59], v[44:47], v[164:167]
    v_fmac_f32 v245, v147, v137
    ds_read_b64_tr_b16 v[96:97], v22 offset:6144
    v_mfma_f32_16x16x32_bf16 v[172:175], v[60:63], v[44:47], v[172:175]
    v_fmac_f32 v246, v147, v138
    v_fmac_f32 v247, v147, v139
    ds_read_b64_tr_b16 v[98:99], v22 offset:6912
    v_mfma_f32_16x16x32_bf16 v[168:171], v[60:63], v[40:43], v[168:171]
    v_fmac_f32 v228, v147, v128
    ds_read_b128 v[84:87], v20 offset:26880
    v_mfma_f32_16x16x32_bf16 v[176:179], v[64:67], v[40:43], v[176:179]
    v_fmac_f32 v229, v147, v129
    ds_read_b64_tr_b16 v[100:101], v22 offset:18432
    v_mfma_f32_16x16x32_bf16 v[180:183], v[64:67], v[44:47], v[180:183]
    v_fmac_f32 v230, v147, v130
    v_fmac_f32 v231, v147, v131
    ds_read_b64_tr_b16 v[102:103], v22 offset:19200
    v_mfma_f32_16x16x32_bf16 v[188:191], v[68:71], v[44:47], v[188:191]
    v_fmac_f32 v208, v146, v120
    ds_read_b64_tr_b16 v[104:105], v23 offset:6144
    v_mfma_f32_16x16x32_bf16 v[184:187], v[68:71], v[40:43], v[184:187]
    v_fmac_f32 v209, v146, v121
    ds_read_b64_tr_b16 v[106:107], v23 offset:6912
    v_mfma_f32_16x16x32_bf16 v[192:195], v[72:75], v[40:43], v[192:195]
    v_fmac_f32 v210, v146, v122
    v_fmac_f32 v211, v146, v123
    ds_read_b64_tr_b16 v[108:109], v23 offset:18432
    v_mfma_f32_16x16x32_bf16 v[196:199], v[72:75], v[44:47], v[196:199]
    v_fmac_f32 v216, v146, v124
    ds_read_b64_tr_b16 v[110:111], v23 offset:19200
    v_mfma_f32_16x16x32_bf16 v[204:207], v[76:79], v[44:47], v[204:207]
    v_fmac_f32 v217, v146, v125
    ds_read_b64_tr_b16 v[112:113], v24 offset:6144
    v_mfma_f32_16x16x32_bf16 v[200:203], v[76:79], v[40:43], v[200:203]
    v_fmac_f32 v218, v146, v126
    v_fmac_f32 v219, v146, v127
    ds_read_b64_tr_b16 v[114:115], v24 offset:6912
    v_mfma_f32_16x16x32_bf16 v[248:251], v[76:79], v[48:51], v[248:251]
    v_fmac_f32 v172, v145, v124
    ds_read_b64_tr_b16 v[116:117], v24 offset:18432
    v_mfma_f32_16x16x32_bf16 v[252:255], v[76:79], v[52:55], v[252:255]
    v_fmac_f32 v173, v145, v125
    ds_read_b64_tr_b16 v[118:119], v24 offset:19200
    v_mfma_f32_16x16x32_bf16 v[244:247], v[72:75], v[52:55], v[244:247]
    v_fmac_f32 v174, v145, v126
    v_fmac_f32 v175, v145, v127
    ds_read_b128 v[88:91], v20 offset:30720
    v_mfma_f32_16x16x32_bf16 v[240:243], v[72:75], v[48:51], v[240:243]
    v_fmac_f32 v180, v145, v128
    ds_read_b128 v[92:95], v20 offset:30976
    v_mfma_f32_16x16x32_bf16 v[224:227], v[64:67], v[48:51], v[224:227]
    v_fmac_f32 v181, v145, v129
    v_mfma_f32_16x16x32_bf16 v[228:231], v[64:67], v[52:55], v[228:231]
    v_fmac_f32 v182, v145, v130
    v_fmac_f32 v183, v145, v131
    v_fmac_f32 v192, v144, v136
    v_mfma_f32_16x16x32_bf16 v[236:239], v[68:71], v[52:55], v[236:239]
    v_fmac_f32 v193, v144, v137
    v_mfma_f32_16x16x32_bf16 v[232:235], v[68:71], v[48:51], v[232:235]
    v_fmac_f32 v194, v144, v138
    v_mfma_f32_16x16x32_bf16 v[208:211], v[56:59], v[48:51], v[208:211]
    v_fmac_f32 v195, v144, v139
    v_fmac_f32 v200, v144, v140
    v_mfma_f32_16x16x32_bf16 v[212:215], v[56:59], v[52:55], v[212:215]
    v_fmac_f32 v201, v144, v141
    v_mfma_f32_16x16x32_bf16 v[220:223], v[60:63], v[52:55], v[220:223]
    v_fmac_f32 v202, v144, v142
    v_mfma_f32_16x16x32_bf16 v[216:219], v[60:63], v[48:51], v[216:219]
    v_fmac_f32 v203, v144, v143
    s_waitcnt lgkmcnt(0)
    s_barrier
    v_mfma_f32_16x16x32_bf16 v[160:163], v[96:99], v[80:83], v[160:163]
    v_mfma_f32_16x16x32_bf16 v[164:167], v[96:99], v[84:87], v[164:167]
    v_mfma_f32_16x16x32_bf16 v[172:175], v[100:103], v[84:87], v[172:175]
    v_mfma_f32_16x16x32_bf16 v[168:171], v[100:103], v[80:83], v[168:171]
    v_mfma_f32_16x16x32_bf16 v[176:179], v[104:107], v[80:83], v[176:179]
    v_mfma_f32_16x16x32_bf16 v[180:183], v[104:107], v[84:87], v[180:183]
    s_nop 2
    v_mul_f32 v40, v160, v32
    v_mul_f32 v41, v161, v32
    v_mfma_f32_16x16x32_bf16 v[188:191], v[108:111], v[84:87], v[188:191]
    v_mul_f32 v42, v162, v32
    v_mul_f32 v43, v163, v32
    v_mfma_f32_16x16x32_bf16 v[184:187], v[108:111], v[80:83], v[184:187]
    v_mul_f32 v44, v164, v34
    v_mul_f32 v45, v165, v34
    v_mfma_f32_16x16x32_bf16 v[192:195], v[112:115], v[80:83], v[192:195]
    v_mul_f32 v46, v166, v34
    v_mul_f32 v47, v167, v34
    v_mfma_f32_16x16x32_bf16 v[196:199], v[112:115], v[84:87], v[196:199]
    v_exp_f32 v40, v40
    v_mfma_f32_16x16x32_bf16 v[204:207], v[116:119], v[84:87], v[204:207]
    v_exp_f32 v41, v41
    v_mfma_f32_16x16x32_bf16 v[200:203], v[116:119], v[80:83], v[200:203]
    v_exp_f32 v42, v42
    v_mfma_f32_16x16x32_bf16 v[248:251], v[116:119], v[88:91], v[248:251]
    v_exp_f32 v43, v43
    v_mfma_f32_16x16x32_bf16 v[252:255], v[116:119], v[92:95], v[252:255]
    v_exp_f32 v44, v44
    v_mfma_f32_16x16x32_bf16 v[244:247], v[112:115], v[92:95], v[244:247]
    v_exp_f32 v45, v45
    v_mfma_f32_16x16x32_bf16 v[240:243], v[112:115], v[88:91], v[240:243]
    v_exp_f32 v46, v46
    v_mfma_f32_16x16x32_bf16 v[224:227], v[104:107], v[88:91], v[224:227]
    v_exp_f32 v47, v47
    v_mfma_f32_16x16x32_bf16 v[228:231], v[104:107], v[92:95], v[228:231]
    v_fma_f32 v40, v40, v33, v33
    v_fma_f32 v41, v41, v33, v33
    v_mfma_f32_16x16x32_bf16 v[236:239], v[108:111], v[92:95], v[236:239]
    v_fma_f32 v42, v42, v33, v33
    v_fma_f32 v43, v43, v33, v33
    v_mfma_f32_16x16x32_bf16 v[232:235], v[108:111], v[88:91], v[232:235]
    v_fma_f32 v44, v44, v35, v35
    v_fma_f32 v45, v45, v35, v35
    v_mfma_f32_16x16x32_bf16 v[208:211], v[96:99], v[88:91], v[208:211]
    v_fma_f32 v46, v46, v35, v35
    v_fma_f32 v47, v47, v35, v35
    v_mfma_f32_16x16x32_bf16 v[212:215], v[96:99], v[92:95], v[212:215]
    v_rcp_f32 v40, v40
    v_mfma_f32_16x16x32_bf16 v[220:223], v[100:103], v[92:95], v[220:223]
    v_rcp_f32 v41, v41
    v_mfma_f32_16x16x32_bf16 v[216:219], v[100:103], v[88:91], v[216:219]
    v_rcp_f32 v42, v42
    v_rcp_f32 v43, v43
    v_rcp_f32 v44, v44
    v_rcp_f32 v45, v45
    v_rcp_f32 v46, v46
    v_rcp_f32 v47, v47
    v_mul_f32 v160, v160, v168
    v_mul_f32 v161, v161, v169
    v_mul_f32 v162, v162, v170
    v_mul_f32 v163, v163, v171
    v_mul_f32 v164, v164, v172
    v_mul_f32 v165, v165, v173
    v_mul_f32 v166, v166, v174
    v_mul_f32 v167, v167, v175
    v_mul_f32 v160, v160, v40
    v_mul_f32 v161, v161, v41
    v_mul_f32 v162, v162, v42
    v_mul_f32 v163, v163, v43
    v_mul_f32 v164, v164, v44
    v_mul_f32 v165, v165, v45
    v_mul_f32 v166, v166, v46
    v_mul_f32 v167, v167, v47
    v_cvt_pk_bf16_f32 v160, v160, v161
    v_cvt_pk_bf16_f32 v161, v162, v163
    v_cvt_pk_bf16_f32 v162, v164, v165
    v_cvt_pk_bf16_f32 v163, v166, v167
    s_nop 0
    v_permlane16_swap_b32 v160, v162
    v_permlane16_swap_b32 v161, v163
    buffer_store_dwordx4 v[160:163], v31, s[20:23], s4 offen offset:0 sc1
    v_pk_mul_f32 v[48:49], v[176:177], v[32:33] op_sel:[0,0] op_sel_hi:[1,0]
    v_pk_mul_f32 v[50:51], v[178:179], v[32:33] op_sel:[0,0] op_sel_hi:[1,0]
    v_pk_mul_f32 v[52:53], v[180:181], v[34:35] op_sel:[0,0] op_sel_hi:[1,0]
    v_pk_mul_f32 v[54:55], v[182:183], v[34:35] op_sel:[0,0] op_sel_hi:[1,0]
    v_exp_f32 v48, v48
    v_exp_f32 v49, v49
    v_exp_f32 v50, v50
    v_exp_f32 v51, v51
    v_exp_f32 v52, v52
    v_exp_f32 v53, v53
    v_exp_f32 v54, v54
    v_exp_f32 v55, v55
    v_pk_fma_f32 v[48:49], v[48:49], v[32:33], v[32:33] op_sel:[0,1,1] op_sel_hi:[1,1,1]
    v_pk_fma_f32 v[50:51], v[50:51], v[32:33], v[32:33] op_sel:[0,1,1] op_sel_hi:[1,1,1]
    v_pk_fma_f32 v[52:53], v[52:53], v[34:35], v[34:35] op_sel:[0,1,1] op_sel_hi:[1,1,1]
    v_pk_fma_f32 v[54:55], v[54:55], v[34:35], v[34:35] op_sel:[0,1,1] op_sel_hi:[1,1,1]
    v_rcp_f32 v48, v48
    v_rcp_f32 v49, v49
    v_rcp_f32 v50, v50
    v_rcp_f32 v51, v51
    v_rcp_f32 v52, v52
    v_rcp_f32 v53, v53
    v_rcp_f32 v54, v54
    v_rcp_f32 v55, v55
    v_pk_mul_f32 v[176:177], v[176:177], v[184:185]
    v_pk_mul_f32 v[178:179], v[178:179], v[186:187]
    v_pk_mul_f32 v[180:181], v[180:181], v[188:189]
    v_pk_mul_f32 v[182:183], v[182:183], v[190:191]
    v_pk_mul_f32 v[176:177], v[176:177], v[48:49]
    v_pk_mul_f32 v[178:179], v[178:179], v[50:51]
    v_pk_mul_f32 v[180:181], v[180:181], v[52:53]
    v_pk_mul_f32 v[182:183], v[182:183], v[54:55]
    v_cvt_pk_bf16_f32 v176, v176, v177
    v_cvt_pk_bf16_f32 v177, v178, v179
    v_cvt_pk_bf16_f32 v178, v180, v181
    v_cvt_pk_bf16_f32 v179, v182, v183
    s_nop 0
    v_permlane16_swap_b32 v176, v178
    v_permlane16_swap_b32 v177, v179
    buffer_store_dwordx4 v[176:179], v31, s[20:23], s4 offen offset:512 sc1
    v_pk_mul_f32 v[40:41], v[192:193], v[32:33] op_sel:[0,0] op_sel_hi:[1,0]
    v_pk_mul_f32 v[42:43], v[194:195], v[32:33] op_sel:[0,0] op_sel_hi:[1,0]
    v_pk_mul_f32 v[44:45], v[196:197], v[34:35] op_sel:[0,0] op_sel_hi:[1,0]
    v_pk_mul_f32 v[46:47], v[198:199], v[34:35] op_sel:[0,0] op_sel_hi:[1,0]
    v_exp_f32 v40, v40
    v_exp_f32 v41, v41
    v_exp_f32 v42, v42
    v_exp_f32 v43, v43
    v_exp_f32 v44, v44
    v_exp_f32 v45, v45
    v_exp_f32 v46, v46
    v_exp_f32 v47, v47
    v_pk_fma_f32 v[40:41], v[40:41], v[32:33], v[32:33] op_sel:[0,1,1] op_sel_hi:[1,1,1]
    v_pk_fma_f32 v[42:43], v[42:43], v[32:33], v[32:33] op_sel:[0,1,1] op_sel_hi:[1,1,1]
    v_pk_fma_f32 v[44:45], v[44:45], v[34:35], v[34:35] op_sel:[0,1,1] op_sel_hi:[1,1,1]
    v_pk_fma_f32 v[46:47], v[46:47], v[34:35], v[34:35] op_sel:[0,1,1] op_sel_hi:[1,1,1]
    v_rcp_f32 v40, v40
    v_rcp_f32 v41, v41
    v_rcp_f32 v42, v42
    v_rcp_f32 v43, v43
    v_rcp_f32 v44, v44
    v_rcp_f32 v45, v45
    v_rcp_f32 v46, v46
    v_rcp_f32 v47, v47
    v_pk_mul_f32 v[192:193], v[192:193], v[200:201]
    v_pk_mul_f32 v[194:195], v[194:195], v[202:203]
    v_pk_mul_f32 v[196:197], v[196:197], v[204:205]
    v_pk_mul_f32 v[198:199], v[198:199], v[206:207]
    v_pk_mul_f32 v[192:193], v[192:193], v[40:41]
    v_pk_mul_f32 v[194:195], v[194:195], v[42:43]
    v_pk_mul_f32 v[196:197], v[196:197], v[44:45]
    v_pk_mul_f32 v[198:199], v[198:199], v[46:47]
    v_cvt_pk_bf16_f32 v192, v192, v193
    v_cvt_pk_bf16_f32 v193, v194, v195
    v_cvt_pk_bf16_f32 v194, v196, v197
    v_cvt_pk_bf16_f32 v195, v198, v199
    s_nop 0
    v_permlane16_swap_b32 v192, v194
    v_permlane16_swap_b32 v193, v195
    buffer_store_dwordx4 v[192:195], v31, s[20:23], s4 offen offset:1024 sc1
    v_pk_mul_f32 v[48:49], v[240:241], v[36:37] op_sel:[0,0] op_sel_hi:[1,0]
    v_pk_mul_f32 v[50:51], v[242:243], v[36:37] op_sel:[0,0] op_sel_hi:[1,0]
    v_pk_mul_f32 v[52:53], v[244:245], v[38:39] op_sel:[0,0] op_sel_hi:[1,0]
    v_pk_mul_f32 v[54:55], v[246:247], v[38:39] op_sel:[0,0] op_sel_hi:[1,0]
    v_exp_f32 v48, v48
    v_exp_f32 v49, v49
    v_exp_f32 v50, v50
    v_exp_f32 v51, v51
    v_exp_f32 v52, v52
    v_exp_f32 v53, v53
    v_exp_f32 v54, v54
    v_exp_f32 v55, v55
    v_pk_fma_f32 v[48:49], v[48:49], v[36:37], v[36:37] op_sel:[0,1,1] op_sel_hi:[1,1,1]
    v_pk_fma_f32 v[50:51], v[50:51], v[36:37], v[36:37] op_sel:[0,1,1] op_sel_hi:[1,1,1]
    v_pk_fma_f32 v[52:53], v[52:53], v[38:39], v[38:39] op_sel:[0,1,1] op_sel_hi:[1,1,1]
    v_pk_fma_f32 v[54:55], v[54:55], v[38:39], v[38:39] op_sel:[0,1,1] op_sel_hi:[1,1,1]
    v_rcp_f32 v48, v48
    v_rcp_f32 v49, v49
    v_rcp_f32 v50, v50
    v_rcp_f32 v51, v51
    v_rcp_f32 v52, v52
    v_rcp_f32 v53, v53
    v_rcp_f32 v54, v54
    v_rcp_f32 v55, v55
    v_pk_mul_f32 v[240:241], v[240:241], v[248:249]
    v_pk_mul_f32 v[242:243], v[242:243], v[250:251]
    v_pk_mul_f32 v[244:245], v[244:245], v[252:253]
    v_pk_mul_f32 v[246:247], v[246:247], v[254:255]
    v_pk_mul_f32 v[240:241], v[240:241], v[48:49]
    v_pk_mul_f32 v[242:243], v[242:243], v[50:51]
    v_pk_mul_f32 v[244:245], v[244:245], v[52:53]
    v_pk_mul_f32 v[246:247], v[246:247], v[54:55]
    v_cvt_pk_bf16_f32 v240, v240, v241
    v_cvt_pk_bf16_f32 v241, v242, v243
    v_cvt_pk_bf16_f32 v242, v244, v245
    v_cvt_pk_bf16_f32 v243, v246, v247
    s_nop 0
    v_permlane16_swap_b32 v240, v242
    v_permlane16_swap_b32 v241, v243
    buffer_store_dwordx4 v[240:243], v31, s[20:23], s5 offen offset:1024 sc1
    v_add_u32 v21, 122880, v2
    s_barrier
    v_pk_mul_f32 v[40:41], v[224:225], v[36:37] op_sel:[0,0] op_sel_hi:[1,0]
    ds_read_b128 v[96:99], v21 offset:0
    v_pk_mul_f32 v[42:43], v[226:227], v[36:37] op_sel:[0,0] op_sel_hi:[1,0]
    v_pk_mul_f32 v[44:45], v[228:229], v[38:39] op_sel:[0,0] op_sel_hi:[1,0]
    v_pk_mul_f32 v[46:47], v[230:231], v[38:39] op_sel:[0,0] op_sel_hi:[1,0]
    v_exp_f32 v40, v40
    ds_read_b128 v[100:103], v21 offset:1024
    v_exp_f32 v41, v41
    v_exp_f32 v42, v42
    v_exp_f32 v43, v43
    v_exp_f32 v44, v44
    v_exp_f32 v45, v45
    ds_read_b128 v[104:107], v21 offset:2048
    v_exp_f32 v46, v46
    v_exp_f32 v47, v47
    v_pk_fma_f32 v[40:41], v[40:41], v[36:37], v[36:37] op_sel:[0,1,1] op_sel_hi:[1,1,1]
    v_pk_fma_f32 v[42:43], v[42:43], v[36:37], v[36:37] op_sel:[0,1,1] op_sel_hi:[1,1,1]
    v_pk_fma_f32 v[44:45], v[44:45], v[38:39], v[38:39] op_sel:[0,1,1] op_sel_hi:[1,1,1]
    ds_read_b128 v[108:111], v21 offset:3072
    v_pk_fma_f32 v[46:47], v[46:47], v[38:39], v[38:39] op_sel:[0,1,1] op_sel_hi:[1,1,1]
    v_rcp_f32 v40, v40
    v_rcp_f32 v41, v41
    v_rcp_f32 v42, v42
    v_rcp_f32 v43, v43
    ds_read_b128 v[112:115], v21 offset:4096
    v_rcp_f32 v44, v44
    v_rcp_f32 v45, v45
    v_rcp_f32 v46, v46
    v_rcp_f32 v47, v47
    ds_read_b128 v[116:119], v21 offset:5120
    v_pk_mul_f32 v[224:225], v[224:225], v[232:233]
    v_pk_mul_f32 v[226:227], v[226:227], v[234:235]
    v_pk_mul_f32 v[228:229], v[228:229], v[236:237]
    v_pk_mul_f32 v[230:231], v[230:231], v[238:239]
    v_pk_mul_f32 v[224:225], v[224:225], v[40:41]
    ds_read_b128 v[120:123], v21 offset:6144
    v_pk_mul_f32 v[226:227], v[226:227], v[42:43]
    v_pk_mul_f32 v[228:229], v[228:229], v[44:45]
    v_pk_mul_f32 v[230:231], v[230:231], v[46:47]
    v_cvt_pk_bf16_f32 v224, v224, v225
    v_cvt_pk_bf16_f32 v225, v226, v227
    ds_read_b128 v[124:127], v21 offset:7168
    v_cvt_pk_bf16_f32 v226, v228, v229
    v_cvt_pk_bf16_f32 v227, v230, v231
    s_nop 0
    v_permlane16_swap_b32 v224, v226
    v_permlane16_swap_b32 v225, v227
    buffer_store_dwordx4 v[224:227], v31, s[20:23], s5 offen offset:512 sc1
    v_pk_mul_f32 v[48:49], v[208:209], v[36:37] op_sel:[0,0] op_sel_hi:[1,0]
    ds_read_b128 v[128:131], v21 offset:8192
    v_pk_mul_f32 v[50:51], v[210:211], v[36:37] op_sel:[0,0] op_sel_hi:[1,0]
    v_pk_mul_f32 v[52:53], v[212:213], v[38:39] op_sel:[0,0] op_sel_hi:[1,0]
    v_pk_mul_f32 v[54:55], v[214:215], v[38:39] op_sel:[0,0] op_sel_hi:[1,0]
    v_exp_f32 v48, v48
    v_exp_f32 v49, v49
    ds_read_b128 v[132:135], v21 offset:9216
    v_exp_f32 v50, v50
    v_exp_f32 v51, v51
    v_exp_f32 v52, v52
    v_exp_f32 v53, v53
    v_exp_f32 v54, v54
    ds_read_b128 v[136:139], v21 offset:10240
    v_exp_f32 v55, v55
    v_pk_fma_f32 v[48:49], v[48:49], v[36:37], v[36:37] op_sel:[0,1,1] op_sel_hi:[1,1,1]
    v_pk_fma_f32 v[50:51], v[50:51], v[36:37], v[36:37] op_sel:[0,1,1] op_sel_hi:[1,1,1]
    v_pk_fma_f32 v[52:53], v[52:53], v[38:39], v[38:39] op_sel:[0,1,1] op_sel_hi:[1,1,1]
    v_pk_fma_f32 v[54:55], v[54:55], v[38:39], v[38:39] op_sel:[0,1,1] op_sel_hi:[1,1,1]
    v_rcp_f32 v48, v48
    ds_read_b128 v[140:143], v21 offset:11264
    v_rcp_f32 v49, v49
    v_rcp_f32 v50, v50
    v_rcp_f32 v51, v51
    v_rcp_f32 v52, v52
    v_rcp_f32 v53, v53
    ds_read_b128 v[144:147], v21 offset:12288
    v_rcp_f32 v54, v54
    v_rcp_f32 v55, v55
    v_pk_mul_f32 v[208:209], v[208:209], v[216:217]
    v_pk_mul_f32 v[210:211], v[210:211], v[218:219]
    v_pk_mul_f32 v[212:213], v[212:213], v[220:221]
    v_pk_mul_f32 v[214:215], v[214:215], v[222:223]
    ds_read_b128 v[148:151], v21 offset:13312
    v_pk_mul_f32 v[208:209], v[208:209], v[48:49]
    v_pk_mul_f32 v[210:211], v[210:211], v[50:51]
    v_pk_mul_f32 v[212:213], v[212:213], v[52:53]
    v_pk_mul_f32 v[214:215], v[214:215], v[54:55]
    v_cvt_pk_bf16_f32 v208, v208, v209
    ds_read_b128 v[152:155], v21 offset:14336
    v_cvt_pk_bf16_f32 v209, v210, v211
    v_cvt_pk_bf16_f32 v210, v212, v213
    v_cvt_pk_bf16_f32 v211, v214, v215
    s_nop 0
    v_permlane16_swap_b32 v208, v210
    v_permlane16_swap_b32 v209, v211
    buffer_store_dwordx4 v[208:211], v31, s[20:23], s5 offen offset:0 sc1
    s_mul_i32 s58, s26, 245760
    s_add_u32 s58, s58, 19398656
    v_add_u32 v35, 4096, v2
mega_kernel_d_done:
    s_and_b32 s28, s24, 3
    s_lshr_b32 s29, s24, 2
    s_mul_i32 s53, s29, 40960
    v_add_u32 v20, s53, v2
    v_add_u32 v21, 81920, v20
    s_sub_u32 s53, 122880, s53
    v_add_u32 v21, s53, v2
    s_cmp_ge_u32 s24, 4
    s_cbranch_scc1 mega_kernel_e_pe
    ds_read_b128 v[156:159], v21 offset:15360
    ds_read_b128 v[160:163], v21 offset:16384
    ds_read_b128 v[164:167], v21 offset:17408
    ds_read_b128 v[168:171], v21 offset:18432
    ds_read_b128 v[172:175], v21 offset:19456
    ds_read_b128 v[176:179], v21 offset:20480
    ds_read_b128 v[180:183], v21 offset:21504
    ds_read_b128 v[184:187], v21 offset:22528
    ds_read_b128 v[188:191], v21 offset:23552
    ds_read_b128 v[192:195], v21 offset:24576
    ds_read_b128 v[196:199], v21 offset:25600
    ds_read_b128 v[200:203], v21 offset:26624
    ds_read_b128 v[204:207], v21 offset:27648
    ds_read_b128 v[208:211], v21 offset:28672
    ds_read_b128 v[212:215], v21 offset:29696
    ds_read_b128 v[216:219], v21 offset:30720
    ds_read_b128 v[220:223], v21 offset:31744
    ds_read_b128 v[224:227], v21 offset:32768
    ds_read_b128 v[228:231], v21 offset:33792
    ds_read_b128 v[232:235], v21 offset:34816
    ds_read_b128 v[236:239], v21 offset:35840
    ds_read_b128 v[240:243], v21 offset:36864
    ds_read_b128 v[244:247], v21 offset:37888
    ds_read_b128 v[248:251], v21 offset:38912
    ds_read_b128 v[252:255], v21 offset:39936
mega_kernel_e_pe:
    s_lshl_b32 s52, s96, 11
    s_lshl_b32 s53, s97, 2
    s_add_u32 s52, s52, s53
    s_add_u32 s52, s52, 22484992
    v_lshlrev_b32 v5, 7, v1
    s_add_u32 s54, s24, 16
    s_mul_i32 s54, s54, 5120
    s_add_u32 s54, s54, s58
    s_add_u32 s55, s54, 122880
    s_mul_i32 s53, s24, 5120
    s_lshl_b32 s61, s97, 2
    s_add_u32 s52, s52, s61
    s_lshr_b32 s61, s24, 1
    s_lshl_b32 s61, s61, 10
    s_add_u32 s52, s52, s61
    s_and_b32 s61, s24, 1
    s_lshl_b32 s61, s61, 2
    s_add_u32 s52, s52, s61
    v_mov_b32 v8, s3
    s_cmp_ge_u32 s24, 4
    s_cbranch_scc1 mega_kernel_d_nf
    s_mov_b64 exec, 0xff
    s_waitcnt vmcnt(0)
    buffer_store_dword v8, v5, s[20:23], s52 offen sc1
    s_mov_b64 exec, -1
mega_kernel_d_nf:
    s_waitcnt lgkmcnt(0)
    s_barrier
    s_add_u32 m0, s53, 122880
    s_nop 0
    buffer_load_dwordx4 v2, s[20:23], s54 offen offset:0 sc1 lds
    buffer_load_dwordx4 v2, s[20:23], s54 offen offset:1024 sc1 lds
    buffer_load_dwordx4 v2, s[20:23], s54 offen offset:2048 sc1 lds
    buffer_load_dwordx4 v2, s[20:23], s54 offen offset:3072 sc1 lds
    s_add_u32 m0, s53, 126976
    s_nop 0
    buffer_load_dwordx4 v35, s[20:23], s54 offen sc1 lds
    s_add_u32 m0, s53, 81920
    s_nop 0
    buffer_load_dwordx4 v2, s[20:23], s55 offen offset:0 sc1 lds
    buffer_load_dwordx4 v2, s[20:23], s55 offen offset:1024 sc1 lds
    buffer_load_dwordx4 v2, s[20:23], s55 offen offset:2048 sc1 lds
    buffer_load_dwordx4 v2, s[20:23], s55 offen offset:3072 sc1 lds
    s_add_u32 m0, s53, 86016
    s_nop 0
    buffer_load_dwordx4 v35, s[20:23], s55 offen sc1 lds
    v_lshrrev_b32 v6, 4, v1
    v_and_b32 v31, 15, v1
    s_lshl_b32 s52, s25, 2
    s_add_u32 s27, s52, s28
    s_mul_i32 s52, s27, 20480
    s_mul_i32 s53, s26, 160
    s_add_u32 s30, s52, s53
    v_mul_u32_u24 v22, 1280, v31
    v_lshl_add_u32 v23, v6, 3, v22
    v_lshl_add_u32 v22, v3, 4, v22
    v_bfe_u32 v5, v1, 4, 1
    v_lshl_add_u32 v22, v5, 5, v22
    s_mul_i32 s52, s28, 5120
    s_add_u32 s52, s52, 0
    v_add_u32 v24, s52, v2
    v_permlane16_swap_b32 v10, v12
    v_permlane16_swap_b32 v11, v13
    v_permlane16_swap_b32 v14, v16
    v_permlane16_swap_b32 v15, v17
    v_lshlrev_b32 v36, 16, v10
    v_and_b32 v37, 0xffff0000, v10
    v_lshlrev_b32 v38, 16, v11
    v_and_b32 v39, 0xffff0000, v11
    v_lshlrev_b32 v40, 16, v12
    v_and_b32 v41, 0xffff0000, v12
    v_lshlrev_b32 v42, 16, v13
    v_and_b32 v43, 0xffff0000, v13
    v_lshlrev_b32 v44, 16, v14
    v_and_b32 v45, 0xffff0000, v14
    v_lshlrev_b32 v46, 16, v15
    v_and_b32 v47, 0xffff0000, v15
    v_lshlrev_b32 v48, 16, v16
    v_and_b32 v49, 0xffff0000, v16
    v_lshlrev_b32 v50, 16, v17
    v_and_b32 v51, 0xffff0000, v17
    v_lshlrev_b32 v52, 16, v18
    v_and_b32 v53, 0xffff0000, v18
    v_lshlrev_b32 v54, 16, v19
    v_and_b32 v55, 0xffff0000, v19
    s_mul_i32 s52, s27, 49152
    s_add_u32 s52, s52, 13107200
    s_mul_i32 s54, s29, 24576
    s_add_u32 s54, s54, s52
    s_add_u32 s5, s54, 24576
    s_mul_i32 s4, s26, 0
    s_add_u32 s4, s4, s54
    s_mov_b32 s6, s54
    s_mov_b32 s12, s46
    s_mov_b32 s13, s47
    s_mov_b32 s14, 2621440
    s_mov_b32 s15, 0x20000
    s_cmp_lg_u32 s24, 1
    s_cbranch_scc1 mega_kernel_e_np
    s_lshl_b32 s52, s25, 3
    s_add_u32 s52, s52, s26
    s_lshl_b32 s52, s52, 7
    s_add_u32 s52, s52, 22484992
    v_lshlrev_b32 v7, 2, v1
    s_nop 15
    s_nop 15
    s_nop 15
    s_nop 15
    s_nop 15
    s_nop 15
    s_nop 15
    s_nop 15
    s_mov_b32 exec_lo, -1
    s_mov_b32 exec_hi, 0
    s_mov_b32 s61, 0
mega_kernel_pl4:
    buffer_load_dword v88, v7, s[20:23], s52 offen sc1
    s_waitcnt vmcnt(0)
    v_cmp_ne_u32 vcc, s3, v88
    s_add_u32 s61, s61, 1
    s_cbranch_vccz mega_kernel_pd4
    s_cmp_lt_u32 s61, 40000
    s_cbranch_scc1 mega_kernel_pl4
mega_kernel_pd4:
    s_mov_b64 exec, -1
    s_branch mega_kernel_e_go
mega_kernel_e_np:
    s_xor_b32 s52, s24, 2
    s_or_b32 s52, s52, s2
    s_cmp_lg_u32 s52, 0
    s_cbranch_scc1 mega_kernel_e_ne
    v_lshrrev_b32 v5, 3, v1
    v_and_b32 v6, 7, v1
    v_lshlrev_b32 v6, 4, v6
    v_lshl_add_u32 v7, v5, 12, v6
    s_mov_b32 s52, 22419456
    s_mov_b32 exec_lo, -1
    s_mov_b32 exec_hi, -1
    s_mov_b32 s61, 0
mega_kernel_pl5:
    buffer_load_dwordx4 v[56:59], v7, s[20:23], s52 offen sc1
    s_waitcnt vmcnt(0)
    v_xor_b32 v56, s3, v56
    v_xor_b32 v57, s3, v57
    v_xor_b32 v58, s3, v58
    v_xor_b32 v59, s3, v59
    v_or3_b32 v56, v56, v57, v58
    v_or_b32 v56, v56, v59
    v_cmp_ne_u32 vcc, 0, v56
    s_add_u32 s61, s61, 1
    s_cbranch_vccz mega_kernel_pd5
    s_cmp_lt_u32 s61, 40000
    s_cbranch_scc1 mega_kernel_pl5
mega_kernel_pd5:
    s_mov_b64 exec, -1
    v_mov_b32 v5, 0
    v_mov_b32 v6, s3
    s_mov_b32 s52, 22517760
    s_mov_b64 exec, 1
    buffer_store_dword v6, v5, s[20:23], s52 offen sc1
    s_mov_b64 exec, -1
mega_kernel_e_ne:
    s_waitcnt vmcnt(0)
mega_kernel_e_go:
    s_barrier
    s_mov_b32 s61, 0
    buffer_load_dwordx4 v[56:59], v2, s[20:23], s4 offen sc1
    s_add_u32 s4, s4, 1024
    buffer_load_dwordx4 v[60:63], v2, s[20:23], s4 offen sc1
    s_add_u32 s4, s4, 1024
    buffer_load_dwordx4 v[64:67], v2, s[20:23], s4 offen sc1
    s_add_u32 s4, s4, 1024
    buffer_load_dwordx4 v[68:71], v2, s[20:23], s4 offen sc1
    s_add_u32 s4, s4, 1024
    buffer_load_dwordx4 v[72:75], v2, s[20:23], s4 offen sc1
    s_add_u32 s4, s4, 1024
    buffer_load_dwordx4 v[76:79], v2, s[20:23], s4 offen sc1
    s_add_u32 s4, s4, 1024
    s_waitcnt vmcnt(5)
    v_mfma_f32_16x16x32_bf16 v[36:39], v[96:99], v[56:59], v[36:39]
    buffer_load_dwordx4 v[80:83], v2, s[20:23], s4 offen sc1
    s_add_u32 s4, s4, 1024
    v_mfma_f32_16x16x32_bf16 v[40:43], v[100:103], v[56:59], v[40:43]
    v_mfma_f32_16x16x32_bf16 v[44:47], v[104:107], v[56:59], v[44:47]
    v_mfma_f32_16x16x32_bf16 v[48:51], v[108:111], v[56:59], v[48:51]
    v_mfma_f32_16x16x32_bf16 v[52:55], v[112:115], v[56:59], v[52:55]
    s_waitcnt vmcnt(5)
    v_mfma_f32_16x16x32_bf16 v[36:39], v[116:119], v[60:63], v[36:39]
    buffer_load_dwordx4 v[84:87], v2, s[20:23], s4 offen sc1
    s_add_u32 s4, s4, 1024
    ds_read_b128 v[96:99], v20 offset:0
    v_mfma_f32_16x16x32_bf16 v[40:43], v[120:123], v[60:63], v[40:43]
    ds_read_b128 v[100:103], v20 offset:1024
    v_mfma_f32_16x16x32_bf16 v[44:47], v[124:127], v[60:63], v[44:47]
    ds_read_b128 v[104:107], v20 offset:2048
    v_mfma_f32_16x16x32_bf16 v[48:51], v[128:131], v[60:63], v[48:51]
    ds_read_b128 v[108:111], v20 offset:3072
    v_mfma_f32_16x16x32_bf16 v[52:55], v[132:135], v[60:63], v[52:55]
    ds_read_b128 v[112:115], v20 offset:4096
    s_waitcnt vmcnt(5)
    v_mfma_f32_16x16x32_bf16 v[36:39], v[136:139], v[64:67], v[36:39]
    buffer_load_dwordx4 v[88:91], v2, s[20:23], s4 offen sc1
    s_add_u32 s4, s4, 1024
    ds_read_b128 v[116:119], v20 offset:5120
    v_mfma_f32_16x16x32_bf16 v[40:43], v[140:143], v[64:67], v[40:43]
    ds_read_b128 v[120:123], v20 offset:6144
    v_mfma_f32_16x16x32_bf16 v[44:47], v[144:147], v[64:67], v[44:47]
    ds_read_b128 v[124:127], v20 offset:7168
    v_mfma_f32_16x16x32_bf16 v[48:51], v[148:151], v[64:67], v[48:51]
    ds_read_b128 v[128:131], v20 offset:8192
    v_mfma_f32_16x16x32_bf16 v[52:55], v[152:155], v[64:67], v[52:55]
    ds_read_b128 v[132:135], v20 offset:9216
    s_waitcnt vmcnt(5)
    v_mfma_f32_16x16x32_bf16 v[36:39], v[156:159], v[68:71], v[36:39]
    buffer_load_dwordx4 v[92:95], v2, s[20:23], s4 offen sc1
    s_add_u32 s4, s4, 1024
    ds_read_b128 v[136:139], v20 offset:10240
    v_mfma_f32_16x16x32_bf16 v[40:43], v[160:163], v[68:71], v[40:43]
    ds_read_b128 v[140:143], v20 offset:11264
    v_mfma_f32_16x16x32_bf16 v[44:47], v[164:167], v[68:71], v[44:47]
    ds_read_b128 v[144:147], v20 offset:12288
    v_mfma_f32_16x16x32_bf16 v[48:51], v[168:171], v[68:71], v[48:51]
    ds_read_b128 v[148:151], v20 offset:13312
    v_mfma_f32_16x16x32_bf16 v[52:55], v[172:175], v[68:71], v[52:55]
    ds_read_b128 v[152:155], v20 offset:14336
    s_waitcnt vmcnt(5)
    v_mfma_f32_16x16x32_bf16 v[36:39], v[176:179], v[72:75], v[36:39]
    buffer_load_dwordx4 v[56:59], v2, s[20:23], s4 offen sc1
    s_add_u32 s4, s4, 1024
    ds_read_b128 v[156:159], v20 offset:15360
    v_mfma_f32_16x16x32_bf16 v[40:43], v[180:183], v[72:75], v[40:43]
    ds_read_b128 v[160:163], v20 offset:16384
    v_mfma_f32_16x16x32_bf16 v[44:47], v[184:187], v[72:75], v[44:47]
    ds_read_b128 v[164:167], v20 offset:17408
    v_mfma_f32_16x16x32_bf16 v[48:51], v[188:191], v[72:75], v[48:51]
    ds_read_b128 v[168:171], v20 offset:18432
    v_mfma_f32_16x16x32_bf16 v[52:55], v[192:195], v[72:75], v[52:55]
    ds_read_b128 v[172:175], v20 offset:19456
    s_waitcnt vmcnt(5)
    v_mfma_f32_16x16x32_bf16 v[36:39], v[196:199], v[76:79], v[36:39]
    buffer_load_dwordx4 v[60:63], v2, s[20:23], s4 offen sc1
    s_add_u32 s4, s4, 1024
    ds_read_b128 v[176:179], v20 offset:20480
    v_mfma_f32_16x16x32_bf16 v[40:43], v[200:203], v[76:79], v[40:43]
    ds_read_b128 v[180:183], v20 offset:21504
    v_mfma_f32_16x16x32_bf16 v[44:47], v[204:207], v[76:79], v[44:47]
    ds_read_b128 v[184:187], v20 offset:22528
    v_mfma_f32_16x16x32_bf16 v[48:51], v[208:211], v[76:79], v[48:51]
    ds_read_b128 v[188:191], v20 offset:23552
    v_mfma_f32_16x16x32_bf16 v[52:55], v[212:215], v[76:79], v[52:55]
    ds_read_b128 v[192:195], v20 offset:24576
    s_waitcnt vmcnt(5)
    v_mfma_f32_16x16x32_bf16 v[36:39], v[216:219], v[80:83], v[36:39]
    buffer_load_dwordx4 v[64:67], v2, s[20:23], s4 offen sc1
    s_add_u32 s4, s4, 1024
    ds_read_b128 v[196:199], v20 offset:25600
    v_mfma_f32_16x16x32_bf16 v[40:43], v[220:223], v[80:83], v[40:43]
    ds_read_b128 v[200:203], v20 offset:26624
    v_mfma_f32_16x16x32_bf16 v[44:47], v[224:227], v[80:83], v[44:47]
    ds_read_b128 v[204:207], v20 offset:27648
    v_mfma_f32_16x16x32_bf16 v[48:51], v[228:231], v[80:83], v[48:51]
    ds_read_b128 v[208:211], v20 offset:28672
    v_mfma_f32_16x16x32_bf16 v[52:55], v[232:235], v[80:83], v[52:55]
    ds_read_b128 v[212:215], v20 offset:29696
    s_waitcnt vmcnt(5)
    v_mfma_f32_16x16x32_bf16 v[36:39], v[236:239], v[84:87], v[36:39]
    buffer_load_dwordx4 v[68:71], v2, s[20:23], s4 offen sc1
    s_add_u32 s4, s4, 1024
    ds_read_b128 v[216:219], v20 offset:30720
    v_mfma_f32_16x16x32_bf16 v[40:43], v[240:243], v[84:87], v[40:43]
    ds_read_b128 v[220:223], v20 offset:31744
    v_mfma_f32_16x16x32_bf16 v[44:47], v[244:247], v[84:87], v[44:47]
    ds_read_b128 v[224:227], v20 offset:32768
    v_mfma_f32_16x16x32_bf16 v[48:51], v[248:251], v[84:87], v[48:51]
    ds_read_b128 v[228:231], v20 offset:33792
    v_mfma_f32_16x16x32_bf16 v[52:55], v[252:255], v[84:87], v[52:55]
    ds_read_b128 v[232:235], v20 offset:34816
    s_waitcnt vmcnt(5) lgkmcnt(10)
    v_mfma_f32_16x16x32_bf16 v[36:39], v[96:99], v[88:91], v[36:39]
    buffer_load_dwordx4 v[72:75], v2, s[20:23], s4 offen sc1
    s_add_u32 s4, s4, 1024
    ds_read_b128 v[236:239], v20 offset:35840
    v_mfma_f32_16x16x32_bf16 v[40:43], v[100:103], v[88:91], v[40:43]
    ds_read_b128 v[240:243], v20 offset:36864
    v_mfma_f32_16x16x32_bf16 v[44:47], v[104:107], v[88:91], v[44:47]
    ds_read_b128 v[244:247], v20 offset:37888
    v_mfma_f32_16x16x32_bf16 v[48:51], v[108:111], v[88:91], v[48:51]
    ds_read_b128 v[248:251], v20 offset:38912
    v_mfma_f32_16x16x32_bf16 v[52:55], v[112:115], v[88:91], v[52:55]
    ds_read_b128 v[252:255], v20 offset:39936
    s_waitcnt vmcnt(5) lgkmcnt(10)
    v_mfma_f32_16x16x32_bf16 v[36:39], v[116:119], v[92:95], v[36:39]
    buffer_load_dwordx4 v[76:79], v2, s[20:23], s4 offen sc1
    s_add_u32 s4, s4, 1024
    ds_read_b128 v[96:99], v21 offset:0
    v_mfma_f32_16x16x32_bf16 v[40:43], v[120:123], v[92:95], v[40:43]
    ds_read_b128 v[100:103], v21 offset:1024
    v_mfma_f32_16x16x32_bf16 v[44:47], v[124:127], v[92:95], v[44:47]
    ds_read_b128 v[104:107], v21 offset:2048
    v_mfma_f32_16x16x32_bf16 v[48:51], v[128:131], v[92:95], v[48:51]
    ds_read_b128 v[108:111], v21 offset:3072
    v_mfma_f32_16x16x32_bf16 v[52:55], v[132:135], v[92:95], v[52:55]
    ds_read_b128 v[112:115], v21 offset:4096
    s_waitcnt vmcnt(5) lgkmcnt(10)
    v_mfma_f32_16x16x32_bf16 v[36:39], v[136:139], v[56:59], v[36:39]
    buffer_load_dwordx4 v[80:83], v2, s[20:23], s4 offen sc1
    s_add_u32 s4, s4, 1024
    ds_read_b128 v[116:119], v21 offset:5120
    v_mfma_f32_16x16x32_bf16 v[40:43], v[140:143], v[56:59], v[40:43]
    ds_read_b128 v[120:123], v21 offset:6144
    v_mfma_f32_16x16x32_bf16 v[44:47], v[144:147], v[56:59], v[44:47]
    ds_read_b128 v[124:127], v21 offset:7168
    v_mfma_f32_16x16x32_bf16 v[48:51], v[148:151], v[56:59], v[48:51]
    ds_read_b128 v[128:131], v21 offset:8192
    v_mfma_f32_16x16x32_bf16 v[52:55], v[152:155], v[56:59], v[52:55]
    ds_read_b128 v[132:135], v21 offset:9216
    s_waitcnt vmcnt(5) lgkmcnt(10)
    v_mfma_f32_16x16x32_bf16 v[36:39], v[156:159], v[60:63], v[36:39]
    buffer_load_dwordx4 v[84:87], v2, s[20:23], s4 offen sc1
    s_add_u32 s4, s4, 1024
    ds_read_b128 v[136:139], v21 offset:10240
    v_mfma_f32_16x16x32_bf16 v[40:43], v[160:163], v[60:63], v[40:43]
    ds_read_b128 v[140:143], v21 offset:11264
    v_mfma_f32_16x16x32_bf16 v[44:47], v[164:167], v[60:63], v[44:47]
    ds_read_b128 v[144:147], v21 offset:12288
    v_mfma_f32_16x16x32_bf16 v[48:51], v[168:171], v[60:63], v[48:51]
    ds_read_b128 v[148:151], v21 offset:13312
    v_mfma_f32_16x16x32_bf16 v[52:55], v[172:175], v[60:63], v[52:55]
    ds_read_b128 v[152:155], v21 offset:14336
    s_waitcnt vmcnt(5) lgkmcnt(10)
    v_mfma_f32_16x16x32_bf16 v[36:39], v[176:179], v[64:67], v[36:39]
    buffer_load_dwordx4 v[88:91], v2, s[20:23], s4 offen sc1
    s_add_u32 s4, s4, 1024
    ds_read_b128 v[156:159], v21 offset:15360
    v_mfma_f32_16x16x32_bf16 v[40:43], v[180:183], v[64:67], v[40:43]
    ds_read_b128 v[160:163], v21 offset:16384
    v_mfma_f32_16x16x32_bf16 v[44:47], v[184:187], v[64:67], v[44:47]
    ds_read_b128 v[164:167], v21 offset:17408
    v_mfma_f32_16x16x32_bf16 v[48:51], v[188:191], v[64:67], v[48:51]
    ds_read_b128 v[168:171], v21 offset:18432
    v_mfma_f32_16x16x32_bf16 v[52:55], v[192:195], v[64:67], v[52:55]
    ds_read_b128 v[172:175], v21 offset:19456
    s_waitcnt vmcnt(5) lgkmcnt(10)
    v_mfma_f32_16x16x32_bf16 v[36:39], v[196:199], v[68:71], v[36:39]
    buffer_load_dwordx4 v[92:95], v2, s[20:23], s4 offen sc1
    s_add_u32 s4, s4, 1024
    ds_read_b128 v[176:179], v21 offset:20480
    v_mfma_f32_16x16x32_bf16 v[40:43], v[200:203], v[68:71], v[40:43]
    ds_read_b128 v[180:183], v21 offset:21504
    v_mfma_f32_16x16x32_bf16 v[44:47], v[204:207], v[68:71], v[44:47]
    ds_read_b128 v[184:187], v21 offset:22528
    v_mfma_f32_16x16x32_bf16 v[48:51], v[208:211], v[68:71], v[48:51]
    ds_read_b128 v[188:191], v21 offset:23552
    v_mfma_f32_16x16x32_bf16 v[52:55], v[212:215], v[68:71], v[52:55]
    ds_read_b128 v[192:195], v21 offset:24576
    s_waitcnt vmcnt(5) lgkmcnt(10)
    v_mfma_f32_16x16x32_bf16 v[36:39], v[216:219], v[72:75], v[36:39]
    buffer_load_dwordx4 v[56:59], v2, s[20:23], s4 offen sc1
    s_add_u32 s4, s4, 1024
    ds_read_b128 v[196:199], v21 offset:25600
    v_mfma_f32_16x16x32_bf16 v[40:43], v[220:223], v[72:75], v[40:43]
    ds_read_b128 v[200:203], v21 offset:26624
    v_mfma_f32_16x16x32_bf16 v[44:47], v[224:227], v[72:75], v[44:47]
    ds_read_b128 v[204:207], v21 offset:27648
    v_mfma_f32_16x16x32_bf16 v[48:51], v[228:231], v[72:75], v[48:51]
    ds_read_b128 v[208:211], v21 offset:28672
    v_mfma_f32_16x16x32_bf16 v[52:55], v[232:235], v[72:75], v[52:55]
    ds_read_b128 v[212:215], v21 offset:29696
    s_waitcnt vmcnt(5) lgkmcnt(10)
    v_mfma_f32_16x16x32_bf16 v[36:39], v[236:239], v[76:79], v[36:39]
    buffer_load_dwordx4 v[60:63], v2, s[20:23], s4 offen sc1
    s_add_u32 s4, s4, 1024
    ds_read_b128 v[216:219], v21 offset:30720
    v_mfma_f32_16x16x32_bf16 v[40:43], v[240:243], v[76:79], v[40:43]
    ds_read_b128 v[220:223], v21 offset:31744
    v_mfma_f32_16x16x32_bf16 v[44:47], v[244:247], v[76:79], v[44:47]
    ds_read_b128 v[224:227], v21 offset:32768
    v_mfma_f32_16x16x32_bf16 v[48:51], v[248:251], v[76:79], v[48:51]
    ds_read_b128 v[228:231], v21 offset:33792
    v_mfma_f32_16x16x32_bf16 v[52:55], v[252:255], v[76:79], v[52:55]
    ds_read_b128 v[232:235], v21 offset:34816
    s_waitcnt vmcnt(5) lgkmcnt(10)
    v_mfma_f32_16x16x32_bf16 v[36:39], v[96:99], v[80:83], v[36:39]
    buffer_load_dwordx4 v[64:67], v2, s[20:23], s4 offen sc1
    s_add_u32 s4, s4, 1024
    ds_read_b128 v[236:239], v21 offset:35840
    v_mfma_f32_16x16x32_bf16 v[40:43], v[100:103], v[80:83], v[40:43]
    ds_read_b128 v[240:243], v21 offset:36864
    v_mfma_f32_16x16x32_bf16 v[44:47], v[104:107], v[80:83], v[44:47]
    ds_read_b128 v[244:247], v21 offset:37888
    v_mfma_f32_16x16x32_bf16 v[48:51], v[108:111], v[80:83], v[48:51]
    ds_read_b128 v[248:251], v21 offset:38912
    v_mfma_f32_16x16x32_bf16 v[52:55], v[112:115], v[80:83], v[52:55]
    ds_read_b128 v[252:255], v21 offset:39936
    s_waitcnt vmcnt(5) lgkmcnt(10)
    v_mfma_f32_16x16x32_bf16 v[36:39], v[116:119], v[84:87], v[36:39]
    buffer_load_dwordx4 v[68:71], v2, s[20:23], s4 offen sc1
    s_add_u32 s4, s4, 1024
    v_mfma_f32_16x16x32_bf16 v[40:43], v[120:123], v[84:87], v[40:43]
    v_mfma_f32_16x16x32_bf16 v[44:47], v[124:127], v[84:87], v[44:47]
    v_mfma_f32_16x16x32_bf16 v[48:51], v[128:131], v[84:87], v[48:51]
    v_mfma_f32_16x16x32_bf16 v[52:55], v[132:135], v[84:87], v[52:55]
    s_waitcnt vmcnt(5) lgkmcnt(0)
    v_mfma_f32_16x16x32_bf16 v[36:39], v[136:139], v[88:91], v[36:39]
    v_mfma_f32_16x16x32_bf16 v[40:43], v[140:143], v[88:91], v[40:43]
    v_mfma_f32_16x16x32_bf16 v[44:47], v[144:147], v[88:91], v[44:47]
    v_mfma_f32_16x16x32_bf16 v[48:51], v[148:151], v[88:91], v[48:51]
    v_mfma_f32_16x16x32_bf16 v[52:55], v[152:155], v[88:91], v[52:55]
    s_barrier
    s_waitcnt vmcnt(4)
    v_mfma_f32_16x16x32_bf16 v[36:39], v[156:159], v[92:95], v[36:39]
    v_mfma_f32_16x16x32_bf16 v[40:43], v[160:163], v[92:95], v[40:43]
    v_mfma_f32_16x16x32_bf16 v[44:47], v[164:167], v[92:95], v[44:47]
    v_mfma_f32_16x16x32_bf16 v[48:51], v[168:171], v[92:95], v[48:51]
    v_mfma_f32_16x16x32_bf16 v[52:55], v[172:175], v[92:95], v[52:55]
    s_waitcnt vmcnt(3)
    v_mfma_f32_16x16x32_bf16 v[36:39], v[176:179], v[56:59], v[36:39]
    v_mfma_f32_16x16x32_bf16 v[40:43], v[180:183], v[56:59], v[40:43]
    v_mfma_f32_16x16x32_bf16 v[44:47], v[184:187], v[56:59], v[44:47]
    v_mfma_f32_16x16x32_bf16 v[48:51], v[188:191], v[56:59], v[48:51]
    v_mfma_f32_16x16x32_bf16 v[52:55], v[192:195], v[56:59], v[52:55]
    s_waitcnt vmcnt(2)
    v_mfma_f32_16x16x32_bf16 v[36:39], v[196:199], v[60:63], v[36:39]
    v_mfma_f32_16x16x32_bf16 v[40:43], v[200:203], v[60:63], v[40:43]
    v_mfma_f32_16x16x32_bf16 v[44:47], v[204:207], v[60:63], v[44:47]
    v_mfma_f32_16x16x32_bf16 v[48:51], v[208:211], v[60:63], v[48:51]
    v_mfma_f32_16x16x32_bf16 v[52:55], v[212:215], v[60:63], v[52:55]
    s_waitcnt vmcnt(1)
    v_mfma_f32_16x16x32_bf16 v[36:39], v[216:219], v[64:67], v[36:39]
    v_mfma_f32_16x16x32_bf16 v[40:43], v[220:223], v[64:67], v[40:43]
    v_mfma_f32_16x16x32_bf16 v[44:47], v[224:227], v[64:67], v[44:47]
    v_mfma_f32_16x16x32_bf16 v[48:51], v[228:231], v[64:67], v[48:51]
    v_mfma_f32_16x16x32_bf16 v[52:55], v[232:235], v[64:67], v[52:55]
    s_cmp_eq_u32 s29, 0
    s_cbranch_scc1 mega_kernel_e_nf
    s_barrier
    ds_read_b128 v[136:139], v24 offset:0
    ds_read_b128 v[140:143], v24 offset:1024
    ds_read_b128 v[144:147], v24 offset:2048
    ds_read_b128 v[148:151], v24 offset:3072
    ds_read_b128 v[152:155], v24 offset:4096
mega_kernel_e_nf:
    s_waitcnt vmcnt(0)
    v_mfma_f32_16x16x32_bf16 v[36:39], v[236:239], v[68:71], v[36:39]
    v_mfma_f32_16x16x32_bf16 v[40:43], v[240:243], v[68:71], v[40:43]
    v_mfma_f32_16x16x32_bf16 v[44:47], v[244:247], v[68:71], v[44:47]
    v_mfma_f32_16x16x32_bf16 v[48:51], v[248:251], v[68:71], v[48:51]
    v_mfma_f32_16x16x32_bf16 v[52:55], v[252:255], v[68:71], v[52:55]
    s_cmp_lg_u32 s29, 0
    s_cbranch_scc1 mega_kernel_e_k1
    s_nop 1
    ds_write_b128 v24, v[36:39] offset:0
    ds_write_b128 v24, v[40:43] offset:1024
    ds_write_b128 v24, v[44:47] offset:2048
    ds_write_b128 v24, v[48:51] offset:3072
    ds_write_b128 v24, v[52:55] offset:4096
    s_waitcnt lgkmcnt(0)
    s_barrier
    s_branch mega_kernel_fin
mega_kernel_e_k1:
    s_waitcnt lgkmcnt(4)
    s_nop 0
    v_pk_add_f32 v[36:37], v[36:37], v[136:137]
    v_pk_add_f32 v[38:39], v[38:39], v[138:139]
    v_cvt_pk_bf16_f32 v10, v36, v37
    v_cvt_pk_bf16_f32 v11, v38, v39
    s_waitcnt lgkmcnt(3)
    v_pk_add_f32 v[40:41], v[40:41], v[140:141]
    v_pk_add_f32 v[42:43], v[42:43], v[142:143]
    v_cvt_pk_bf16_f32 v12, v40, v41
    v_cvt_pk_bf16_f32 v13, v42, v43
    s_waitcnt lgkmcnt(2)
    v_pk_add_f32 v[44:45], v[44:45], v[144:145]
    v_pk_add_f32 v[46:47], v[46:47], v[146:147]
    v_cvt_pk_bf16_f32 v14, v44, v45
    v_cvt_pk_bf16_f32 v15, v46, v47
    s_waitcnt lgkmcnt(1)
    v_pk_add_f32 v[48:49], v[48:49], v[148:149]
    v_pk_add_f32 v[50:51], v[50:51], v[150:151]
    v_cvt_pk_bf16_f32 v16, v48, v49
    v_cvt_pk_bf16_f32 v17, v50, v51
    s_waitcnt lgkmcnt(0)
    v_pk_add_f32 v[52:53], v[52:53], v[152:153]
    v_pk_add_f32 v[54:55], v[54:55], v[154:155]
    v_cvt_pk_bf16_f32 v18, v52, v53
    v_cvt_pk_bf16_f32 v19, v54, v55
    v_permlane16_swap_b32 v10, v12
    v_permlane16_swap_b32 v11, v13
    v_permlane16_swap_b32 v14, v16
    v_permlane16_swap_b32 v15, v17
    buffer_store_dwordx2 v[18:19], v23, s[12:15], s30 offen offset:128
    buffer_store_dwordx4 v[10:13], v22, s[12:15], s30 offen
    buffer_store_dwordx4 v[14:17], v22, s[12:15], s30 offen offset:64
mega_kernel_fin:
mega_kernel_end:
    s_endpgm
.fill 64, 4, 0xbf800000
.section .rodata,"a"
.p2align 6
.amdhsa_kernel mega_kernel
  .amdhsa_next_free_vgpr 256
  .amdhsa_next_free_sgpr 100
  .amdhsa_accum_offset 256
  .amdhsa_group_segment_fixed_size 0
  .amdhsa_kernarg_size 80
  .amdhsa_user_sgpr_count 2
  .amdhsa_user_sgpr_kernarg_segment_ptr 1
  .amdhsa_system_sgpr_workgroup_id_x 1
  .amdhsa_float_denorm_mode_32 3
.end_amdhsa_kernel
```
